```python
import torch

def _softmax(x, axis=-1):
    return torch.softmax(x, dim=axis)
def _gelu(x):
    return torch.nn.functional.gelu(x, approximate="tanh")
def _silu(x):
    return torch.nn.functional.silu(x)
def _sigmoid(x):
    return torch.sigmoid(x)
def _layernorm(x, axis=-1, eps=1e-5):
    m = x.mean(dim=axis, keepdim=True)
    v = x.var(dim=axis, keepdim=True, unbiased=False)
    return (x - m) / torch.sqrt(v + eps)
def _scatter_add(tgt, idx, src, axis=0):
    return tgt.clone().index_add_(axis, idx, src)
def _segment_sum(src, seg, n):
    out = torch.zeros((n,) + src.shape[1:], dtype=src.dtype)
    return out.index_add_(0, seg, src)
def _pad(x, pw):
    flat = tuple(v for pair in reversed(pw) for v in pair)
    return torch.nn.functional.pad(x, flat)

kernel_name = 'parallel_sum__linear_kernel_hedgehog__mixer_token_mlp__prompt'

def setup_inputs():

    _w = (lambda a: (lambda t: t.to(torch.bfloat16) if t.is_floating_point() else t)(torch.as_tensor(a)))
    def _A_setup():
        B, S, D, H = 1, 2048, 576, 32
        Dh = D // H
        return {
            "x": _w((lambda *s: torch.randn(*s, dtype=torch.bfloat16) * 0.05)(B, S, D)),
            "wqkv": _w((lambda *s: torch.randn(*s, dtype=torch.bfloat16) * 0.2)(D, 3 * D)),
            "w_phi": _w((lambda *s: torch.randn(*s, dtype=torch.bfloat16) * 0.2)(H, Dh, Dh) * (Dh ** -0.5)),
            "wo": _w((lambda *s: torch.randn(*s, dtype=torch.bfloat16) * 0.05)(D, D)),
        }
    _A_in = _A_setup()

    def _B_setup():
        B, S, D, F = 1, 2048, 576, 4608
        return {
            "x": _w((lambda *s: torch.randn(*s, dtype=torch.bfloat16) * 0.05)(B, S, D)),
            "w1": _w((lambda *s: torch.randn(*s, dtype=torch.bfloat16) * 0.8)(S, F) * (S ** -0.5)),
            "b1": _w((lambda *s: torch.randn(*s, dtype=torch.bfloat16) * 12.8)(F) * 0.02),
            "w2": _w((lambda *s: torch.randn(*s, dtype=torch.bfloat16) * 0.1)(F, S) * (F ** -0.5)),
            "b2": _w((lambda *s: torch.randn(*s, dtype=torch.bfloat16) * 1.6)(S) * 0.02),
        }
    _B_in = _B_setup()

    return {
        "A_x": _A_in["x"],
        "A_wqkv": _A_in["wqkv"],
        "A_w_phi": _A_in["w_phi"],
        "A_wo": _A_in["wo"],
        "B_x": _B_in["x"],
        "B_w1": _B_in["w1"],
        "B_b1": _B_in["b1"],
        "B_w2": _B_in["w2"],
        "B_b2": _B_in["b2"],
    }

def reference(A_x, A_wqkv, A_w_phi, A_wo, B_x, B_w1, B_b1, B_w2, B_b2):
    def _A_ref(x, wqkv, w_phi, wo):
        B, S, D = x.shape
        H = 32; Dh = D // H
        qkv = (lambda x, *d: x.permute(*d))((x @ wqkv).reshape(B, S, 3, H, Dh), 2, 0, 3, 1, 4)
        q, k, v = qkv[0], qkv[1], qkv[2]
        pq = torch.einsum("bhsd,hdf->bhsf", q, w_phi)
        pk = torch.einsum("bhsd,hdf->bhsf", k, w_phi)
        phi_q = torch.concatenate([_softmax(pq, axis=-1), _softmax(-pq, axis=-1)], axis=-1)
        phi_k = torch.concatenate([_softmax(pk, axis=-1), _softmax(-pk, axis=-1)], axis=-1)
        kv = torch.einsum("bhsf,bhsd->bhfd", phi_k, v)
        z  = torch.einsum("bhsf->bhf", phi_k)
        num = torch.einsum("bhqf,bhfd->bhqd", phi_q, kv)
        den = torch.einsum("bhqf,bhf->bhq", phi_q, z)[..., None] + 1e-6
        o = num / den
        return (lambda x, *d: x.permute(*d))(o, 0, 2, 1, 3).reshape(B, S, D) @ wo

    def _B_ref(x, w1, b1, w2, b2):
        B, S, D = x.shape
        h = _layernorm(x, axis=-1)
        u = torch.einsum("bsd,sf->bdf", h, w1) + b1
        u = _gelu(u)
        y = torch.einsum("bdf,fs->bds", u, w2) + b2
        return (lambda x, *d: x.permute(*d))(y, 0, 2, 1)

    x = A_x
    xn = _layernorm(x, axis=-1)
    return x + _A_ref(xn, A_wqkv, A_w_phi, A_wo) + _B_ref(xn, B_w1, B_b1, B_w2, B_b2)
```

```asm
; @launch grid=(256,1,1) block=(512,1,1) lds=163840
.amdgcn_target "amdgcn-amd-amdhsa--gfx950"
.text
.globl parallel_sum__linear_kernel_hedgehog__mixer_token_mlp__prompt_kernel
.p2align 8
.type parallel_sum__linear_kernel_hedgehog__mixer_token_mlp__prompt_kernel,@function
parallel_sum__linear_kernel_hedgehog__mixer_token_mlp__prompt_kernel:
s_cmp_ge_u32 s2, 256
s_cbranch_scc1 K_end
s_load_dwordx4 s[4:7], s[0:1], 0
s_load_dwordx2 s[26:27], s[0:1], 88
s_load_dwordx4 s[20:23], s[0:1], 16
s_load_dwordx2 s[48:49], s[0:1], 40
s_sub_u32 s44, s2, 112
s_cmp_ge_u32 s44, 128
s_cbranch_scc1 K0_pf
v_lshrrev_b32 v2, 5, v0
v_and_b32 v3, 31, v0
v_mul_u32_u24 v4, 1152, v2
v_lshl_add_u32 v4, v3, 4, v4
v_cmp_gt_u32 s[30:31], 24, v3
v_mov_b32 v5, 2147483648
s_mul_i32 s3, s44, 18432
v_cndmask_b32 v4, v5, v4, s[30:31]
s_waitcnt lgkmcnt(0)
s_mov_b32 s8, s4
s_mov_b32 s9, s5
s_mov_b32 s10, 2359296
s_mov_b32 s11, 0x20000
buffer_load_dwordx4 v[8:11], v4, s[8:11], s3 offen offset:0
buffer_load_dwordx4 v[12:15], v4, s[8:11], s3 offen offset:384
buffer_load_dwordx4 v[16:19], v4, s[8:11], s3 offen offset:768
s_branch K0_ln
K0_pf:
v_lshrrev_b32 v1, 6, v0
s_nop 1
v_readfirstlane_b32 s16, v1
s_cmp_ge_u32 s2, 108
s_cbranch_scc1 K0_nofold
s_mul_i32 s18, s2, 7282
s_lshr_b32 s18, s18, 16
s_mul_i32 s19, s18, 9
s_sub_u32 s17, s2, s19
s_and_b32 s28, s18, 3
s_lshr_b32 s29, s18, 2
v_add_u32 v4, 0, v0
v_mul_u32_u24 v5, 58255, v4
v_lshrrev_b32 v5, 20, v5
v_mul_u32_u24 v5, 3168, v5
v_lshl_add_u32 v12, v4, 4, v5
v_add_u32 v4, 512, v0
v_mul_u32_u24 v5, 58255, v4
v_lshrrev_b32 v5, 20, v5
v_mul_u32_u24 v5, 3168, v5
v_lshl_add_u32 v13, v4, 4, v5
v_add_u32 v4, 1024, v0
v_mul_u32_u24 v5, 58255, v4
v_lshrrev_b32 v5, 20, v5
v_mul_u32_u24 v5, 3168, v5
v_lshl_add_u32 v14, v4, 4, v5
s_mul_i32 s32, s17, 221184
s_mul_i32 s33, s29, 1152
s_add_u32 s32, s32, s33
s_mul_i32 s33, s28, 288
s_add_u32 s32, s32, s33
s_mul_i32 s33, s28, 5184
v_lshlrev_b32 v15, 4, v0
v_subrev_u32 v15, 2048, v15
s_lshl_b32 s34, s16, 10
s_add_u32 m0, s34, 129024
s_waitcnt lgkmcnt(0)
s_mov_b32 s8, s6
s_mov_b32 s9, s7
s_mov_b32 s10, 1990656
s_mov_b32 s11, 0x20000
buffer_load_dwordx4 v12, s[8:11], s32 offen lds
s_add_u32 m0, s34, 137216
s_mov_b32 s12, s20
s_mov_b32 s13, s21
s_mov_b32 s14, 20736
s_mov_b32 s15, 0x20000
buffer_load_dwordx4 v13, s[8:11], s32 offen lds
s_add_u32 m0, s34, 145408
s_cmp_ge_u32 s16, 2
s_cbranch_scc1 K0_f1
buffer_load_dwordx4 v14, s[8:11], s32 offen lds
K0_f1:
s_add_u32 m0, s34, 145408
s_cmp_eq_u32 s29, 2
s_cselect_b32 s3, 1, 6
s_sub_u32 s35, s16, 2
s_cmp_ge_u32 s35, s3
s_cbranch_scc1 K0_f2
buffer_load_dwordx4 v15, s[12:15], s33 offen lds
K0_f2:
s_add_u32 s96, s26, 32505856
s_addc_u32 s97, s27, 0
s_mov_b32 s98, 360448
s_mov_b32 s99, 0x20000
s_load_dword s100, s[96:97], 336896
s_mov_b32 s52, s48
s_mov_b32 s53, s49
s_mov_b32 s54, 18874368
s_mov_b32 s55, 0x20000
s_and_b32 s46, s2, 7
s_mul_i32 s46, s46, 18
s_lshr_b32 s46, s46, 2
s_lshl_b32 s46, s46, 8
s_and_b32 s47, s2, 0x78
s_add_u32 s47, s47, s16
v_and_b32 v1, 63, v0
s_barrier
s_getpc_b64 s[60:61]
Lpc_1:
s_add_u32 s60, s60, K0_ln-Lpc_1
s_addc_u32 s61, s61, 0
s_and_b32 s3, s2, 0x78
s_add_u32 s3, s3, s16
s_mul_i32 s3, s3, 6
v_add_lshl_u32 v90, v1, s3, 7
v_min_u32 v90, CODE_END-K0_ln-4, v90
s_mov_b64 exec, 63
global_load_dword v255, v90, s[60:61]
s_mov_b64 exec, -1
s_mul_i32 s57, s47, 32
v_add_u32 v88, s57, v1
v_mul_u32_u24 v89, 52429, v88
v_lshrrev_b32 v89, 19, v89
v_mul_u32_u24 v89, 7936, v89
v_lshl_add_u32 v88, v88, 7, v89
s_bfm_b64 exec, 32, 0
buffer_load_dword v255, v88, s[52:55], s46 offen
s_mov_b64 exec, -1
s_add_u32 s47, s47, 128
s_lshr_b32 s19, s16, 2
s_and_b32 s43, s16, 3
s_lshl_b32 s30, s43, 1
s_add_u32 s30, s30, s19
s_add_u32 s20, s26, 4718592
s_addc_u32 s21, s27, 0
s_mov_b32 s22, 1990656
s_mov_b32 s23, 0x20000
v_and_b32 v2, 15, v1
v_lshrrev_b32 v3, 4, v1
v_and_b32 v4, 12, v2
v_add_u32 v4, v4, v2
v_mul_u32_u24 v4, 288, v4
v_lshl_add_u32 v4, v3, 4, v4
s_mul_i32 s33, s30, 36
s_and_b32 s39, s33, 15
s_sub_u32 s33, s33, s39
s_add_u32 s33, s33, 129024
v_add_u32 v76, s33, v4
s_lshr_b32 s39, s39, 1
v_lshlrev_b32 v11, 3, v3
v_subrev_u32 v11, s39, v11
s_mov_b32 s40, 0x00030003
s_mov_b32 s41, 0x00030003
s_cmp_eq_u32 s29, 2
s_cbranch_scc1 K0_ident
s_mul_i32 s34, s19, 18
v_add_u32 v5, s34, v2
s_lshl_b32 s35, s43, 6
s_add_u32 s35, s35, 110592
v_lshrrev_b32 v6, 2, v5
v_lshlrev_b32 v6, 10, v6
v_and_b32 v7, 3, v5
v_lshl_add_u32 v6, v7, 4, v6
v_lshl_add_u32 v6, v3, 8, v6
v_add_u32 v52, s35, v6
v_add_u32 v5, 16, v5
v_lshrrev_b32 v6, 2, v5
v_lshlrev_b32 v6, 10, v6
v_and_b32 v7, 3, v5
v_lshl_add_u32 v6, v7, 4, v6
v_lshl_add_u32 v6, v3, 8, v6
v_add_u32 v53, s35, v6
s_lshr_b32 s34, s28, 1
s_add_u32 s34, s34, 4
s_and_b32 s35, s28, 1
s_mul_i32 s35, s35, 9216
s_cmp_eq_u32 s29, 0
s_cselect_b32 s34, s34, s28
s_cselect_b32 s35, s35, 0
s_mov_b32 s42, 1069066811
v_mul_i32_i24 v5, 36, v11
v_lshl_add_u32 v5, v2, 1, v5
s_mul_i32 s33, s30, 648
s_add_u32 s33, s33, 147456
v_add_u32 v80, s33, v5
v_add_u32 v5, 0, v11
v_cmp_gt_u32 s[36:37], 18, v5
v_add_u32 v5, 2, v11
v_cmp_gt_u32 s[44:45], 18, v5
v_add_u32 v5, 4, v11
v_cmp_gt_u32 s[58:59], 18, v5
v_add_u32 v5, 6, v11
v_cmp_gt_u32 s[60:61], 18, v5
s_waitcnt vmcnt(2)
s_barrier
ds_read_b128 v[12:15], v76 offset:0
ds_read_b128 v[16:19], v76 offset:1152
ds_read_b128 v[20:23], v76 offset:9216
ds_read_b128 v[24:27], v76 offset:10368
ds_read_u16 v36, v80 offset:0
ds_read_u16 v37, v80 offset:36
ds_read_u16 v38, v80 offset:72
ds_read_u16 v39, v80 offset:108
ds_read_u16 v40, v80 offset:144
ds_read_u16 v41, v80 offset:180
ds_read_u16 v42, v80 offset:216
ds_read_u16 v43, v80 offset:252
ds_read_u16 v44, v80 offset:32
ds_read_u16 v45, v80 offset:68
ds_read_u16 v46, v80 offset:104
ds_read_u16 v47, v80 offset:140
ds_read_u16 v48, v80 offset:176
ds_read_u16 v49, v80 offset:212
ds_read_u16 v50, v80 offset:248
ds_read_u16 v51, v80 offset:284
s_waitcnt lgkmcnt(0)
v_lshl_or_b32 v28, v37, 16, v36
v_lshl_or_b32 v29, v39, 16, v38
v_lshl_or_b32 v30, v41, 16, v40
v_lshl_or_b32 v31, v43, 16, v42
v_lshl_or_b32 v32, v45, 16, v44
v_lshl_or_b32 v33, v47, 16, v46
v_lshl_or_b32 v34, v49, 16, v48
v_lshl_or_b32 v35, v51, 16, v50
v_cndmask_b32 v28, 0, v28, s[36:37]
v_cndmask_b32 v29, 0, v29, s[44:45]
v_cndmask_b32 v30, 0, v30, s[58:59]
v_cndmask_b32 v31, 0, v31, s[60:61]
v_cndmask_b32 v32, 0, v32, s[36:37]
v_cndmask_b32 v33, 0, v33, s[44:45]
v_cndmask_b32 v34, 0, v34, s[58:59]
v_cndmask_b32 v35, 0, v35, s[60:61]
s_branch K0_fmm
K0_ident:
v_sub_u32 v5, v2, v11
v_add_u32 v6, 16, v5
v_mov_b32 v7, 0x3f80
v_mov_b32 v8, 0x3f800000
v_cmp_eq_u32 vcc, 0, v5
v_cmp_eq_u32 s[44:45], 1, v5
s_nop 1
v_cndmask_b32 v9, 0, v7, vcc
v_cndmask_b32 v28, v9, v8, s[44:45]
v_cmp_eq_u32 vcc, 2, v5
v_cmp_eq_u32 s[44:45], 3, v5
s_nop 1
v_cndmask_b32 v9, 0, v7, vcc
v_cndmask_b32 v29, v9, v8, s[44:45]
v_cmp_eq_u32 vcc, 4, v5
v_cmp_eq_u32 s[44:45], 5, v5
s_nop 1
v_cndmask_b32 v9, 0, v7, vcc
v_cndmask_b32 v30, v9, v8, s[44:45]
v_cmp_eq_u32 vcc, 6, v5
v_cmp_eq_u32 s[44:45], 7, v5
s_nop 1
v_cndmask_b32 v9, 0, v7, vcc
v_cndmask_b32 v31, v9, v8, s[44:45]
v_cmp_eq_u32 vcc, 0, v6
v_cmp_eq_u32 s[44:45], 1, v6
s_nop 1
v_cndmask_b32 v9, 0, v7, vcc
v_cndmask_b32 v32, v9, v8, s[44:45]
v_cmp_eq_u32 vcc, 2, v6
v_cmp_eq_u32 s[44:45], 3, v6
s_nop 1
v_cndmask_b32 v9, 0, v7, vcc
v_cndmask_b32 v33, v9, v8, s[44:45]
v_cmp_eq_u32 vcc, 4, v6
v_cmp_eq_u32 s[44:45], 5, v6
s_nop 1
v_cndmask_b32 v9, 0, v7, vcc
v_cndmask_b32 v34, v9, v8, s[44:45]
v_cmp_eq_u32 vcc, 6, v6
v_cmp_eq_u32 s[44:45], 7, v6
s_nop 1
v_cndmask_b32 v9, 0, v7, vcc
v_cndmask_b32 v35, v9, v8, s[44:45]
v_lshlrev_b32 v6, 8, v3
v_lshl_add_u32 v6, v2, 4, v6
v_add_u32 v6, 110592, v6
s_lshl_b32 s34, s30, 10
v_add_u32 v52, s34, v6
s_lshl_b32 s34, s30, 5
s_add_u32 s34, s34, 8192
v_add_u32 v53, s34, v6
s_mov_b32 s34, s28
s_mov_b32 s35, 9216
s_mov_b32 s42, 1.0
s_waitcnt vmcnt(2)
s_barrier
ds_read_b128 v[12:15], v76 offset:0
ds_read_b128 v[16:19], v76 offset:1152
ds_read_b128 v[20:23], v76 offset:9216
ds_read_b128 v[24:27], v76 offset:10368
s_waitcnt lgkmcnt(0)
K0_fmm:
s_mul_i32 s34, s34, 18
s_lshl_b32 s33, s17, 1
s_add_u32 s34, s34, s33
s_mul_i32 s34, s34, 18432
s_add_u32 s34, s34, s35
v_mfma_f32_16x16x32_bf16 v[56:59], v[12:15], v[28:31], 0
v_mfma_f32_16x16x32_bf16 v[60:63], v[16:19], v[28:31], 0
v_mfma_f32_16x16x32_bf16 v[64:67], v[12:15], v[32:35], 0
v_mfma_f32_16x16x32_bf16 v[68:71], v[16:19], v[32:35], 0
v_mfma_f32_16x16x32_bf16 v[72:75], v[20:23], v[28:31], 0
v_mfma_f32_16x16x32_bf16 v[76:79], v[24:27], v[28:31], 0
v_mfma_f32_16x16x32_bf16 v[80:83], v[20:23], v[32:35], 0
v_mfma_f32_16x16x32_bf16 v[84:87], v[24:27], v[32:35], 0
s_add_u32 s100, s100, 1
s_mul_i32 s101, s100, 0x9e3779b1
s_add_u32 s101, s101, 0x7f4a7c15
s_lshl_b32 s49, s2, 2
s_add_u32 s49, s49, s16
s_add_u32 s49, s49, 256
s_cmp_eq_u32 s16, 4
s_cselect_b32 s49, s2, s49
s_lshl_b32 s49, s49, 7
s_cmp_gt_u32 s16, 4
s_cselect_b32 s49, 2147483648, s49
s_load_dwordx4 s[4:7], s[0:1], 40
s_load_dwordx2 s[50:51], s[0:1], 56
s_mov_b32 s43, s42
s_lshl_b32 s33, s16, 10
v_lshlrev_b32 v89, 4, v1
s_and_b32 s3, s16, 1
s_mul_i32 s35, s3, 9216
s_add_u32 s37, s33, 110592
v_add_u32 v90, s37, v89
s_add_u32 s35, s35, 118784
v_add_u32 v91, s35, v89
s_mul_i32 s3, s3, 18432
s_add_u32 s37, s34, s3
s_add_u32 s37, s37, 8192
s_add_u32 s17, s34, s33
v_pk_mul_f32 v[56:57], v[56:57], s[42:43]
v_pk_mul_f32 v[58:59], v[58:59], s[42:43]
v_pk_mul_f32 v[60:61], v[60:61], s[42:43]
v_pk_mul_f32 v[62:63], v[62:63], s[42:43]
v_cvt_pk_bf16_f32 v36, v56, v57
v_cvt_pk_bf16_f32 v37, v58, v59
v_cvt_pk_bf16_f32 v38, v60, v61
v_cvt_pk_bf16_f32 v39, v62, v63
ds_write_b128 v52, v[36:39] offset:0
v_pk_mul_f32 v[64:65], v[64:65], s[42:43]
v_pk_mul_f32 v[66:67], v[66:67], s[42:43]
v_pk_mul_f32 v[68:69], v[68:69], s[42:43]
v_pk_mul_f32 v[70:71], v[70:71], s[42:43]
v_cvt_pk_bf16_f32 v40, v64, v65
v_cvt_pk_bf16_f32 v41, v66, v67
v_cvt_pk_bf16_f32 v42, v68, v69
v_cvt_pk_bf16_f32 v43, v70, v71
v_pk_mul_f32 v[72:73], v[72:73], s[42:43]
v_pk_mul_f32 v[74:75], v[74:75], s[42:43]
v_pk_mul_f32 v[76:77], v[76:77], s[42:43]
v_pk_mul_f32 v[78:79], v[78:79], s[42:43]
v_cvt_pk_bf16_f32 v44, v72, v73
v_cvt_pk_bf16_f32 v45, v74, v75
v_cvt_pk_bf16_f32 v46, v76, v77
v_cvt_pk_bf16_f32 v47, v78, v79
ds_write_b128 v52, v[44:47] offset:9216
v_pk_mul_f32 v[80:81], v[80:81], s[42:43]
v_pk_mul_f32 v[82:83], v[82:83], s[42:43]
v_pk_mul_f32 v[84:85], v[84:85], s[42:43]
v_pk_mul_f32 v[86:87], v[86:87], s[42:43]
v_cvt_pk_bf16_f32 v48, v80, v81
v_cvt_pk_bf16_f32 v49, v82, v83
v_cvt_pk_bf16_f32 v50, v84, v85
v_cvt_pk_bf16_f32 v51, v86, v87
s_mov_b64 exec, s[40:41]
ds_write_b128 v53, v[40:43]
ds_write_b128 v53, v[48:51] offset:9216
s_mov_b64 exec, -1
s_waitcnt lgkmcnt(0)
s_barrier
s_cmp_ge_u32 s16, 4
s_cbranch_scc1 K0_seam
ds_read_b128 v[12:15], v90 offset:0
ds_read_b128 v[16:19], v90 offset:4096
ds_read_b128 v[20:23], v90 offset:9216
ds_read_b128 v[24:27], v90 offset:13312
ds_read_b128 v[28:31], v91
s_waitcnt lgkmcnt(4)
buffer_store_dwordx4 v[12:15], v89, s[20:23], s17 offen sc1
s_add_u32 s17, s17, 4096
s_waitcnt lgkmcnt(3)
buffer_store_dwordx4 v[16:19], v89, s[20:23], s17 offen sc1
s_add_u32 s17, s17, 14336
s_waitcnt lgkmcnt(2)
buffer_store_dwordx4 v[20:23], v89, s[20:23], s17 offen sc1
s_add_u32 s17, s17, 4096
s_waitcnt lgkmcnt(1)
buffer_store_dwordx4 v[24:27], v89, s[20:23], s17 offen sc1
s_add_u32 s17, s17, 4096
s_branch K0_last
K0_nofold:
s_waitcnt lgkmcnt(0)
s_add_u32 s96, s26, 32505856
s_addc_u32 s97, s27, 0
s_mov_b32 s98, 360448
s_mov_b32 s99, 0x20000
s_load_dword s100, s[96:97], 336896
s_mov_b32 s52, s48
s_mov_b32 s53, s49
s_mov_b32 s54, 18874368
s_mov_b32 s55, 0x20000
s_and_b32 s46, s2, 7
s_mul_i32 s46, s46, 18
s_lshr_b32 s46, s46, 2
s_lshl_b32 s46, s46, 8
s_and_b32 s47, s2, 0x78
s_add_u32 s47, s47, s16
v_and_b32 v1, 63, v0
s_cmp_ge_u32 s2, 240
s_cbranch_scc1 K1_spare
s_sub_u32 s3, s2, 108
s_lshl_b32 s3, s3, 3
s_add_u32 s3, s3, s16
s_mul_i32 s3, s3, 25
v_add_lshl_u32 v90, v1, s3, 7
s_bfm_b64 exec, 25, 0
buffer_load_dword v255, v90, s[96:99], 0 offen sc1
s_mov_b64 exec, -1
s_cmp_ge_u32 s2, 240
s_cbranch_scc1 K1_spare
s_mul_i32 s57, s47, 32
v_add_u32 v88, s57, v1
v_mul_u32_u24 v89, 52429, v88
v_lshrrev_b32 v89, 19, v89
v_mul_u32_u24 v89, 7936, v89
v_lshl_add_u32 v88, v88, 7, v89
s_bfm_b64 exec, 32, 0
buffer_load_dword v255, v88, s[52:55], s46 offen
s_mov_b64 exec, -1
s_add_u32 s47, s47, 128
s_waitcnt lgkmcnt(0)
s_add_u32 s100, s100, 1
s_mul_i32 s101, s100, 0x9e3779b1
s_add_u32 s101, s101, 0x7f4a7c15
s_lshl_b32 s49, s2, 2
s_add_u32 s49, s49, s16
s_add_u32 s49, s49, 256
s_cmp_eq_u32 s16, 4
s_cselect_b32 s49, s2, s49
s_lshl_b32 s49, s49, 7
s_cmp_gt_u32 s16, 4
s_cselect_b32 s49, 2147483648, s49
s_load_dwordx4 s[4:7], s[0:1], 40
s_load_dwordx2 s[50:51], s[0:1], 56
s_waitcnt lgkmcnt(0)
s_barrier
s_branch K0_seam
K0_ln:
s_add_u32 s96, s26, 32505856
s_addc_u32 s97, s27, 0
s_mov_b32 s98, 360448
s_mov_b32 s99, 0x20000
s_load_dword s100, s[96:97], 336896
v_lshrrev_b32 v1, 6, v0
s_nop 1
v_readfirstlane_b32 s16, v1
v_lshlrev_b32 v6, 2, v2
v_add_u32 v6, 110592, v6
v_mul_u32_u24 v7, 1216, v2
v_lshl_add_u32 v7, v3, 4, v7
v_add_u32 v7, 110848, v7
s_add_u32 s12, s26, 0
s_addc_u32 s13, s27, 0
s_mov_b32 s14, 16384
s_mov_b32 s15, 0x20000
s_add_u32 s20, s26, 2359296
s_addc_u32 s21, s27, 0
s_mov_b32 s22, 2359296
s_mov_b32 s23, 0x20000
s_mov_b32 s33, 987991609
s_mov_b32 s34, 925353388
v_and_b32 v1, 63, v0
v_and_b32 v2, 15, v1
v_lshrrev_b32 v3, 4, v1
s_lshl_b32 s3, s16, 6
s_and_b32 s35, s16, 1
s_lshl_b32 s36, s35, 6
v_lshlrev_b32 v69, 2, v2
v_add_u32 v68, 110592, v69
s_lshl_b32 s17, s44, 7
v_bfe_u32 v4, v1, 2, 2
v_lshrrev_b32 v5, 5, v1
v_lshl_add_u32 v4, v5, 3, v4
v_mul_u32_u24 v4, 1216, v4
v_and_b32 v3, 1, v3
v_lshl_add_u32 v4, v3, 5, v4
v_and_b32 v44, 3, v1
v_lshl_add_u32 v4, v44, 3, v4
v_add_u32 v4, 110848, v4
v_add_u32 v72, s36, v4
v_add_u32 v71, s3, v4
v_lshlrev_b32 v2, 4, v2
v_lshl_add_u32 v2, v5, 8, v2
s_mov_b32 s38, 580608
s_lshl_b32 s3, s16, 1
s_lshl_b32 s36, s35, 1
s_add_u32 s36, s36, 32
v_add_u32 v4, s3, v3
v_mul_u32_u24 v44, 57, v4
v_lshrrev_b32 v44, 9, v44
v_lshl_add_u32 v4, v4, 10, v2
v_mad_u32_u24 v73, v44, s38, v4
v_add_u32 v4, s3, v3
v_add_u32 v4, 16, v4
v_mul_u32_u24 v44, 57, v4
v_lshrrev_b32 v44, 9, v44
v_lshl_add_u32 v4, v4, 10, v2
v_mad_u32_u24 v74, v44, s38, v4
v_add_u32 v4, s36, v3
v_mul_u32_u24 v44, 57, v4
v_lshrrev_b32 v44, 9, v44
v_lshl_add_u32 v4, v4, 10, v2
v_mad_u32_u24 v75, v44, s38, v4
s_lshr_b32 s18, s44, 1
s_mul_i32 s18, s18, 9216
s_and_b32 s19, s44, 1
s_lshl_b32 s19, s19, 9
s_add_u32 s18, s18, s19
s_waitcnt vmcnt(0)
v_lshlrev_b32 v20, 16, v8
v_and_b32 v21, 0xffff0000, v8
v_lshlrev_b32 v22, 16, v9
v_and_b32 v23, 0xffff0000, v9
v_lshlrev_b32 v24, 16, v10
v_and_b32 v25, 0xffff0000, v10
v_lshlrev_b32 v26, 16, v11
v_and_b32 v27, 0xffff0000, v11
v_lshlrev_b32 v28, 16, v12
v_and_b32 v29, 0xffff0000, v12
v_lshlrev_b32 v30, 16, v13
v_and_b32 v31, 0xffff0000, v13
v_lshlrev_b32 v32, 16, v14
v_and_b32 v33, 0xffff0000, v14
v_lshlrev_b32 v34, 16, v15
v_and_b32 v35, 0xffff0000, v15
v_lshlrev_b32 v36, 16, v16
v_and_b32 v37, 0xffff0000, v16
v_lshlrev_b32 v38, 16, v17
v_and_b32 v39, 0xffff0000, v17
v_lshlrev_b32 v40, 16, v18
v_and_b32 v41, 0xffff0000, v18
v_lshlrev_b32 v42, 16, v19
v_and_b32 v43, 0xffff0000, v19
v_pk_add_f32 v[44:45], v[20:21], v[22:23]
v_pk_add_f32 v[46:47], v[24:25], v[26:27]
v_pk_add_f32 v[44:45], v[44:45], v[28:29]
v_pk_add_f32 v[46:47], v[46:47], v[30:31]
v_pk_add_f32 v[44:45], v[44:45], v[32:33]
v_pk_add_f32 v[46:47], v[46:47], v[34:35]
v_pk_add_f32 v[44:45], v[44:45], v[36:37]
v_pk_add_f32 v[46:47], v[46:47], v[38:39]
v_pk_add_f32 v[44:45], v[44:45], v[40:41]
v_pk_add_f32 v[46:47], v[46:47], v[42:43]
v_pk_add_f32 v[44:45], v[44:45], v[46:47]
v_add_f32 v44, v44, v45
s_nop 1
v_add_f32_dpp v44, v44, v44 quad_perm:[1,0,3,2] row_mask:0xf bank_mask:0xf
s_nop 1
v_add_f32_dpp v44, v44, v44 quad_perm:[2,3,0,1] row_mask:0xf bank_mask:0xf
s_nop 1
v_add_f32_dpp v44, v44, v44 row_half_mirror row_mask:0xf bank_mask:0xf
s_nop 1
v_add_f32_dpp v44, v44, v44 row_mirror row_mask:0xf bank_mask:0xf
s_nop 1
v_mov_b32 v52, v44
s_nop 1
v_permlane16_swap_b32 v44, v52
s_nop 1
v_add_f32 v44, v44, v52
v_mul_f32 v44, s33, v44
v_pk_add_f32 v[20:21], v[20:21], v[44:45] op_sel_hi:[1,0] neg_lo:[0,1] neg_hi:[0,1]
v_pk_add_f32 v[22:23], v[22:23], v[44:45] op_sel_hi:[1,0] neg_lo:[0,1] neg_hi:[0,1]
v_pk_add_f32 v[24:25], v[24:25], v[44:45] op_sel_hi:[1,0] neg_lo:[0,1] neg_hi:[0,1]
v_pk_add_f32 v[26:27], v[26:27], v[44:45] op_sel_hi:[1,0] neg_lo:[0,1] neg_hi:[0,1]
v_pk_add_f32 v[28:29], v[28:29], v[44:45] op_sel_hi:[1,0] neg_lo:[0,1] neg_hi:[0,1]
v_pk_add_f32 v[30:31], v[30:31], v[44:45] op_sel_hi:[1,0] neg_lo:[0,1] neg_hi:[0,1]
v_pk_add_f32 v[32:33], v[32:33], v[44:45] op_sel_hi:[1,0] neg_lo:[0,1] neg_hi:[0,1]
v_pk_add_f32 v[34:35], v[34:35], v[44:45] op_sel_hi:[1,0] neg_lo:[0,1] neg_hi:[0,1]
v_pk_add_f32 v[36:37], v[36:37], v[44:45] op_sel_hi:[1,0] neg_lo:[0,1] neg_hi:[0,1]
v_pk_add_f32 v[38:39], v[38:39], v[44:45] op_sel_hi:[1,0] neg_lo:[0,1] neg_hi:[0,1]
v_pk_add_f32 v[40:41], v[40:41], v[44:45] op_sel_hi:[1,0] neg_lo:[0,1] neg_hi:[0,1]
v_pk_add_f32 v[42:43], v[42:43], v[44:45] op_sel_hi:[1,0] neg_lo:[0,1] neg_hi:[0,1]
v_pk_mul_f32 v[48:49], v[20:21], v[20:21]
v_pk_mul_f32 v[50:51], v[22:23], v[22:23]
v_pk_fma_f32 v[48:49], v[24:25], v[24:25], v[48:49]
v_pk_fma_f32 v[50:51], v[26:27], v[26:27], v[50:51]
v_pk_fma_f32 v[48:49], v[28:29], v[28:29], v[48:49]
v_pk_fma_f32 v[50:51], v[30:31], v[30:31], v[50:51]
v_pk_fma_f32 v[48:49], v[32:33], v[32:33], v[48:49]
v_pk_fma_f32 v[50:51], v[34:35], v[34:35], v[50:51]
v_pk_fma_f32 v[48:49], v[36:37], v[36:37], v[48:49]
v_pk_fma_f32 v[50:51], v[38:39], v[38:39], v[50:51]
v_pk_fma_f32 v[48:49], v[40:41], v[40:41], v[48:49]
v_pk_fma_f32 v[50:51], v[42:43], v[42:43], v[50:51]
v_pk_add_f32 v[48:49], v[48:49], v[50:51]
v_add_f32 v48, v48, v49
v_cndmask_b32 v48, 0, v48, s[30:31]
s_nop 1
v_add_f32_dpp v48, v48, v48 quad_perm:[1,0,3,2] row_mask:0xf bank_mask:0xf
s_nop 1
v_add_f32_dpp v48, v48, v48 quad_perm:[2,3,0,1] row_mask:0xf bank_mask:0xf
s_nop 1
v_add_f32_dpp v48, v48, v48 row_half_mirror row_mask:0xf bank_mask:0xf
s_nop 1
v_add_f32_dpp v48, v48, v48 row_mirror row_mask:0xf bank_mask:0xf
s_nop 1
v_mov_b32 v52, v48
s_nop 1
v_permlane16_swap_b32 v48, v52
s_nop 1
v_add_f32 v48, v48, v52
v_mul_f32 v48, s33, v48
v_add_f32 v44, s34, v48
v_rsq_f32 v44, v44
v_mov_b32 v49, s34
v_mul_f32 v48, v48, v44
v_fma_f32 v50, v48, v44, v49
v_rsq_f32 v48, v50
s_mov_b64 exec, s[30:31]
v_mul_f32 v50, v50, v48
v_mul_f32 v48, v48, v44
v_mul_f32 v48, 1055913304, v48
v_mul_f32 v50, 1074302617, v50
ds_write_b32 v6, v50
v_pk_mul_f32 v[56:57], v[20:21], v[48:49] op_sel_hi:[1,0]
v_pk_mul_f32 v[58:59], v[22:23], v[48:49] op_sel_hi:[1,0]
v_pk_mul_f32 v[60:61], v[24:25], v[48:49] op_sel_hi:[1,0]
v_pk_mul_f32 v[62:63], v[26:27], v[48:49] op_sel_hi:[1,0]
v_cvt_pk_bf16_f32 v8, v56, v57
v_cvt_pk_bf16_f32 v9, v58, v59
v_cvt_pk_bf16_f32 v10, v60, v61
v_cvt_pk_bf16_f32 v11, v62, v63
ds_write_b128 v7, v[8:11] offset:0
v_pk_mul_f32 v[56:57], v[28:29], v[48:49] op_sel_hi:[1,0]
v_pk_mul_f32 v[58:59], v[30:31], v[48:49] op_sel_hi:[1,0]
v_pk_mul_f32 v[60:61], v[32:33], v[48:49] op_sel_hi:[1,0]
v_pk_mul_f32 v[62:63], v[34:35], v[48:49] op_sel_hi:[1,0]
v_cvt_pk_bf16_f32 v12, v56, v57
v_cvt_pk_bf16_f32 v13, v58, v59
v_cvt_pk_bf16_f32 v14, v60, v61
v_cvt_pk_bf16_f32 v15, v62, v63
ds_write_b128 v7, v[12:15] offset:384
v_pk_mul_f32 v[56:57], v[36:37], v[48:49] op_sel_hi:[1,0]
v_pk_mul_f32 v[58:59], v[38:39], v[48:49] op_sel_hi:[1,0]
v_pk_mul_f32 v[60:61], v[40:41], v[48:49] op_sel_hi:[1,0]
v_pk_mul_f32 v[62:63], v[42:43], v[48:49] op_sel_hi:[1,0]
v_cvt_pk_bf16_f32 v16, v56, v57
v_cvt_pk_bf16_f32 v17, v58, v59
v_cvt_pk_bf16_f32 v18, v60, v61
v_cvt_pk_bf16_f32 v19, v62, v63
ds_write_b128 v7, v[16:19] offset:768
s_mov_b64 exec, -1
s_waitcnt lgkmcnt(0)
s_barrier
ds_read_b64_tr_b16 v[76:77], v71 offset:0
ds_read_b64_tr_b16 v[78:79], v71 offset:4864
ds_read_b64_tr_b16 v[80:81], v71 offset:512
ds_read_b64_tr_b16 v[82:83], v71 offset:5376
ds_read_b64_tr_b16 v[84:85], v72 offset:1024
ds_read_b64_tr_b16 v[86:87], v72 offset:5888
ds_read_b32 v88, v68
s_cmp_lt_u32 s16, 2
s_cselect_b32 s3, 0, 2147483648
v_or_b32 v75, s3, v75
s_waitcnt lgkmcnt(5)
buffer_store_dwordx4 v[76:79], v73, s[20:23], s18 offen sc1
s_waitcnt lgkmcnt(3)
buffer_store_dwordx4 v[80:83], v74, s[20:23], s18 offen sc1
s_waitcnt lgkmcnt(1)
buffer_store_dwordx4 v[84:87], v75, s[20:23], s18 offen sc1
s_waitcnt lgkmcnt(0)
s_cmp_lg_u32 s16, 2
s_cbranch_scc1 K0_nors
s_mov_b64 exec, 0xffff
buffer_store_dword v88, v69, s[12:15], s17 offen sc1
s_mov_b64 exec, -1
K0_nors:
s_add_u32 s100, s100, 1
s_mul_i32 s101, s100, 0x9e3779b1
s_add_u32 s101, s101, 0x7f4a7c15
s_lshl_b32 s49, s2, 2
s_add_u32 s49, s49, s16
s_add_u32 s49, s49, 256
s_cmp_eq_u32 s16, 4
s_cselect_b32 s49, s2, s49
s_lshl_b32 s49, s49, 7
s_cmp_gt_u32 s16, 4
s_cselect_b32 s49, 2147483648, s49
s_load_dwordx4 s[4:7], s[0:1], 40
s_load_dwordx2 s[50:51], s[0:1], 56
s_cmp_eq_u32 s16, 4
s_cselect_b32 s49, s49, 2147483648
s_cmp_lg_u32 s16, 5
s_cbranch_scc1 K0_noh
s_cmp_ge_u32 s44, 8
s_cbranch_scc1 K0_noh
s_add_u32 s3, s44, 704
s_lshl_b32 s3, s3, 7
v_mov_b32 v4, s100
v_mov_b32 v5, s101
v_mov_b32 v6, s3
s_mov_b64 exec, 1
buffer_store_dwordx2 v[4:5], v6, s[96:99], 0 offen sc1
s_mov_b64 exec, -1
K0_noh:
s_waitcnt vmcnt(0)
s_barrier
s_branch K0_seam
K0_last:
s_waitcnt lgkmcnt(0)
s_cmp_ge_u32 s16, 2
s_cbranch_scc1 K0_last2
buffer_store_dwordx4 v[28:31], v89, s[20:23], s37 offen sc1
K0_last2:
s_waitcnt vmcnt(0)
K0_seam:
v_mov_b32 v4, s100
v_mov_b32 v5, s101
v_mov_b32 v6, s49
s_mov_b64 exec, 1
buffer_store_dwordx2 v[4:5], v6, s[96:99], 0 offen sc1
s_mov_b64 exec, -1
s_cmp_lt_u32 s2, 208
s_cbranch_scc1 K0_noa
s_cmp_ge_u32 s2, 240
s_cbranch_scc1 K0_noa
s_cmp_ge_u32 s16, 4
s_cbranch_scc1 K0_noa
s_lshr_b32 s47, s2, 3
s_sub_u32 s47, s47, 18
s_lshl_b32 s47, s47, 2
s_add_u32 s47, s47, s16
s_waitcnt lgkmcnt(0)
s_mov_b32 s52, s4
s_mov_b32 s53, s5
s_mov_b32 s54, 18874368
s_mov_b32 s55, 0x20000
s_and_b32 s46, s2, 7
s_mul_i32 s46, s46, 18
s_lshr_b32 s46, s46, 2
s_lshl_b32 s46, s46, 8
s_cmp_lt_u32 s2, 208
s_cbranch_scc1 K0_noa
s_sub_u32 s47, s47, 32
s_mul_i32 s57, s47, 64
s_add_u32 s57, s57, 3584
v_add_u32 v88, s57, v1
v_mul_u32_u24 v89, 52429, v88
v_lshrrev_b32 v89, 19, v89
v_mul_u32_u24 v89, 7936, v89
v_lshl_add_u32 v88, v88, 7, v89
buffer_load_dword v255, v88, s[52:55], s46 offen
s_add_u32 s47, s47, 16
s_mul_i32 s57, s47, 64
s_add_u32 s57, s57, 3584
v_add_u32 v88, s57, v1
v_mul_u32_u24 v89, 52429, v88
v_lshrrev_b32 v89, 19, v89
v_mul_u32_u24 v89, 7936, v89
v_lshl_add_u32 v88, v88, 7, v89
buffer_load_dword v255, v88, s[52:55], s46 offen
s_add_u32 s47, s47, 16
K0_noa:
s_and_b32 s17, s2, 7
s_lshr_b32 s18, s2, 3
s_cmp_ge_u32 s18, 18
s_cbranch_scc1 K1_notg1
s_mul_i32 s19, s17, 18
s_add_u32 s19, s19, s18
s_and_b32 s22, s19, 3
s_lshr_b32 s23, s19, 2
s_or_b32 s19, s23, 1
s_cmp_eq_u32 s19, 13
s_cselect_b32 s19, 1, 0
s_xor_b32 s23, s23, s19
s_add_u32 s59, s22, s23
s_and_b32 s59, s59, 3
s_mul_i32 s59, s59, 1
s_waitcnt lgkmcnt(0)
s_cmp_ge_u32 s16, 6
s_cbranch_scc1 K1_ldW
s_cmp_ge_u32 s16, 4
s_cbranch_scc1 K1_ldP
s_mov_b32 s32, s6
s_mov_b32 s33, s7
s_mov_b32 s34, 9216
s_mov_b32 s35, 0x20000
s_add_u32 s36, s26, 6815744
s_addc_u32 s37, s27, 0
s_mov_b32 s38, 5308416
s_mov_b32 s39, 0x20000
v_bfe_u32 v8, v0, 4, 2
v_lshlrev_b32 v8, 3, v8
s_lshl_b32 s3, s23, 8
s_lshl_b32 s17, s16, 6
s_add_u32 s3, s3, s17
buffer_load_dwordx2 v[12:13], v8, s[32:35], s3 offen
buffer_load_dwordx2 v[14:15], v8, s[32:35], s3 offen offset:32
v_and_b32 v1, 63, v0
v_lshlrev_b32 v2, 4, v1
v_add_u32 v3, 73728, v2
v_lshrrev_b32 v8, 2, v1
v_and_b32 v9, 7, v8
v_and_b32 v10, 12, v8
v_add_u32 v8, v8, v10
s_lshl_b32 s3, s16, 1
v_xor_b32 v9, s3, v9
v_lshlrev_b32 v9, 5, v9
v_lshl_add_u32 v9, v8, 8, v9
v_and_b32 v8, 3, v1
v_lshl_add_u32 v9, v8, 3, v9
v_add_u32 v4, 18432, v9
v_xor_b32 v5, 32, v4
v_add_u32 v6, 73728, v4
v_add_u32 v7, 73728, v5
s_waitcnt vmcnt(0)
v_lshlrev_b32 v96, 16, v12
v_and_b32 v97, 0xffff0000, v12
v_lshlrev_b32 v98, 16, v13
v_and_b32 v99, 0xffff0000, v13
v_lshlrev_b32 v100, 16, v14
v_and_b32 v101, 0xffff0000, v14
v_lshlrev_b32 v102, 16, v15
v_and_b32 v103, 0xffff0000, v15
v_mul_f32 v96, 1055913304, v96
v_mul_f32 v97, 1055913304, v97
v_mul_f32 v98, 1055913304, v98
v_mul_f32 v99, 1055913304, v99
v_mul_f32 v100, 1055913304, v100
v_mul_f32 v101, 1055913304, v101
v_mul_f32 v102, 1055913304, v102
v_mul_f32 v103, 1055913304, v103
v_pk_mov_b32 v[104:105], v[96:97], v[96:97] op_sel:[0,1]
v_pk_mov_b32 v[106:107], v[98:99], v[98:99] op_sel:[0,1]
v_pk_mov_b32 v[108:109], v[100:101], v[100:101] op_sel:[0,1]
v_pk_mov_b32 v[110:111], v[102:103], v[102:103] op_sel:[0,1]
v_pk_mov_b32 v[112:113], v[96:97], v[96:97] op_sel:[0,1]
v_pk_mov_b32 v[114:115], v[98:99], v[98:99] op_sel:[0,1]
v_pk_mov_b32 v[116:117], v[100:101], v[100:101] op_sel:[0,1]
v_pk_mov_b32 v[118:119], v[102:103], v[102:103] op_sel:[0,1]
v_pk_mov_b32 v[120:121], v[96:97], v[96:97] op_sel:[0,1]
v_pk_mov_b32 v[122:123], v[98:99], v[98:99] op_sel:[0,1]
v_pk_mov_b32 v[124:125], v[100:101], v[100:101] op_sel:[0,1]
v_pk_mov_b32 v[126:127], v[102:103], v[102:103] op_sel:[0,1]
v_pk_mov_b32 v[128:129], v[96:97], v[96:97] op_sel:[0,1]
v_pk_mov_b32 v[130:131], v[98:99], v[98:99] op_sel:[0,1]
v_pk_mov_b32 v[132:133], v[100:101], v[100:101] op_sel:[0,1]
v_pk_mov_b32 v[134:135], v[102:103], v[102:103] op_sel:[0,1]
v_pk_mov_b32 v[136:137], v[96:97], v[96:97] op_sel:[0,1]
v_pk_mov_b32 v[138:139], v[98:99], v[98:99] op_sel:[0,1]
v_pk_mov_b32 v[140:141], v[100:101], v[100:101] op_sel:[0,1]
v_pk_mov_b32 v[142:143], v[102:103], v[102:103] op_sel:[0,1]
v_pk_mov_b32 v[144:145], v[96:97], v[96:97] op_sel:[0,1]
v_pk_mov_b32 v[146:147], v[98:99], v[98:99] op_sel:[0,1]
v_pk_mov_b32 v[148:149], v[100:101], v[100:101] op_sel:[0,1]
v_pk_mov_b32 v[150:151], v[102:103], v[102:103] op_sel:[0,1]
v_pk_mov_b32 v[152:153], v[96:97], v[96:97] op_sel:[0,1]
v_pk_mov_b32 v[154:155], v[98:99], v[98:99] op_sel:[0,1]
v_pk_mov_b32 v[156:157], v[100:101], v[100:101] op_sel:[0,1]
v_pk_mov_b32 v[158:159], v[102:103], v[102:103] op_sel:[0,1]
v_pk_mov_b32 v[160:161], v[96:97], v[96:97] op_sel:[0,1]
v_pk_mov_b32 v[162:163], v[98:99], v[98:99] op_sel:[0,1]
v_pk_mov_b32 v[164:165], v[100:101], v[100:101] op_sel:[0,1]
v_pk_mov_b32 v[166:167], v[102:103], v[102:103] op_sel:[0,1]
s_mul_i32 s17, s22, 144
s_lshl_b32 s3, s23, 2
s_add_u32 s17, s17, s3
s_add_u32 s17, s17, s16
s_add_u32 s49, s17, 792
s_lshl_b32 s49, s49, 7
s_mul_i32 s17, s17, 9216
s_barrier
ds_read_b64_tr_b16 v[80:81], v4 offset:0
ds_read_b64_tr_b16 v[82:83], v4 offset:1024
ds_read_b64_tr_b16 v[84:85], v5 offset:0
ds_read_b64_tr_b16 v[86:87], v5 offset:1024
ds_read_b128 v[8:11], v2 offset:0
ds_read_b128 v[12:15], v2 offset:1024
ds_read_b128 v[16:19], v2 offset:2048
ds_read_b128 v[20:23], v2 offset:3072
ds_read_b128 v[24:27], v2 offset:4096
ds_read_b128 v[28:31], v2 offset:5120
ds_read_b128 v[32:35], v2 offset:6144
ds_read_b128 v[36:39], v2 offset:7168
ds_read_b128 v[40:43], v2 offset:8192
s_mov_b32 s20, 7
Lc_2:
s_waitcnt lgkmcnt(0)
v_mfma_f32_16x16x32_bf16 v[96:99], v[80:83], v[8:11], v[96:99]
ds_read_b64_tr_b16 v[88:89], v4 offset:8192
v_mfma_f32_16x16x32_bf16 v[100:103], v[84:87], v[8:11], v[100:103]
ds_read_b64_tr_b16 v[90:91], v4 offset:9216
v_mfma_f32_16x16x32_bf16 v[104:107], v[80:83], v[12:15], v[104:107]
ds_read_b64_tr_b16 v[92:93], v5 offset:8192
v_mfma_f32_16x16x32_bf16 v[108:111], v[84:87], v[12:15], v[108:111]
ds_read_b64_tr_b16 v[94:95], v5 offset:9216
v_mfma_f32_16x16x32_bf16 v[112:115], v[80:83], v[16:19], v[112:115]
ds_read_b128 v[44:47], v2 offset:9216
v_mfma_f32_16x16x32_bf16 v[116:119], v[84:87], v[16:19], v[116:119]
ds_read_b128 v[48:51], v2 offset:10240
v_mfma_f32_16x16x32_bf16 v[120:123], v[80:83], v[20:23], v[120:123]
ds_read_b128 v[52:55], v2 offset:11264
v_mfma_f32_16x16x32_bf16 v[124:127], v[84:87], v[20:23], v[124:127]
ds_read_b128 v[56:59], v2 offset:12288
v_mfma_f32_16x16x32_bf16 v[128:131], v[80:83], v[24:27], v[128:131]
ds_read_b128 v[60:63], v2 offset:13312
v_mfma_f32_16x16x32_bf16 v[132:135], v[84:87], v[24:27], v[132:135]
ds_read_b128 v[64:67], v2 offset:14336
v_mfma_f32_16x16x32_bf16 v[136:139], v[80:83], v[28:31], v[136:139]
ds_read_b128 v[68:71], v2 offset:15360
v_mfma_f32_16x16x32_bf16 v[140:143], v[84:87], v[28:31], v[140:143]
ds_read_b128 v[72:75], v2 offset:16384
v_mfma_f32_16x16x32_bf16 v[144:147], v[80:83], v[32:35], v[144:147]
ds_read_b128 v[76:79], v2 offset:17408
v_mfma_f32_16x16x32_bf16 v[148:151], v[84:87], v[32:35], v[148:151]
v_mfma_f32_16x16x32_bf16 v[152:155], v[80:83], v[36:39], v[152:155]
v_mfma_f32_16x16x32_bf16 v[156:159], v[84:87], v[36:39], v[156:159]
v_mfma_f32_16x16x32_bf16 v[160:163], v[80:83], v[40:43], v[160:163]
v_mfma_f32_16x16x32_bf16 v[164:167], v[84:87], v[40:43], v[164:167]
s_waitcnt lgkmcnt(0)
s_barrier
v_mfma_f32_16x16x32_bf16 v[96:99], v[88:91], v[44:47], v[96:99]
ds_read_b64_tr_b16 v[80:81], v4 offset:36864
v_mfma_f32_16x16x32_bf16 v[100:103], v[92:95], v[44:47], v[100:103]
ds_read_b64_tr_b16 v[82:83], v4 offset:37888
v_mfma_f32_16x16x32_bf16 v[104:107], v[88:91], v[48:51], v[104:107]
ds_read_b64_tr_b16 v[84:85], v5 offset:36864
v_mfma_f32_16x16x32_bf16 v[108:111], v[92:95], v[48:51], v[108:111]
ds_read_b64_tr_b16 v[86:87], v5 offset:37888
v_mfma_f32_16x16x32_bf16 v[112:115], v[88:91], v[52:55], v[112:115]
ds_read_b128 v[8:11], v2 offset:36864
v_mfma_f32_16x16x32_bf16 v[116:119], v[92:95], v[52:55], v[116:119]
ds_read_b128 v[12:15], v2 offset:37888
v_mfma_f32_16x16x32_bf16 v[120:123], v[88:91], v[56:59], v[120:123]
ds_read_b128 v[16:19], v2 offset:38912
v_mfma_f32_16x16x32_bf16 v[124:127], v[92:95], v[56:59], v[124:127]
ds_read_b128 v[20:23], v2 offset:39936
v_mfma_f32_16x16x32_bf16 v[128:131], v[88:91], v[60:63], v[128:131]
ds_read_b128 v[24:27], v2 offset:40960
v_mfma_f32_16x16x32_bf16 v[132:135], v[92:95], v[60:63], v[132:135]
ds_read_b128 v[28:31], v2 offset:41984
v_mfma_f32_16x16x32_bf16 v[136:139], v[88:91], v[64:67], v[136:139]
ds_read_b128 v[32:35], v2 offset:43008
v_mfma_f32_16x16x32_bf16 v[140:143], v[92:95], v[64:67], v[140:143]
ds_read_b128 v[36:39], v2 offset:44032
v_mfma_f32_16x16x32_bf16 v[144:147], v[88:91], v[68:71], v[144:147]
ds_read_b128 v[40:43], v2 offset:45056
v_mfma_f32_16x16x32_bf16 v[148:151], v[92:95], v[68:71], v[148:151]
v_mfma_f32_16x16x32_bf16 v[152:155], v[88:91], v[72:75], v[152:155]
v_mfma_f32_16x16x32_bf16 v[156:159], v[92:95], v[72:75], v[156:159]
v_mfma_f32_16x16x32_bf16 v[160:163], v[88:91], v[76:79], v[160:163]
v_mfma_f32_16x16x32_bf16 v[164:167], v[92:95], v[76:79], v[164:167]
s_waitcnt lgkmcnt(0)
v_mfma_f32_16x16x32_bf16 v[96:99], v[80:83], v[8:11], v[96:99]
ds_read_b64_tr_b16 v[88:89], v4 offset:45056
v_mfma_f32_16x16x32_bf16 v[100:103], v[84:87], v[8:11], v[100:103]
ds_read_b64_tr_b16 v[90:91], v4 offset:46080
v_mfma_f32_16x16x32_bf16 v[104:107], v[80:83], v[12:15], v[104:107]
ds_read_b64_tr_b16 v[92:93], v5 offset:45056
v_mfma_f32_16x16x32_bf16 v[108:111], v[84:87], v[12:15], v[108:111]
ds_read_b64_tr_b16 v[94:95], v5 offset:46080
v_mfma_f32_16x16x32_bf16 v[112:115], v[80:83], v[16:19], v[112:115]
ds_read_b128 v[44:47], v2 offset:46080
v_mfma_f32_16x16x32_bf16 v[116:119], v[84:87], v[16:19], v[116:119]
ds_read_b128 v[48:51], v2 offset:47104
v_mfma_f32_16x16x32_bf16 v[120:123], v[80:83], v[20:23], v[120:123]
ds_read_b128 v[52:55], v2 offset:48128
v_mfma_f32_16x16x32_bf16 v[124:127], v[84:87], v[20:23], v[124:127]
ds_read_b128 v[56:59], v2 offset:49152
v_mfma_f32_16x16x32_bf16 v[128:131], v[80:83], v[24:27], v[128:131]
ds_read_b128 v[60:63], v2 offset:50176
v_mfma_f32_16x16x32_bf16 v[132:135], v[84:87], v[24:27], v[132:135]
ds_read_b128 v[64:67], v2 offset:51200
v_mfma_f32_16x16x32_bf16 v[136:139], v[80:83], v[28:31], v[136:139]
ds_read_b128 v[68:71], v2 offset:52224
v_mfma_f32_16x16x32_bf16 v[140:143], v[84:87], v[28:31], v[140:143]
ds_read_b128 v[72:75], v2 offset:53248
v_mfma_f32_16x16x32_bf16 v[144:147], v[80:83], v[32:35], v[144:147]
ds_read_b128 v[76:79], v2 offset:54272
v_mfma_f32_16x16x32_bf16 v[148:151], v[84:87], v[32:35], v[148:151]
v_mfma_f32_16x16x32_bf16 v[152:155], v[80:83], v[36:39], v[152:155]
v_mfma_f32_16x16x32_bf16 v[156:159], v[84:87], v[36:39], v[156:159]
v_mfma_f32_16x16x32_bf16 v[160:163], v[80:83], v[40:43], v[160:163]
v_mfma_f32_16x16x32_bf16 v[164:167], v[84:87], v[40:43], v[164:167]
s_waitcnt lgkmcnt(0)
s_barrier
v_mfma_f32_16x16x32_bf16 v[96:99], v[88:91], v[44:47], v[96:99]
ds_read_b64_tr_b16 v[80:81], v6 offset:0
v_mfma_f32_16x16x32_bf16 v[100:103], v[92:95], v[44:47], v[100:103]
ds_read_b64_tr_b16 v[82:83], v6 offset:1024
v_mfma_f32_16x16x32_bf16 v[104:107], v[88:91], v[48:51], v[104:107]
ds_read_b64_tr_b16 v[84:85], v7 offset:0
v_mfma_f32_16x16x32_bf16 v[108:111], v[92:95], v[48:51], v[108:111]
ds_read_b64_tr_b16 v[86:87], v7 offset:1024
v_mfma_f32_16x16x32_bf16 v[112:115], v[88:91], v[52:55], v[112:115]
ds_read_b128 v[8:11], v3 offset:0
v_mfma_f32_16x16x32_bf16 v[116:119], v[92:95], v[52:55], v[116:119]
ds_read_b128 v[12:15], v3 offset:1024
v_mfma_f32_16x16x32_bf16 v[120:123], v[88:91], v[56:59], v[120:123]
ds_read_b128 v[16:19], v3 offset:2048
v_mfma_f32_16x16x32_bf16 v[124:127], v[92:95], v[56:59], v[124:127]
ds_read_b128 v[20:23], v3 offset:3072
v_mfma_f32_16x16x32_bf16 v[128:131], v[88:91], v[60:63], v[128:131]
ds_read_b128 v[24:27], v3 offset:4096
v_mfma_f32_16x16x32_bf16 v[132:135], v[92:95], v[60:63], v[132:135]
ds_read_b128 v[28:31], v3 offset:5120
v_mfma_f32_16x16x32_bf16 v[136:139], v[88:91], v[64:67], v[136:139]
ds_read_b128 v[32:35], v3 offset:6144
v_mfma_f32_16x16x32_bf16 v[140:143], v[92:95], v[64:67], v[140:143]
ds_read_b128 v[36:39], v3 offset:7168
v_mfma_f32_16x16x32_bf16 v[144:147], v[88:91], v[68:71], v[144:147]
ds_read_b128 v[40:43], v3 offset:8192
v_mfma_f32_16x16x32_bf16 v[148:151], v[92:95], v[68:71], v[148:151]
v_mfma_f32_16x16x32_bf16 v[152:155], v[88:91], v[72:75], v[152:155]
v_mfma_f32_16x16x32_bf16 v[156:159], v[92:95], v[72:75], v[156:159]
v_mfma_f32_16x16x32_bf16 v[160:163], v[88:91], v[76:79], v[160:163]
v_mfma_f32_16x16x32_bf16 v[164:167], v[92:95], v[76:79], v[164:167]
s_waitcnt lgkmcnt(0)
v_mfma_f32_16x16x32_bf16 v[96:99], v[80:83], v[8:11], v[96:99]
ds_read_b64_tr_b16 v[88:89], v6 offset:8192
v_mfma_f32_16x16x32_bf16 v[100:103], v[84:87], v[8:11], v[100:103]
ds_read_b64_tr_b16 v[90:91], v6 offset:9216
v_mfma_f32_16x16x32_bf16 v[104:107], v[80:83], v[12:15], v[104:107]
ds_read_b64_tr_b16 v[92:93], v7 offset:8192
v_mfma_f32_16x16x32_bf16 v[108:111], v[84:87], v[12:15], v[108:111]
ds_read_b64_tr_b16 v[94:95], v7 offset:9216
v_mfma_f32_16x16x32_bf16 v[112:115], v[80:83], v[16:19], v[112:115]
ds_read_b128 v[44:47], v3 offset:9216
v_mfma_f32_16x16x32_bf16 v[116:119], v[84:87], v[16:19], v[116:119]
ds_read_b128 v[48:51], v3 offset:10240
v_mfma_f32_16x16x32_bf16 v[120:123], v[80:83], v[20:23], v[120:123]
ds_read_b128 v[52:55], v3 offset:11264
v_mfma_f32_16x16x32_bf16 v[124:127], v[84:87], v[20:23], v[124:127]
ds_read_b128 v[56:59], v3 offset:12288
v_mfma_f32_16x16x32_bf16 v[128:131], v[80:83], v[24:27], v[128:131]
ds_read_b128 v[60:63], v3 offset:13312
v_mfma_f32_16x16x32_bf16 v[132:135], v[84:87], v[24:27], v[132:135]
ds_read_b128 v[64:67], v3 offset:14336
v_mfma_f32_16x16x32_bf16 v[136:139], v[80:83], v[28:31], v[136:139]
ds_read_b128 v[68:71], v3 offset:15360
v_mfma_f32_16x16x32_bf16 v[140:143], v[84:87], v[28:31], v[140:143]
ds_read_b128 v[72:75], v3 offset:16384
v_mfma_f32_16x16x32_bf16 v[144:147], v[80:83], v[32:35], v[144:147]
ds_read_b128 v[76:79], v3 offset:17408
v_mfma_f32_16x16x32_bf16 v[148:151], v[84:87], v[32:35], v[148:151]
v_mfma_f32_16x16x32_bf16 v[152:155], v[80:83], v[36:39], v[152:155]
v_mfma_f32_16x16x32_bf16 v[156:159], v[84:87], v[36:39], v[156:159]
v_mfma_f32_16x16x32_bf16 v[160:163], v[80:83], v[40:43], v[160:163]
v_mfma_f32_16x16x32_bf16 v[164:167], v[84:87], v[40:43], v[164:167]
s_waitcnt lgkmcnt(0)
s_barrier
v_mfma_f32_16x16x32_bf16 v[96:99], v[88:91], v[44:47], v[96:99]
ds_read_b64_tr_b16 v[80:81], v6 offset:36864
v_mfma_f32_16x16x32_bf16 v[100:103], v[92:95], v[44:47], v[100:103]
ds_read_b64_tr_b16 v[82:83], v6 offset:37888
v_mfma_f32_16x16x32_bf16 v[104:107], v[88:91], v[48:51], v[104:107]
ds_read_b64_tr_b16 v[84:85], v7 offset:36864
v_mfma_f32_16x16x32_bf16 v[108:111], v[92:95], v[48:51], v[108:111]
ds_read_b64_tr_b16 v[86:87], v7 offset:37888
v_mfma_f32_16x16x32_bf16 v[112:115], v[88:91], v[52:55], v[112:115]
ds_read_b128 v[8:11], v3 offset:36864
v_mfma_f32_16x16x32_bf16 v[116:119], v[92:95], v[52:55], v[116:119]
ds_read_b128 v[12:15], v3 offset:37888
v_mfma_f32_16x16x32_bf16 v[120:123], v[88:91], v[56:59], v[120:123]
ds_read_b128 v[16:19], v3 offset:38912
v_mfma_f32_16x16x32_bf16 v[124:127], v[92:95], v[56:59], v[124:127]
ds_read_b128 v[20:23], v3 offset:39936
v_mfma_f32_16x16x32_bf16 v[128:131], v[88:91], v[60:63], v[128:131]
ds_read_b128 v[24:27], v3 offset:40960
v_mfma_f32_16x16x32_bf16 v[132:135], v[92:95], v[60:63], v[132:135]
ds_read_b128 v[28:31], v3 offset:41984
v_mfma_f32_16x16x32_bf16 v[136:139], v[88:91], v[64:67], v[136:139]
ds_read_b128 v[32:35], v3 offset:43008
v_mfma_f32_16x16x32_bf16 v[140:143], v[92:95], v[64:67], v[140:143]
ds_read_b128 v[36:39], v3 offset:44032
v_mfma_f32_16x16x32_bf16 v[144:147], v[88:91], v[68:71], v[144:147]
ds_read_b128 v[40:43], v3 offset:45056
v_mfma_f32_16x16x32_bf16 v[148:151], v[92:95], v[68:71], v[148:151]
v_mfma_f32_16x16x32_bf16 v[152:155], v[88:91], v[72:75], v[152:155]
v_mfma_f32_16x16x32_bf16 v[156:159], v[92:95], v[72:75], v[156:159]
v_mfma_f32_16x16x32_bf16 v[160:163], v[88:91], v[76:79], v[160:163]
v_mfma_f32_16x16x32_bf16 v[164:167], v[92:95], v[76:79], v[164:167]
s_waitcnt lgkmcnt(0)
v_mfma_f32_16x16x32_bf16 v[96:99], v[80:83], v[8:11], v[96:99]
ds_read_b64_tr_b16 v[88:89], v6 offset:45056
v_mfma_f32_16x16x32_bf16 v[100:103], v[84:87], v[8:11], v[100:103]
ds_read_b64_tr_b16 v[90:91], v6 offset:46080
v_mfma_f32_16x16x32_bf16 v[104:107], v[80:83], v[12:15], v[104:107]
ds_read_b64_tr_b16 v[92:93], v7 offset:45056
v_mfma_f32_16x16x32_bf16 v[108:111], v[84:87], v[12:15], v[108:111]
ds_read_b64_tr_b16 v[94:95], v7 offset:46080
v_mfma_f32_16x16x32_bf16 v[112:115], v[80:83], v[16:19], v[112:115]
ds_read_b128 v[44:47], v3 offset:46080
v_mfma_f32_16x16x32_bf16 v[116:119], v[84:87], v[16:19], v[116:119]
ds_read_b128 v[48:51], v3 offset:47104
v_mfma_f32_16x16x32_bf16 v[120:123], v[80:83], v[20:23], v[120:123]
ds_read_b128 v[52:55], v3 offset:48128
v_mfma_f32_16x16x32_bf16 v[124:127], v[84:87], v[20:23], v[124:127]
ds_read_b128 v[56:59], v3 offset:49152
v_mfma_f32_16x16x32_bf16 v[128:131], v[80:83], v[24:27], v[128:131]
ds_read_b128 v[60:63], v3 offset:50176
v_mfma_f32_16x16x32_bf16 v[132:135], v[84:87], v[24:27], v[132:135]
ds_read_b128 v[64:67], v3 offset:51200
v_mfma_f32_16x16x32_bf16 v[136:139], v[80:83], v[28:31], v[136:139]
ds_read_b128 v[68:71], v3 offset:52224
v_mfma_f32_16x16x32_bf16 v[140:143], v[84:87], v[28:31], v[140:143]
ds_read_b128 v[72:75], v3 offset:53248
v_mfma_f32_16x16x32_bf16 v[144:147], v[80:83], v[32:35], v[144:147]
ds_read_b128 v[76:79], v3 offset:54272
v_mfma_f32_16x16x32_bf16 v[148:151], v[84:87], v[32:35], v[148:151]
v_mfma_f32_16x16x32_bf16 v[152:155], v[80:83], v[36:39], v[152:155]
v_mfma_f32_16x16x32_bf16 v[156:159], v[84:87], v[36:39], v[156:159]
v_mfma_f32_16x16x32_bf16 v[160:163], v[80:83], v[40:43], v[160:163]
v_mfma_f32_16x16x32_bf16 v[164:167], v[84:87], v[40:43], v[164:167]
s_waitcnt lgkmcnt(0)
s_barrier
v_mfma_f32_16x16x32_bf16 v[96:99], v[88:91], v[44:47], v[96:99]
ds_read_b64_tr_b16 v[80:81], v4 offset:0
v_mfma_f32_16x16x32_bf16 v[100:103], v[92:95], v[44:47], v[100:103]
ds_read_b64_tr_b16 v[82:83], v4 offset:1024
v_mfma_f32_16x16x32_bf16 v[104:107], v[88:91], v[48:51], v[104:107]
ds_read_b64_tr_b16 v[84:85], v5 offset:0
v_mfma_f32_16x16x32_bf16 v[108:111], v[92:95], v[48:51], v[108:111]
ds_read_b64_tr_b16 v[86:87], v5 offset:1024
v_mfma_f32_16x16x32_bf16 v[112:115], v[88:91], v[52:55], v[112:115]
ds_read_b128 v[8:11], v2 offset:0
v_mfma_f32_16x16x32_bf16 v[116:119], v[92:95], v[52:55], v[116:119]
ds_read_b128 v[12:15], v2 offset:1024
v_mfma_f32_16x16x32_bf16 v[120:123], v[88:91], v[56:59], v[120:123]
ds_read_b128 v[16:19], v2 offset:2048
v_mfma_f32_16x16x32_bf16 v[124:127], v[92:95], v[56:59], v[124:127]
ds_read_b128 v[20:23], v2 offset:3072
v_mfma_f32_16x16x32_bf16 v[128:131], v[88:91], v[60:63], v[128:131]
ds_read_b128 v[24:27], v2 offset:4096
v_mfma_f32_16x16x32_bf16 v[132:135], v[92:95], v[60:63], v[132:135]
ds_read_b128 v[28:31], v2 offset:5120
v_mfma_f32_16x16x32_bf16 v[136:139], v[88:91], v[64:67], v[136:139]
ds_read_b128 v[32:35], v2 offset:6144
v_mfma_f32_16x16x32_bf16 v[140:143], v[92:95], v[64:67], v[140:143]
ds_read_b128 v[36:39], v2 offset:7168
v_mfma_f32_16x16x32_bf16 v[144:147], v[88:91], v[68:71], v[144:147]
ds_read_b128 v[40:43], v2 offset:8192
v_mfma_f32_16x16x32_bf16 v[148:151], v[92:95], v[68:71], v[148:151]
v_mfma_f32_16x16x32_bf16 v[152:155], v[88:91], v[72:75], v[152:155]
v_mfma_f32_16x16x32_bf16 v[156:159], v[92:95], v[72:75], v[156:159]
v_mfma_f32_16x16x32_bf16 v[160:163], v[88:91], v[76:79], v[160:163]
v_mfma_f32_16x16x32_bf16 v[164:167], v[92:95], v[76:79], v[164:167]
s_sub_u32 s20, s20, 1
s_cmp_lg_u32 s20, 0
s_cbranch_scc1 Lc_2
s_waitcnt lgkmcnt(0)
v_mfma_f32_16x16x32_bf16 v[96:99], v[80:83], v[8:11], v[96:99]
ds_read_b64_tr_b16 v[88:89], v4 offset:8192
v_mfma_f32_16x16x32_bf16 v[100:103], v[84:87], v[8:11], v[100:103]
ds_read_b64_tr_b16 v[90:91], v4 offset:9216
v_mfma_f32_16x16x32_bf16 v[104:107], v[80:83], v[12:15], v[104:107]
ds_read_b64_tr_b16 v[92:93], v5 offset:8192
v_mfma_f32_16x16x32_bf16 v[108:111], v[84:87], v[12:15], v[108:111]
ds_read_b64_tr_b16 v[94:95], v5 offset:9216
v_mfma_f32_16x16x32_bf16 v[112:115], v[80:83], v[16:19], v[112:115]
ds_read_b128 v[44:47], v2 offset:9216
v_mfma_f32_16x16x32_bf16 v[116:119], v[84:87], v[16:19], v[116:119]
ds_read_b128 v[48:51], v2 offset:10240
v_mfma_f32_16x16x32_bf16 v[120:123], v[80:83], v[20:23], v[120:123]
ds_read_b128 v[52:55], v2 offset:11264
v_mfma_f32_16x16x32_bf16 v[124:127], v[84:87], v[20:23], v[124:127]
ds_read_b128 v[56:59], v2 offset:12288
v_mfma_f32_16x16x32_bf16 v[128:131], v[80:83], v[24:27], v[128:131]
ds_read_b128 v[60:63], v2 offset:13312
v_mfma_f32_16x16x32_bf16 v[132:135], v[84:87], v[24:27], v[132:135]
ds_read_b128 v[64:67], v2 offset:14336
v_mfma_f32_16x16x32_bf16 v[136:139], v[80:83], v[28:31], v[136:139]
ds_read_b128 v[68:71], v2 offset:15360
v_mfma_f32_16x16x32_bf16 v[140:143], v[84:87], v[28:31], v[140:143]
ds_read_b128 v[72:75], v2 offset:16384
v_mfma_f32_16x16x32_bf16 v[144:147], v[80:83], v[32:35], v[144:147]
ds_read_b128 v[76:79], v2 offset:17408
v_mfma_f32_16x16x32_bf16 v[148:151], v[84:87], v[32:35], v[148:151]
v_mfma_f32_16x16x32_bf16 v[152:155], v[80:83], v[36:39], v[152:155]
v_mfma_f32_16x16x32_bf16 v[156:159], v[84:87], v[36:39], v[156:159]
v_mfma_f32_16x16x32_bf16 v[160:163], v[80:83], v[40:43], v[160:163]
v_mfma_f32_16x16x32_bf16 v[164:167], v[84:87], v[40:43], v[164:167]
s_waitcnt lgkmcnt(0)
s_barrier
v_mfma_f32_16x16x32_bf16 v[96:99], v[88:91], v[44:47], v[96:99]
ds_read_b64_tr_b16 v[80:81], v4 offset:36864
v_mfma_f32_16x16x32_bf16 v[100:103], v[92:95], v[44:47], v[100:103]
ds_read_b64_tr_b16 v[82:83], v4 offset:37888
v_mfma_f32_16x16x32_bf16 v[104:107], v[88:91], v[48:51], v[104:107]
ds_read_b64_tr_b16 v[84:85], v5 offset:36864
v_mfma_f32_16x16x32_bf16 v[108:111], v[92:95], v[48:51], v[108:111]
ds_read_b64_tr_b16 v[86:87], v5 offset:37888
v_mfma_f32_16x16x32_bf16 v[112:115], v[88:91], v[52:55], v[112:115]
ds_read_b128 v[8:11], v2 offset:36864
v_mfma_f32_16x16x32_bf16 v[116:119], v[92:95], v[52:55], v[116:119]
ds_read_b128 v[12:15], v2 offset:37888
v_mfma_f32_16x16x32_bf16 v[120:123], v[88:91], v[56:59], v[120:123]
ds_read_b128 v[16:19], v2 offset:38912
v_mfma_f32_16x16x32_bf16 v[124:127], v[92:95], v[56:59], v[124:127]
ds_read_b128 v[20:23], v2 offset:39936
v_mfma_f32_16x16x32_bf16 v[128:131], v[88:91], v[60:63], v[128:131]
ds_read_b128 v[24:27], v2 offset:40960
v_mfma_f32_16x16x32_bf16 v[132:135], v[92:95], v[60:63], v[132:135]
ds_read_b128 v[28:31], v2 offset:41984
v_mfma_f32_16x16x32_bf16 v[136:139], v[88:91], v[64:67], v[136:139]
ds_read_b128 v[32:35], v2 offset:43008
v_mfma_f32_16x16x32_bf16 v[140:143], v[92:95], v[64:67], v[140:143]
ds_read_b128 v[36:39], v2 offset:44032
v_mfma_f32_16x16x32_bf16 v[144:147], v[88:91], v[68:71], v[144:147]
ds_read_b128 v[40:43], v2 offset:45056
v_mfma_f32_16x16x32_bf16 v[148:151], v[92:95], v[68:71], v[148:151]
v_mfma_f32_16x16x32_bf16 v[152:155], v[88:91], v[72:75], v[152:155]
v_mfma_f32_16x16x32_bf16 v[156:159], v[92:95], v[72:75], v[156:159]
v_mfma_f32_16x16x32_bf16 v[160:163], v[88:91], v[76:79], v[160:163]
v_mfma_f32_16x16x32_bf16 v[164:167], v[92:95], v[76:79], v[164:167]
s_waitcnt lgkmcnt(0)
v_mfma_f32_16x16x32_bf16 v[96:99], v[80:83], v[8:11], v[96:99]
ds_read_b64_tr_b16 v[88:89], v4 offset:45056
v_mfma_f32_16x16x32_bf16 v[100:103], v[84:87], v[8:11], v[100:103]
ds_read_b64_tr_b16 v[90:91], v4 offset:46080
v_mfma_f32_16x16x32_bf16 v[104:107], v[80:83], v[12:15], v[104:107]
ds_read_b64_tr_b16 v[92:93], v5 offset:45056
v_mfma_f32_16x16x32_bf16 v[108:111], v[84:87], v[12:15], v[108:111]
ds_read_b64_tr_b16 v[94:95], v5 offset:46080
v_mfma_f32_16x16x32_bf16 v[112:115], v[80:83], v[16:19], v[112:115]
ds_read_b128 v[44:47], v2 offset:46080
v_mfma_f32_16x16x32_bf16 v[116:119], v[84:87], v[16:19], v[116:119]
ds_read_b128 v[48:51], v2 offset:47104
v_mfma_f32_16x16x32_bf16 v[120:123], v[80:83], v[20:23], v[120:123]
ds_read_b128 v[52:55], v2 offset:48128
v_mfma_f32_16x16x32_bf16 v[124:127], v[84:87], v[20:23], v[124:127]
ds_read_b128 v[56:59], v2 offset:49152
v_mfma_f32_16x16x32_bf16 v[128:131], v[80:83], v[24:27], v[128:131]
ds_read_b128 v[60:63], v2 offset:50176
v_mfma_f32_16x16x32_bf16 v[132:135], v[84:87], v[24:27], v[132:135]
ds_read_b128 v[64:67], v2 offset:51200
v_mfma_f32_16x16x32_bf16 v[136:139], v[80:83], v[28:31], v[136:139]
ds_read_b128 v[68:71], v2 offset:52224
v_mfma_f32_16x16x32_bf16 v[140:143], v[84:87], v[28:31], v[140:143]
ds_read_b128 v[72:75], v2 offset:53248
v_mfma_f32_16x16x32_bf16 v[144:147], v[80:83], v[32:35], v[144:147]
ds_read_b128 v[76:79], v2 offset:54272
v_mfma_f32_16x16x32_bf16 v[148:151], v[84:87], v[32:35], v[148:151]
v_mfma_f32_16x16x32_bf16 v[152:155], v[80:83], v[36:39], v[152:155]
v_mfma_f32_16x16x32_bf16 v[156:159], v[84:87], v[36:39], v[156:159]
v_mfma_f32_16x16x32_bf16 v[160:163], v[80:83], v[40:43], v[160:163]
v_mfma_f32_16x16x32_bf16 v[164:167], v[84:87], v[40:43], v[164:167]
s_waitcnt lgkmcnt(0)
s_barrier
v_mfma_f32_16x16x32_bf16 v[96:99], v[88:91], v[44:47], v[96:99]
ds_read_b64_tr_b16 v[80:81], v6 offset:0
v_mfma_f32_16x16x32_bf16 v[100:103], v[92:95], v[44:47], v[100:103]
ds_read_b64_tr_b16 v[82:83], v6 offset:1024
v_mfma_f32_16x16x32_bf16 v[104:107], v[88:91], v[48:51], v[104:107]
ds_read_b64_tr_b16 v[84:85], v7 offset:0
v_mfma_f32_16x16x32_bf16 v[108:111], v[92:95], v[48:51], v[108:111]
ds_read_b64_tr_b16 v[86:87], v7 offset:1024
v_mfma_f32_16x16x32_bf16 v[112:115], v[88:91], v[52:55], v[112:115]
ds_read_b128 v[8:11], v3 offset:0
v_mfma_f32_16x16x32_bf16 v[116:119], v[92:95], v[52:55], v[116:119]
ds_read_b128 v[12:15], v3 offset:1024
v_mfma_f32_16x16x32_bf16 v[120:123], v[88:91], v[56:59], v[120:123]
ds_read_b128 v[16:19], v3 offset:2048
v_mfma_f32_16x16x32_bf16 v[124:127], v[92:95], v[56:59], v[124:127]
ds_read_b128 v[20:23], v3 offset:3072
v_mfma_f32_16x16x32_bf16 v[128:131], v[88:91], v[60:63], v[128:131]
ds_read_b128 v[24:27], v3 offset:4096
v_mfma_f32_16x16x32_bf16 v[132:135], v[92:95], v[60:63], v[132:135]
ds_read_b128 v[28:31], v3 offset:5120
v_mfma_f32_16x16x32_bf16 v[136:139], v[88:91], v[64:67], v[136:139]
ds_read_b128 v[32:35], v3 offset:6144
v_mfma_f32_16x16x32_bf16 v[140:143], v[92:95], v[64:67], v[140:143]
ds_read_b128 v[36:39], v3 offset:7168
v_mfma_f32_16x16x32_bf16 v[144:147], v[88:91], v[68:71], v[144:147]
ds_read_b128 v[40:43], v3 offset:8192
v_mfma_f32_16x16x32_bf16 v[148:151], v[92:95], v[68:71], v[148:151]
v_mfma_f32_16x16x32_bf16 v[152:155], v[88:91], v[72:75], v[152:155]
v_mfma_f32_16x16x32_bf16 v[156:159], v[92:95], v[72:75], v[156:159]
v_mfma_f32_16x16x32_bf16 v[160:163], v[88:91], v[76:79], v[160:163]
v_mfma_f32_16x16x32_bf16 v[164:167], v[92:95], v[76:79], v[164:167]
s_waitcnt lgkmcnt(0)
v_mfma_f32_16x16x32_bf16 v[96:99], v[80:83], v[8:11], v[96:99]
ds_read_b64_tr_b16 v[88:89], v6 offset:8192
v_mfma_f32_16x16x32_bf16 v[100:103], v[84:87], v[8:11], v[100:103]
ds_read_b64_tr_b16 v[90:91], v6 offset:9216
v_mfma_f32_16x16x32_bf16 v[104:107], v[80:83], v[12:15], v[104:107]
ds_read_b64_tr_b16 v[92:93], v7 offset:8192
v_mfma_f32_16x16x32_bf16 v[108:111], v[84:87], v[12:15], v[108:111]
ds_read_b64_tr_b16 v[94:95], v7 offset:9216
v_mfma_f32_16x16x32_bf16 v[112:115], v[80:83], v[16:19], v[112:115]
ds_read_b128 v[44:47], v3 offset:9216
v_mfma_f32_16x16x32_bf16 v[116:119], v[84:87], v[16:19], v[116:119]
ds_read_b128 v[48:51], v3 offset:10240
v_mfma_f32_16x16x32_bf16 v[120:123], v[80:83], v[20:23], v[120:123]
ds_read_b128 v[52:55], v3 offset:11264
v_mfma_f32_16x16x32_bf16 v[124:127], v[84:87], v[20:23], v[124:127]
ds_read_b128 v[56:59], v3 offset:12288
v_mfma_f32_16x16x32_bf16 v[128:131], v[80:83], v[24:27], v[128:131]
ds_read_b128 v[60:63], v3 offset:13312
v_mfma_f32_16x16x32_bf16 v[132:135], v[84:87], v[24:27], v[132:135]
ds_read_b128 v[64:67], v3 offset:14336
v_mfma_f32_16x16x32_bf16 v[136:139], v[80:83], v[28:31], v[136:139]
ds_read_b128 v[68:71], v3 offset:15360
v_mfma_f32_16x16x32_bf16 v[140:143], v[84:87], v[28:31], v[140:143]
ds_read_b128 v[72:75], v3 offset:16384
v_mfma_f32_16x16x32_bf16 v[144:147], v[80:83], v[32:35], v[144:147]
ds_read_b128 v[76:79], v3 offset:17408
v_mfma_f32_16x16x32_bf16 v[148:151], v[84:87], v[32:35], v[148:151]
v_mfma_f32_16x16x32_bf16 v[152:155], v[80:83], v[36:39], v[152:155]
v_mfma_f32_16x16x32_bf16 v[156:159], v[84:87], v[36:39], v[156:159]
v_mfma_f32_16x16x32_bf16 v[160:163], v[80:83], v[40:43], v[160:163]
v_mfma_f32_16x16x32_bf16 v[164:167], v[84:87], v[40:43], v[164:167]
s_waitcnt lgkmcnt(0)
s_barrier
v_mfma_f32_16x16x32_bf16 v[96:99], v[88:91], v[44:47], v[96:99]
ds_read_b64_tr_b16 v[80:81], v6 offset:36864
v_mfma_f32_16x16x32_bf16 v[100:103], v[92:95], v[44:47], v[100:103]
ds_read_b64_tr_b16 v[82:83], v6 offset:37888
v_mfma_f32_16x16x32_bf16 v[104:107], v[88:91], v[48:51], v[104:107]
ds_read_b64_tr_b16 v[84:85], v7 offset:36864
v_mfma_f32_16x16x32_bf16 v[108:111], v[92:95], v[48:51], v[108:111]
ds_read_b64_tr_b16 v[86:87], v7 offset:37888
v_mfma_f32_16x16x32_bf16 v[112:115], v[88:91], v[52:55], v[112:115]
ds_read_b128 v[8:11], v3 offset:36864
v_mfma_f32_16x16x32_bf16 v[116:119], v[92:95], v[52:55], v[116:119]
ds_read_b128 v[12:15], v3 offset:37888
v_mfma_f32_16x16x32_bf16 v[120:123], v[88:91], v[56:59], v[120:123]
ds_read_b128 v[16:19], v3 offset:38912
v_mfma_f32_16x16x32_bf16 v[124:127], v[92:95], v[56:59], v[124:127]
ds_read_b128 v[20:23], v3 offset:39936
v_mfma_f32_16x16x32_bf16 v[128:131], v[88:91], v[60:63], v[128:131]
ds_read_b128 v[24:27], v3 offset:40960
v_mfma_f32_16x16x32_bf16 v[132:135], v[92:95], v[60:63], v[132:135]
ds_read_b128 v[28:31], v3 offset:41984
v_mfma_f32_16x16x32_bf16 v[136:139], v[88:91], v[64:67], v[136:139]
ds_read_b128 v[32:35], v3 offset:43008
v_mfma_f32_16x16x32_bf16 v[140:143], v[92:95], v[64:67], v[140:143]
ds_read_b128 v[36:39], v3 offset:44032
v_mfma_f32_16x16x32_bf16 v[144:147], v[88:91], v[68:71], v[144:147]
ds_read_b128 v[40:43], v3 offset:45056
v_mfma_f32_16x16x32_bf16 v[148:151], v[92:95], v[68:71], v[148:151]
v_mfma_f32_16x16x32_bf16 v[152:155], v[88:91], v[72:75], v[152:155]
v_mfma_f32_16x16x32_bf16 v[156:159], v[92:95], v[72:75], v[156:159]
v_mfma_f32_16x16x32_bf16 v[160:163], v[88:91], v[76:79], v[160:163]
v_mfma_f32_16x16x32_bf16 v[164:167], v[92:95], v[76:79], v[164:167]
s_waitcnt lgkmcnt(0)
v_mfma_f32_16x16x32_bf16 v[96:99], v[80:83], v[8:11], v[96:99]
ds_read_b64_tr_b16 v[88:89], v6 offset:45056
v_mfma_f32_16x16x32_bf16 v[100:103], v[84:87], v[8:11], v[100:103]
ds_read_b64_tr_b16 v[90:91], v6 offset:46080
v_mfma_f32_16x16x32_bf16 v[104:107], v[80:83], v[12:15], v[104:107]
ds_read_b64_tr_b16 v[92:93], v7 offset:45056
v_mfma_f32_16x16x32_bf16 v[108:111], v[84:87], v[12:15], v[108:111]
ds_read_b64_tr_b16 v[94:95], v7 offset:46080
v_mfma_f32_16x16x32_bf16 v[112:115], v[80:83], v[16:19], v[112:115]
ds_read_b128 v[44:47], v3 offset:46080
v_mfma_f32_16x16x32_bf16 v[116:119], v[84:87], v[16:19], v[116:119]
ds_read_b128 v[48:51], v3 offset:47104
v_mfma_f32_16x16x32_bf16 v[120:123], v[80:83], v[20:23], v[120:123]
ds_read_b128 v[52:55], v3 offset:48128
v_mfma_f32_16x16x32_bf16 v[124:127], v[84:87], v[20:23], v[124:127]
ds_read_b128 v[56:59], v3 offset:49152
v_mfma_f32_16x16x32_bf16 v[128:131], v[80:83], v[24:27], v[128:131]
ds_read_b128 v[60:63], v3 offset:50176
v_mfma_f32_16x16x32_bf16 v[132:135], v[84:87], v[24:27], v[132:135]
ds_read_b128 v[64:67], v3 offset:51200
v_mfma_f32_16x16x32_bf16 v[136:139], v[80:83], v[28:31], v[136:139]
ds_read_b128 v[68:71], v3 offset:52224
v_mfma_f32_16x16x32_bf16 v[140:143], v[84:87], v[28:31], v[140:143]
ds_read_b128 v[72:75], v3 offset:53248
v_mfma_f32_16x16x32_bf16 v[144:147], v[80:83], v[32:35], v[144:147]
ds_read_b128 v[76:79], v3 offset:54272
v_mfma_f32_16x16x32_bf16 v[148:151], v[84:87], v[32:35], v[148:151]
v_mfma_f32_16x16x32_bf16 v[152:155], v[80:83], v[36:39], v[152:155]
v_mfma_f32_16x16x32_bf16 v[156:159], v[84:87], v[36:39], v[156:159]
v_mfma_f32_16x16x32_bf16 v[160:163], v[80:83], v[40:43], v[160:163]
v_mfma_f32_16x16x32_bf16 v[164:167], v[84:87], v[40:43], v[164:167]
s_waitcnt lgkmcnt(0)
v_mfma_f32_16x16x32_bf16 v[96:99], v[88:91], v[44:47], v[96:99]
v_mfma_f32_16x16x32_bf16 v[100:103], v[92:95], v[44:47], v[100:103]
v_mfma_f32_16x16x32_bf16 v[104:107], v[88:91], v[48:51], v[104:107]
v_mfma_f32_16x16x32_bf16 v[108:111], v[92:95], v[48:51], v[108:111]
v_mfma_f32_16x16x32_bf16 v[112:115], v[88:91], v[52:55], v[112:115]
v_mfma_f32_16x16x32_bf16 v[116:119], v[92:95], v[52:55], v[116:119]
v_mfma_f32_16x16x32_bf16 v[120:123], v[88:91], v[56:59], v[120:123]
v_mfma_f32_16x16x32_bf16 v[124:127], v[92:95], v[56:59], v[124:127]
v_mfma_f32_16x16x32_bf16 v[128:131], v[88:91], v[60:63], v[128:131]
v_mfma_f32_16x16x32_bf16 v[132:135], v[92:95], v[60:63], v[132:135]
v_mfma_f32_16x16x32_bf16 v[136:139], v[88:91], v[64:67], v[136:139]
v_mfma_f32_16x16x32_bf16 v[140:143], v[92:95], v[64:67], v[140:143]
v_mfma_f32_16x16x32_bf16 v[144:147], v[88:91], v[68:71], v[144:147]
v_mfma_f32_16x16x32_bf16 v[148:151], v[92:95], v[68:71], v[148:151]
v_mfma_f32_16x16x32_bf16 v[152:155], v[88:91], v[72:75], v[152:155]
v_mfma_f32_16x16x32_bf16 v[156:159], v[92:95], v[72:75], v[156:159]
v_mfma_f32_16x16x32_bf16 v[160:163], v[88:91], v[76:79], v[160:163]
v_mfma_f32_16x16x32_bf16 v[164:167], v[92:95], v[76:79], v[164:167]
s_barrier
s_mov_b32 s52, 3184710632
s_mov_b32 s53, 3184710632
v_mov_b32 v8, 3222493025
v_mov_b32 v9, 3222493025
s_lshr_b32 s3, s16, 1
s_mul_i32 s3, s3, 18432
s_mul_i32 s18, s16, 9216
s_add_u32 s3, s3, s18
v_add_u32 v10, s3, v2
s_mov_b32 s52, 1084043516
s_mov_b32 s53, 1084043516
s_mov_b32 s54, 1055913304
s_mov_b32 s55, 1055913304
v_pk_fma_f32 v[16:17], v[96:97], v[96:97], s[52:53]
v_pk_fma_f32 v[18:19], v[98:99], v[98:99], s[52:53]
v_pk_fma_f32 v[20:21], v[100:101], v[100:101], s[52:53]
v_pk_fma_f32 v[22:23], v[102:103], v[102:103], s[52:53]
v_pk_mul_f32 v[16:17], v[16:17], v[96:97] neg_lo:[1,0] neg_hi:[1,0]
v_pk_mul_f32 v[18:19], v[18:19], v[98:99] neg_lo:[1,0] neg_hi:[1,0]
v_pk_mul_f32 v[20:21], v[20:21], v[100:101] neg_lo:[1,0] neg_hi:[1,0]
v_pk_mul_f32 v[22:23], v[22:23], v[102:103] neg_lo:[1,0] neg_hi:[1,0]
v_exp_f32 v16, v16
v_exp_f32 v17, v17
v_exp_f32 v18, v18
v_exp_f32 v19, v19
v_exp_f32 v20, v20
v_exp_f32 v21, v21
v_exp_f32 v22, v22
v_exp_f32 v23, v23
v_pk_fma_f32 v[16:17], v[16:17], s[54:55], s[54:55]
v_pk_fma_f32 v[18:19], v[18:19], s[54:55], s[54:55]
v_pk_fma_f32 v[20:21], v[20:21], s[54:55], s[54:55]
v_pk_fma_f32 v[22:23], v[22:23], s[54:55], s[54:55]
v_rcp_f32 v16, v16
v_pk_fma_f32 v[24:25], v[104:105], v[104:105], s[52:53]
v_rcp_f32 v17, v17
v_pk_fma_f32 v[26:27], v[106:107], v[106:107], s[52:53]
v_rcp_f32 v18, v18
v_pk_fma_f32 v[28:29], v[108:109], v[108:109], s[52:53]
v_rcp_f32 v19, v19
v_pk_fma_f32 v[30:31], v[110:111], v[110:111], s[52:53]
v_rcp_f32 v20, v20
v_pk_mul_f32 v[24:25], v[24:25], v[104:105] neg_lo:[1,0] neg_hi:[1,0]
v_rcp_f32 v21, v21
v_pk_mul_f32 v[26:27], v[26:27], v[106:107] neg_lo:[1,0] neg_hi:[1,0]
v_rcp_f32 v22, v22
v_pk_mul_f32 v[28:29], v[28:29], v[108:109] neg_lo:[1,0] neg_hi:[1,0]
v_rcp_f32 v23, v23
v_pk_mul_f32 v[30:31], v[30:31], v[110:111] neg_lo:[1,0] neg_hi:[1,0]
v_exp_f32 v24, v24
v_pk_mul_f32 v[16:17], v[16:17], v[96:97]
v_exp_f32 v25, v25
v_pk_mul_f32 v[18:19], v[18:19], v[98:99]
v_exp_f32 v26, v26
v_pk_mul_f32 v[20:21], v[20:21], v[100:101]
v_exp_f32 v27, v27
v_pk_mul_f32 v[22:23], v[22:23], v[102:103]
v_exp_f32 v28, v28
v_cvt_pk_bf16_f32 v44, v16, v17
v_exp_f32 v29, v29
v_cvt_pk_bf16_f32 v45, v18, v19
v_exp_f32 v30, v30
v_cvt_pk_bf16_f32 v46, v20, v21
v_exp_f32 v31, v31
v_cvt_pk_bf16_f32 v47, v22, v23
buffer_store_dwordx4 v[44:47], v2, s[36:39], s17 offen offset:0 sc1
ds_write_b128 v10, v[44:47] offset:0
v_pk_fma_f32 v[24:25], v[24:25], s[54:55], s[54:55]
v_pk_fma_f32 v[26:27], v[26:27], s[54:55], s[54:55]
v_pk_fma_f32 v[28:29], v[28:29], s[54:55], s[54:55]
v_pk_fma_f32 v[30:31], v[30:31], s[54:55], s[54:55]
v_rcp_f32 v24, v24
v_pk_fma_f32 v[32:33], v[112:113], v[112:113], s[52:53]
v_rcp_f32 v25, v25
v_pk_fma_f32 v[34:35], v[114:115], v[114:115], s[52:53]
v_rcp_f32 v26, v26
v_pk_fma_f32 v[36:37], v[116:117], v[116:117], s[52:53]
v_rcp_f32 v27, v27
v_pk_fma_f32 v[38:39], v[118:119], v[118:119], s[52:53]
v_rcp_f32 v28, v28
v_pk_mul_f32 v[32:33], v[32:33], v[112:113] neg_lo:[1,0] neg_hi:[1,0]
v_rcp_f32 v29, v29
v_pk_mul_f32 v[34:35], v[34:35], v[114:115] neg_lo:[1,0] neg_hi:[1,0]
v_rcp_f32 v30, v30
v_pk_mul_f32 v[36:37], v[36:37], v[116:117] neg_lo:[1,0] neg_hi:[1,0]
v_rcp_f32 v31, v31
v_pk_mul_f32 v[38:39], v[38:39], v[118:119] neg_lo:[1,0] neg_hi:[1,0]
v_exp_f32 v32, v32
v_pk_mul_f32 v[24:25], v[24:25], v[104:105]
v_exp_f32 v33, v33
v_pk_mul_f32 v[26:27], v[26:27], v[106:107]
v_exp_f32 v34, v34
v_pk_mul_f32 v[28:29], v[28:29], v[108:109]
v_exp_f32 v35, v35
v_pk_mul_f32 v[30:31], v[30:31], v[110:111]
v_exp_f32 v36, v36
v_cvt_pk_bf16_f32 v48, v24, v25
v_exp_f32 v37, v37
v_cvt_pk_bf16_f32 v49, v26, v27
v_exp_f32 v38, v38
v_cvt_pk_bf16_f32 v50, v28, v29
v_exp_f32 v39, v39
v_cvt_pk_bf16_f32 v51, v30, v31
buffer_store_dwordx4 v[48:51], v2, s[36:39], s17 offen offset:1024 sc1
ds_write_b128 v10, v[48:51] offset:1024
v_pk_fma_f32 v[32:33], v[32:33], s[54:55], s[54:55]
v_pk_fma_f32 v[34:35], v[34:35], s[54:55], s[54:55]
v_pk_fma_f32 v[36:37], v[36:37], s[54:55], s[54:55]
v_pk_fma_f32 v[38:39], v[38:39], s[54:55], s[54:55]
v_rcp_f32 v32, v32
v_pk_fma_f32 v[16:17], v[120:121], v[120:121], s[52:53]
v_rcp_f32 v33, v33
v_pk_fma_f32 v[18:19], v[122:123], v[122:123], s[52:53]
v_rcp_f32 v34, v34
v_pk_fma_f32 v[20:21], v[124:125], v[124:125], s[52:53]
v_rcp_f32 v35, v35
v_pk_fma_f32 v[22:23], v[126:127], v[126:127], s[52:53]
v_rcp_f32 v36, v36
v_pk_mul_f32 v[16:17], v[16:17], v[120:121] neg_lo:[1,0] neg_hi:[1,0]
v_rcp_f32 v37, v37
v_pk_mul_f32 v[18:19], v[18:19], v[122:123] neg_lo:[1,0] neg_hi:[1,0]
v_rcp_f32 v38, v38
v_pk_mul_f32 v[20:21], v[20:21], v[124:125] neg_lo:[1,0] neg_hi:[1,0]
v_rcp_f32 v39, v39
v_pk_mul_f32 v[22:23], v[22:23], v[126:127] neg_lo:[1,0] neg_hi:[1,0]
v_exp_f32 v16, v16
v_pk_mul_f32 v[32:33], v[32:33], v[112:113]
v_exp_f32 v17, v17
v_pk_mul_f32 v[34:35], v[34:35], v[114:115]
v_exp_f32 v18, v18
v_pk_mul_f32 v[36:37], v[36:37], v[116:117]
v_exp_f32 v19, v19
v_pk_mul_f32 v[38:39], v[38:39], v[118:119]
v_exp_f32 v20, v20
v_cvt_pk_bf16_f32 v52, v32, v33
v_exp_f32 v21, v21
v_cvt_pk_bf16_f32 v53, v34, v35
v_exp_f32 v22, v22
v_cvt_pk_bf16_f32 v54, v36, v37
v_exp_f32 v23, v23
v_cvt_pk_bf16_f32 v55, v38, v39
buffer_store_dwordx4 v[52:55], v2, s[36:39], s17 offen offset:2048 sc1
ds_write_b128 v10, v[52:55] offset:2048
v_pk_fma_f32 v[16:17], v[16:17], s[54:55], s[54:55]
v_pk_fma_f32 v[18:19], v[18:19], s[54:55], s[54:55]
v_pk_fma_f32 v[20:21], v[20:21], s[54:55], s[54:55]
v_pk_fma_f32 v[22:23], v[22:23], s[54:55], s[54:55]
v_rcp_f32 v16, v16
v_pk_fma_f32 v[24:25], v[128:129], v[128:129], s[52:53]
v_rcp_f32 v17, v17
v_pk_fma_f32 v[26:27], v[130:131], v[130:131], s[52:53]
v_rcp_f32 v18, v18
v_pk_fma_f32 v[28:29], v[132:133], v[132:133], s[52:53]
v_rcp_f32 v19, v19
v_pk_fma_f32 v[30:31], v[134:135], v[134:135], s[52:53]
v_rcp_f32 v20, v20
v_pk_mul_f32 v[24:25], v[24:25], v[128:129] neg_lo:[1,0] neg_hi:[1,0]
v_rcp_f32 v21, v21
v_pk_mul_f32 v[26:27], v[26:27], v[130:131] neg_lo:[1,0] neg_hi:[1,0]
v_rcp_f32 v22, v22
v_pk_mul_f32 v[28:29], v[28:29], v[132:133] neg_lo:[1,0] neg_hi:[1,0]
v_rcp_f32 v23, v23
v_pk_mul_f32 v[30:31], v[30:31], v[134:135] neg_lo:[1,0] neg_hi:[1,0]
v_exp_f32 v24, v24
v_pk_mul_f32 v[16:17], v[16:17], v[120:121]
v_exp_f32 v25, v25
v_pk_mul_f32 v[18:19], v[18:19], v[122:123]
v_exp_f32 v26, v26
v_pk_mul_f32 v[20:21], v[20:21], v[124:125]
v_exp_f32 v27, v27
v_pk_mul_f32 v[22:23], v[22:23], v[126:127]
v_exp_f32 v28, v28
v_cvt_pk_bf16_f32 v56, v16, v17
v_exp_f32 v29, v29
v_cvt_pk_bf16_f32 v57, v18, v19
v_exp_f32 v30, v30
v_cvt_pk_bf16_f32 v58, v20, v21
v_exp_f32 v31, v31
v_cvt_pk_bf16_f32 v59, v22, v23
buffer_store_dwordx4 v[56:59], v2, s[36:39], s17 offen offset:3072 sc1
ds_write_b128 v10, v[56:59] offset:3072
v_pk_fma_f32 v[24:25], v[24:25], s[54:55], s[54:55]
v_pk_fma_f32 v[26:27], v[26:27], s[54:55], s[54:55]
v_pk_fma_f32 v[28:29], v[28:29], s[54:55], s[54:55]
v_pk_fma_f32 v[30:31], v[30:31], s[54:55], s[54:55]
v_rcp_f32 v24, v24
v_pk_fma_f32 v[32:33], v[136:137], v[136:137], s[52:53]
v_rcp_f32 v25, v25
v_pk_fma_f32 v[34:35], v[138:139], v[138:139], s[52:53]
v_rcp_f32 v26, v26
v_pk_fma_f32 v[36:37], v[140:141], v[140:141], s[52:53]
v_rcp_f32 v27, v27
v_pk_fma_f32 v[38:39], v[142:143], v[142:143], s[52:53]
v_rcp_f32 v28, v28
v_pk_mul_f32 v[32:33], v[32:33], v[136:137] neg_lo:[1,0] neg_hi:[1,0]
v_rcp_f32 v29, v29
v_pk_mul_f32 v[34:35], v[34:35], v[138:139] neg_lo:[1,0] neg_hi:[1,0]
v_rcp_f32 v30, v30
v_pk_mul_f32 v[36:37], v[36:37], v[140:141] neg_lo:[1,0] neg_hi:[1,0]
v_rcp_f32 v31, v31
v_pk_mul_f32 v[38:39], v[38:39], v[142:143] neg_lo:[1,0] neg_hi:[1,0]
v_exp_f32 v32, v32
v_pk_mul_f32 v[24:25], v[24:25], v[128:129]
v_exp_f32 v33, v33
v_pk_mul_f32 v[26:27], v[26:27], v[130:131]
v_exp_f32 v34, v34
v_pk_mul_f32 v[28:29], v[28:29], v[132:133]
v_exp_f32 v35, v35
v_pk_mul_f32 v[30:31], v[30:31], v[134:135]
v_exp_f32 v36, v36
v_cvt_pk_bf16_f32 v60, v24, v25
v_exp_f32 v37, v37
v_cvt_pk_bf16_f32 v61, v26, v27
v_exp_f32 v38, v38
v_cvt_pk_bf16_f32 v62, v28, v29
v_exp_f32 v39, v39
v_cvt_pk_bf16_f32 v63, v30, v31
s_add_u32 s17, s17, 4096
buffer_store_dwordx4 v[60:63], v2, s[36:39], s17 offen offset:0 sc1
ds_write_b128 v10, v[60:63] offset:4096
v_pk_fma_f32 v[32:33], v[32:33], s[54:55], s[54:55]
v_pk_fma_f32 v[34:35], v[34:35], s[54:55], s[54:55]
v_pk_fma_f32 v[36:37], v[36:37], s[54:55], s[54:55]
v_pk_fma_f32 v[38:39], v[38:39], s[54:55], s[54:55]
v_rcp_f32 v32, v32
v_pk_fma_f32 v[16:17], v[144:145], v[144:145], s[52:53]
v_rcp_f32 v33, v33
v_pk_fma_f32 v[18:19], v[146:147], v[146:147], s[52:53]
v_rcp_f32 v34, v34
v_pk_fma_f32 v[20:21], v[148:149], v[148:149], s[52:53]
v_rcp_f32 v35, v35
v_pk_fma_f32 v[22:23], v[150:151], v[150:151], s[52:53]
v_rcp_f32 v36, v36
v_pk_mul_f32 v[16:17], v[16:17], v[144:145] neg_lo:[1,0] neg_hi:[1,0]
v_rcp_f32 v37, v37
v_pk_mul_f32 v[18:19], v[18:19], v[146:147] neg_lo:[1,0] neg_hi:[1,0]
v_rcp_f32 v38, v38
v_pk_mul_f32 v[20:21], v[20:21], v[148:149] neg_lo:[1,0] neg_hi:[1,0]
v_rcp_f32 v39, v39
v_pk_mul_f32 v[22:23], v[22:23], v[150:151] neg_lo:[1,0] neg_hi:[1,0]
v_exp_f32 v16, v16
v_pk_mul_f32 v[32:33], v[32:33], v[136:137]
v_exp_f32 v17, v17
v_pk_mul_f32 v[34:35], v[34:35], v[138:139]
v_exp_f32 v18, v18
v_pk_mul_f32 v[36:37], v[36:37], v[140:141]
v_exp_f32 v19, v19
v_pk_mul_f32 v[38:39], v[38:39], v[142:143]
v_exp_f32 v20, v20
v_cvt_pk_bf16_f32 v64, v32, v33
v_exp_f32 v21, v21
v_cvt_pk_bf16_f32 v65, v34, v35
v_exp_f32 v22, v22
v_cvt_pk_bf16_f32 v66, v36, v37
v_exp_f32 v23, v23
v_cvt_pk_bf16_f32 v67, v38, v39
buffer_store_dwordx4 v[64:67], v2, s[36:39], s17 offen offset:1024 sc1
ds_write_b128 v10, v[64:67] offset:5120
v_pk_fma_f32 v[16:17], v[16:17], s[54:55], s[54:55]
v_pk_fma_f32 v[18:19], v[18:19], s[54:55], s[54:55]
v_pk_fma_f32 v[20:21], v[20:21], s[54:55], s[54:55]
v_pk_fma_f32 v[22:23], v[22:23], s[54:55], s[54:55]
v_rcp_f32 v16, v16
v_pk_fma_f32 v[24:25], v[152:153], v[152:153], s[52:53]
v_rcp_f32 v17, v17
v_pk_fma_f32 v[26:27], v[154:155], v[154:155], s[52:53]
v_rcp_f32 v18, v18
v_pk_fma_f32 v[28:29], v[156:157], v[156:157], s[52:53]
v_rcp_f32 v19, v19
v_pk_fma_f32 v[30:31], v[158:159], v[158:159], s[52:53]
v_rcp_f32 v20, v20
v_pk_mul_f32 v[24:25], v[24:25], v[152:153] neg_lo:[1,0] neg_hi:[1,0]
v_rcp_f32 v21, v21
v_pk_mul_f32 v[26:27], v[26:27], v[154:155] neg_lo:[1,0] neg_hi:[1,0]
v_rcp_f32 v22, v22
v_pk_mul_f32 v[28:29], v[28:29], v[156:157] neg_lo:[1,0] neg_hi:[1,0]
v_rcp_f32 v23, v23
v_pk_mul_f32 v[30:31], v[30:31], v[158:159] neg_lo:[1,0] neg_hi:[1,0]
v_exp_f32 v24, v24
v_pk_mul_f32 v[16:17], v[16:17], v[144:145]
v_exp_f32 v25, v25
v_pk_mul_f32 v[18:19], v[18:19], v[146:147]
v_exp_f32 v26, v26
v_pk_mul_f32 v[20:21], v[20:21], v[148:149]
v_exp_f32 v27, v27
v_pk_mul_f32 v[22:23], v[22:23], v[150:151]
v_exp_f32 v28, v28
v_cvt_pk_bf16_f32 v68, v16, v17
v_exp_f32 v29, v29
v_cvt_pk_bf16_f32 v69, v18, v19
v_exp_f32 v30, v30
v_cvt_pk_bf16_f32 v70, v20, v21
v_exp_f32 v31, v31
v_cvt_pk_bf16_f32 v71, v22, v23
buffer_store_dwordx4 v[68:71], v2, s[36:39], s17 offen offset:2048 sc1
ds_write_b128 v10, v[68:71] offset:6144
v_pk_fma_f32 v[24:25], v[24:25], s[54:55], s[54:55]
v_pk_fma_f32 v[26:27], v[26:27], s[54:55], s[54:55]
v_pk_fma_f32 v[28:29], v[28:29], s[54:55], s[54:55]
v_pk_fma_f32 v[30:31], v[30:31], s[54:55], s[54:55]
v_rcp_f32 v24, v24
v_pk_fma_f32 v[32:33], v[160:161], v[160:161], s[52:53]
v_rcp_f32 v25, v25
v_pk_fma_f32 v[34:35], v[162:163], v[162:163], s[52:53]
v_rcp_f32 v26, v26
v_pk_fma_f32 v[36:37], v[164:165], v[164:165], s[52:53]
v_rcp_f32 v27, v27
v_pk_fma_f32 v[38:39], v[166:167], v[166:167], s[52:53]
v_rcp_f32 v28, v28
v_pk_mul_f32 v[32:33], v[32:33], v[160:161] neg_lo:[1,0] neg_hi:[1,0]
v_rcp_f32 v29, v29
v_pk_mul_f32 v[34:35], v[34:35], v[162:163] neg_lo:[1,0] neg_hi:[1,0]
v_rcp_f32 v30, v30
v_pk_mul_f32 v[36:37], v[36:37], v[164:165] neg_lo:[1,0] neg_hi:[1,0]
v_rcp_f32 v31, v31
v_pk_mul_f32 v[38:39], v[38:39], v[166:167] neg_lo:[1,0] neg_hi:[1,0]
v_exp_f32 v32, v32
v_pk_mul_f32 v[24:25], v[24:25], v[152:153]
v_exp_f32 v33, v33
v_pk_mul_f32 v[26:27], v[26:27], v[154:155]
v_exp_f32 v34, v34
v_pk_mul_f32 v[28:29], v[28:29], v[156:157]
v_exp_f32 v35, v35
v_pk_mul_f32 v[30:31], v[30:31], v[158:159]
v_exp_f32 v36, v36
v_cvt_pk_bf16_f32 v72, v24, v25
v_exp_f32 v37, v37
v_cvt_pk_bf16_f32 v73, v26, v27
v_exp_f32 v38, v38
v_cvt_pk_bf16_f32 v74, v28, v29
v_exp_f32 v39, v39
v_cvt_pk_bf16_f32 v75, v30, v31
buffer_store_dwordx4 v[72:75], v2, s[36:39], s17 offen offset:3072 sc1
ds_write_b128 v10, v[72:75] offset:7168
v_pk_fma_f32 v[32:33], v[32:33], s[54:55], s[54:55]
v_pk_fma_f32 v[34:35], v[34:35], s[54:55], s[54:55]
v_pk_fma_f32 v[36:37], v[36:37], s[54:55], s[54:55]
v_pk_fma_f32 v[38:39], v[38:39], s[54:55], s[54:55]
v_rcp_f32 v32, v32
v_rcp_f32 v33, v33
v_rcp_f32 v34, v34
v_rcp_f32 v35, v35
v_rcp_f32 v36, v36
v_rcp_f32 v37, v37
v_rcp_f32 v38, v38
v_rcp_f32 v39, v39
v_pk_mul_f32 v[32:33], v[32:33], v[160:161]
v_pk_mul_f32 v[34:35], v[34:35], v[162:163]
v_pk_mul_f32 v[36:37], v[36:37], v[164:165]
v_pk_mul_f32 v[38:39], v[38:39], v[166:167]
v_cvt_pk_bf16_f32 v76, v32, v33
v_cvt_pk_bf16_f32 v77, v34, v35
v_cvt_pk_bf16_f32 v78, v36, v37
v_cvt_pk_bf16_f32 v79, v38, v39
s_add_u32 s17, s17, 4096
buffer_store_dwordx4 v[76:79], v2, s[36:39], s17 offen offset:0 sc1
ds_write_b128 v10, v[76:79] offset:8192
s_branch K2_c
K1_ldP:
s_lshr_b32 s56, s2, 3
s_lshl_b32 s3, s2, 1
s_add_u32 s56, s56, s3
s_and_b32 s56, s56, 3
s_mul_i32 s56, s56, 20
s_add_u32 s3, s56, 712
v_and_b32 v36, 63, v0
v_lshlrev_b32 v37, 4, v36
v_min_u32 v36, 19, v36
v_add_lshl_u32 v36, v36, s3, 7
s_sub_u32 s3, s16, 4
s_mul_i32 s55, s3, 46080
s_add_u32 s55, s55, 8192
v_add_u32 v33, s55, v37
s_lshl_b32 s3, s3, 10
v_add_u32 v37, s3, v37
v_add_u32 v23, 4096, v37
s_add_u32 s8, s26, 2359296
s_addc_u32 s9, s27, 0
s_mov_b32 s10, 2359296
s_mov_b32 s11, 0x20000
s_sub_u32 s17, s16, 4
s_mul_i32 s21, s22, 589824
s_mul_i32 s62, s59, 18432
s_add_u32 s21, s21, s62
s_sub_u32 s60, 4, s59
s_mov_b32 s61, 4
v_and_b32 v1, 63, v0
v_lshlrev_b32 v1, 4, v1
s_mul_i32 s18, s17, 9216
v_add_u32 v2, s18, v1
v_add_u32 v3, 4096, v2
v_add_u32 v4, 8192, v2
s_mov_b32 s20, 7
v_and_b32 v8, 62, v0
v_and_b32 v9, 1, v0
v_lshl_add_u32 v8, v8, 1, v9
s_lshl_b32 s3, s17, 1
s_add_u32 s3, s3, 112
v_add_lshl_u32 v8, v8, s3, 7
s_and_b32 s3, s2, 7
s_add_u32 s3, s3, 704
s_lshl_b32 s3, s3, 7
v_mov_b32 v9, s3
s_mov_b64 exec, 1
s_mov_b32 s63, 60000
Lp_5:
buffer_load_dwordx2 v[10:11], v9, s[96:99], 0 offen sc1
s_waitcnt vmcnt(0)
v_cmp_ne_u64 vcc, s[100:101], v[10:11]
s_sub_u32 s63, s63, 1
s_cbranch_scc1 Lx_6
s_nop 2
s_cbranch_vccz Lx_6
s_mov_b64 exec, vcc
s_sleep 2
s_branch Lp_5
Lx_6:
s_mov_b64 exec, -1
Ls_4:
s_mov_b32 s63, 60000
Lp_7:
buffer_load_dwordx2 v[10:11], v8, s[96:99], 0 offen sc1
s_waitcnt vmcnt(0)
v_cmp_ne_u64 vcc, s[100:101], v[10:11]
s_sub_u32 s63, s63, 1
s_cbranch_scc1 Lx_8
s_nop 2
s_cbranch_vccz Lx_8
s_mov_b64 exec, vcc
s_branch Lp_7
Lx_8:
s_mov_b64 exec, -1
s_add_u32 m0, s18, 0
s_nop 0
buffer_load_dwordx4 v2, s[8:11], s21 offen offset:0 sc1 lds
buffer_load_dwordx4 v2, s[8:11], s21 offen offset:1024 sc1 lds
buffer_load_dwordx4 v2, s[8:11], s21 offen offset:2048 sc1 lds
buffer_load_dwordx4 v2, s[8:11], s21 offen offset:3072 sc1 lds
s_add_u32 m0, s18, 4096
s_nop 0
buffer_load_dwordx4 v3, s[8:11], s21 offen offset:0 sc1 lds
buffer_load_dwordx4 v3, s[8:11], s21 offen offset:1024 sc1 lds
buffer_load_dwordx4 v3, s[8:11], s21 offen offset:2048 sc1 lds
buffer_load_dwordx4 v3, s[8:11], s21 offen offset:3072 sc1 lds
s_add_u32 m0, s18, 8192
s_nop 0
buffer_load_dwordx4 v4, s[8:11], s21 offen offset:0 sc1 lds
s_add_u32 s21, s21, 18432
s_sub_u32 s60, s60, 1
s_cmp_eq_u32 s60, 0
s_cselect_b32 s62, 73728, 0
s_cselect_b32 s60, 4, s60
s_sub_u32 s21, s21, s62
s_sub_u32 s61, s61, 1
s_cmp_eq_u32 s61, 0
s_cselect_b32 s62, 73728, 0
s_cselect_b32 s61, 4, s61
s_add_u32 s21, s21, s62
s_add_u32 m0, s18, 36864
s_nop 0
buffer_load_dwordx4 v2, s[8:11], s21 offen offset:0 sc1 lds
buffer_load_dwordx4 v2, s[8:11], s21 offen offset:1024 sc1 lds
buffer_load_dwordx4 v2, s[8:11], s21 offen offset:2048 sc1 lds
buffer_load_dwordx4 v2, s[8:11], s21 offen offset:3072 sc1 lds
s_add_u32 m0, s18, 40960
s_nop 0
buffer_load_dwordx4 v3, s[8:11], s21 offen offset:0 sc1 lds
buffer_load_dwordx4 v3, s[8:11], s21 offen offset:1024 sc1 lds
buffer_load_dwordx4 v3, s[8:11], s21 offen offset:2048 sc1 lds
buffer_load_dwordx4 v3, s[8:11], s21 offen offset:3072 sc1 lds
s_add_u32 m0, s18, 45056
s_nop 0
buffer_load_dwordx4 v4, s[8:11], s21 offen offset:0 sc1 lds
s_add_u32 s21, s21, 18432
s_sub_u32 s60, s60, 1
s_cmp_eq_u32 s60, 0
s_cselect_b32 s62, 73728, 0
s_cselect_b32 s60, 4, s60
s_sub_u32 s21, s21, s62
s_sub_u32 s61, s61, 1
s_cmp_eq_u32 s61, 0
s_cselect_b32 s62, 73728, 0
s_cselect_b32 s61, 4, s61
s_add_u32 s21, s21, s62
s_add_u32 m0, s18, 73728
s_nop 0
buffer_load_dwordx4 v2, s[8:11], s21 offen offset:0 sc1 lds
buffer_load_dwordx4 v2, s[8:11], s21 offen offset:1024 sc1 lds
buffer_load_dwordx4 v2, s[8:11], s21 offen offset:2048 sc1 lds
buffer_load_dwordx4 v2, s[8:11], s21 offen offset:3072 sc1 lds
s_add_u32 m0, s18, 77824
s_nop 0
buffer_load_dwordx4 v3, s[8:11], s21 offen offset:0 sc1 lds
buffer_load_dwordx4 v3, s[8:11], s21 offen offset:1024 sc1 lds
buffer_load_dwordx4 v3, s[8:11], s21 offen offset:2048 sc1 lds
buffer_load_dwordx4 v3, s[8:11], s21 offen offset:3072 sc1 lds
s_add_u32 m0, s18, 81920
s_nop 0
buffer_load_dwordx4 v4, s[8:11], s21 offen offset:0 sc1 lds
s_add_u32 s21, s21, 18432
s_sub_u32 s60, s60, 1
s_cmp_eq_u32 s60, 0
s_cselect_b32 s62, 73728, 0
s_cselect_b32 s60, 4, s60
s_sub_u32 s21, s21, s62
s_sub_u32 s61, s61, 1
s_cmp_eq_u32 s61, 0
s_cselect_b32 s62, 73728, 0
s_cselect_b32 s61, 4, s61
s_add_u32 s21, s21, s62
Ll_3:
s_waitcnt vmcnt(18)
s_barrier
s_add_u32 m0, s18, 110592
s_nop 0
buffer_load_dwordx4 v2, s[8:11], s21 offen offset:0 sc1 lds
buffer_load_dwordx4 v2, s[8:11], s21 offen offset:1024 sc1 lds
buffer_load_dwordx4 v2, s[8:11], s21 offen offset:2048 sc1 lds
buffer_load_dwordx4 v2, s[8:11], s21 offen offset:3072 sc1 lds
s_add_u32 m0, s18, 114688
s_nop 0
buffer_load_dwordx4 v3, s[8:11], s21 offen offset:0 sc1 lds
buffer_load_dwordx4 v3, s[8:11], s21 offen offset:1024 sc1 lds
buffer_load_dwordx4 v3, s[8:11], s21 offen offset:2048 sc1 lds
buffer_load_dwordx4 v3, s[8:11], s21 offen offset:3072 sc1 lds
s_add_u32 m0, s18, 118784
s_nop 0
buffer_load_dwordx4 v4, s[8:11], s21 offen offset:0 sc1 lds
s_add_u32 s21, s21, 18432
s_sub_u32 s60, s60, 1
s_cmp_eq_u32 s60, 0
s_cselect_b32 s62, 73728, 0
s_cselect_b32 s60, 4, s60
s_sub_u32 s21, s21, s62
s_sub_u32 s61, s61, 1
s_cmp_eq_u32 s61, 0
s_cselect_b32 s62, 73728, 0
s_cselect_b32 s61, 4, s61
s_add_u32 s21, s21, s62
s_waitcnt vmcnt(18)
s_barrier
s_add_u32 m0, s18, 0
s_nop 0
buffer_load_dwordx4 v2, s[8:11], s21 offen offset:0 sc1 lds
buffer_load_dwordx4 v2, s[8:11], s21 offen offset:1024 sc1 lds
buffer_load_dwordx4 v2, s[8:11], s21 offen offset:2048 sc1 lds
buffer_load_dwordx4 v2, s[8:11], s21 offen offset:3072 sc1 lds
s_add_u32 m0, s18, 4096
s_nop 0
buffer_load_dwordx4 v3, s[8:11], s21 offen offset:0 sc1 lds
buffer_load_dwordx4 v3, s[8:11], s21 offen offset:1024 sc1 lds
buffer_load_dwordx4 v3, s[8:11], s21 offen offset:2048 sc1 lds
buffer_load_dwordx4 v3, s[8:11], s21 offen offset:3072 sc1 lds
s_add_u32 m0, s18, 8192
s_nop 0
buffer_load_dwordx4 v4, s[8:11], s21 offen offset:0 sc1 lds
s_add_u32 s21, s21, 18432
s_sub_u32 s60, s60, 1
s_cmp_eq_u32 s60, 0
s_cselect_b32 s62, 73728, 0
s_cselect_b32 s60, 4, s60
s_sub_u32 s21, s21, s62
s_sub_u32 s61, s61, 1
s_cmp_eq_u32 s61, 0
s_cselect_b32 s62, 73728, 0
s_cselect_b32 s61, 4, s61
s_add_u32 s21, s21, s62
s_cmp_lg_u32 s20, 7
s_cbranch_scc1 Lv_9
buffer_load_dwordx2 v[38:39], v36, s[96:99], 0 offen sc1
Lv_9:
Ll_3_2:
s_waitcnt vmcnt(18)
s_barrier
s_add_u32 m0, s18, 36864
s_nop 0
buffer_load_dwordx4 v2, s[8:11], s21 offen offset:0 sc1 lds
buffer_load_dwordx4 v2, s[8:11], s21 offen offset:1024 sc1 lds
buffer_load_dwordx4 v2, s[8:11], s21 offen offset:2048 sc1 lds
buffer_load_dwordx4 v2, s[8:11], s21 offen offset:3072 sc1 lds
s_add_u32 m0, s18, 40960
s_nop 0
buffer_load_dwordx4 v3, s[8:11], s21 offen offset:0 sc1 lds
buffer_load_dwordx4 v3, s[8:11], s21 offen offset:1024 sc1 lds
buffer_load_dwordx4 v3, s[8:11], s21 offen offset:2048 sc1 lds
buffer_load_dwordx4 v3, s[8:11], s21 offen offset:3072 sc1 lds
s_add_u32 m0, s18, 45056
s_nop 0
buffer_load_dwordx4 v4, s[8:11], s21 offen offset:0 sc1 lds
s_add_u32 s21, s21, 18432
s_sub_u32 s60, s60, 1
s_cmp_eq_u32 s60, 0
s_cselect_b32 s62, 73728, 0
s_cselect_b32 s60, 4, s60
s_sub_u32 s21, s21, s62
s_sub_u32 s61, s61, 1
s_cmp_eq_u32 s61, 0
s_cselect_b32 s62, 73728, 0
s_cselect_b32 s61, 4, s61
s_add_u32 s21, s21, s62
Ll_3_3:
s_waitcnt vmcnt(18)
s_barrier
s_add_u32 m0, s18, 73728
s_nop 0
buffer_load_dwordx4 v2, s[8:11], s21 offen offset:0 sc1 lds
buffer_load_dwordx4 v2, s[8:11], s21 offen offset:1024 sc1 lds
buffer_load_dwordx4 v2, s[8:11], s21 offen offset:2048 sc1 lds
buffer_load_dwordx4 v2, s[8:11], s21 offen offset:3072 sc1 lds
s_add_u32 m0, s18, 77824
s_nop 0
buffer_load_dwordx4 v3, s[8:11], s21 offen offset:0 sc1 lds
buffer_load_dwordx4 v3, s[8:11], s21 offen offset:1024 sc1 lds
buffer_load_dwordx4 v3, s[8:11], s21 offen offset:2048 sc1 lds
buffer_load_dwordx4 v3, s[8:11], s21 offen offset:3072 sc1 lds
s_add_u32 m0, s18, 81920
s_nop 0
buffer_load_dwordx4 v4, s[8:11], s21 offen offset:0 sc1 lds
s_add_u32 s21, s21, 18432
s_sub_u32 s60, s60, 1
s_cmp_eq_u32 s60, 0
s_cselect_b32 s62, 73728, 0
s_cselect_b32 s60, 4, s60
s_sub_u32 s21, s21, s62
s_sub_u32 s61, s61, 1
s_cmp_eq_u32 s61, 0
s_cselect_b32 s62, 73728, 0
s_cselect_b32 s61, 4, s61
s_add_u32 s21, s21, s62
s_cmp_lg_u32 s20, 7
s_cbranch_scc1 Lv_10
s_waitcnt vmcnt(18)
v_cmp_ne_u64 vcc, s[100:101], v[38:39]
s_nop 4
s_cbranch_vccz Lw_11
s_mov_b32 s63, 60000
Lp_12:
buffer_load_dwordx2 v[38:39], v36, s[96:99], 0 offen sc1
s_waitcnt vmcnt(0)
v_cmp_ne_u64 vcc, s[100:101], v[38:39]
s_sub_u32 s63, s63, 1
s_cbranch_scc1 Lx_13
s_nop 2
s_cbranch_vccz Lx_13
s_mov_b64 exec, vcc
s_sleep 2
s_branch Lp_12
Lx_13:
s_mov_b64 exec, -1
Lw_11:
s_add_u32 s92, s26, 19922944
s_addc_u32 s93, s27, 0
s_mov_b32 s94, 737280
s_mov_b32 s95, 0x20000
s_add_u32 s56, s56, 2
s_mul_i32 s56, s56, 9216
s_sub_u32 s3, s16, 4
s_lshl_b32 s3, s3, 10
s_add_u32 m0, s3, 147456
s_mov_b32 s3, s56
buffer_load_dwordx4 v33, s[92:95], s56 offen sc1 lds
buffer_load_dwordx4 v[40:43], v37, s[92:95], s3 offen sc1
buffer_load_dwordx4 v[44:47], v23, s[92:95], s3 offen sc1
s_add_u32 s3, s3, 46080
buffer_load_dwordx4 v[48:51], v37, s[92:95], s3 offen sc1
buffer_load_dwordx4 v[52:55], v23, s[92:95], s3 offen sc1
s_add_u32 s3, s3, 46080
buffer_load_dwordx4 v[56:59], v37, s[92:95], s3 offen sc1
buffer_load_dwordx4 v[60:63], v23, s[92:95], s3 offen sc1
s_add_u32 s3, s3, 46080
buffer_load_dwordx4 v[64:67], v37, s[92:95], s3 offen sc1
buffer_load_dwordx4 v[68:71], v23, s[92:95], s3 offen sc1
s_add_u32 s56, s56, 9216
Lv_10:
s_sub_u32 s20, s20, 1
s_cmp_lg_u32 s20, 0
s_cbranch_scc1 Ll_3
Ll_3_e:
s_waitcnt vmcnt(18)
s_barrier
s_add_u32 m0, s18, 110592
s_nop 0
buffer_load_dwordx4 v2, s[8:11], s21 offen offset:0 sc1 lds
buffer_load_dwordx4 v2, s[8:11], s21 offen offset:1024 sc1 lds
buffer_load_dwordx4 v2, s[8:11], s21 offen offset:2048 sc1 lds
buffer_load_dwordx4 v2, s[8:11], s21 offen offset:3072 sc1 lds
s_add_u32 m0, s18, 114688
s_nop 0
buffer_load_dwordx4 v3, s[8:11], s21 offen offset:0 sc1 lds
buffer_load_dwordx4 v3, s[8:11], s21 offen offset:1024 sc1 lds
buffer_load_dwordx4 v3, s[8:11], s21 offen offset:2048 sc1 lds
buffer_load_dwordx4 v3, s[8:11], s21 offen offset:3072 sc1 lds
s_add_u32 m0, s18, 118784
s_nop 0
buffer_load_dwordx4 v4, s[8:11], s21 offen offset:0 sc1 lds
s_add_u32 s21, s21, 18432
s_sub_u32 s60, s60, 1
s_cmp_eq_u32 s60, 0
s_cselect_b32 s62, 73728, 0
s_cselect_b32 s60, 4, s60
s_sub_u32 s21, s21, s62
s_sub_u32 s61, s61, 1
s_cmp_eq_u32 s61, 0
s_cselect_b32 s62, 73728, 0
s_cselect_b32 s61, 4, s61
s_add_u32 s21, s21, s62
s_waitcnt vmcnt(18)
s_barrier
s_waitcnt vmcnt(9)
s_barrier
s_waitcnt vmcnt(0)
s_barrier
s_branch K1_ldseam
K1_ldW:
s_mov_b32 s12, s4
s_mov_b32 s13, s5
s_mov_b32 s14, 18874368
s_mov_b32 s15, 0x20000
s_sub_u32 s17, s16, 6
s_lshl_b32 s21, s23, 8
s_mul_i32 s62, s59, 589824
s_add_u32 s21, s21, s62
s_sub_u32 s60, 4, s59
s_mov_b32 s61, 4
v_and_b32 v1, 63, v0
v_lshrrev_b32 v10, 4, v1
v_and_b32 v11, 15, v1
s_lshl_b32 s18, s17, 5
v_add_u32 v12, s18, v10
s_mov_b32 s3, 9216
v_mul_lo_u32 v12, v12, s3
v_or_b32 v13, 0, v10
v_lshlrev_b32 v13, 1, v13
v_xor_b32 v13, v13, v11
v_lshl_add_u32 v13, v13, 4, v12
v_add_u32 v2, 0, v13
v_add_u32 v3, 35840, v13
v_add_u32 v6, 147456, v13
v_add_u32 v7, 183296, v13
v_or_b32 v13, 4, v10
v_lshlrev_b32 v13, 1, v13
v_xor_b32 v13, v13, v11
v_lshl_add_u32 v13, v13, 4, v12
v_add_u32 v4, 71680, v13
v_add_u32 v5, 107520, v13
v_add_u32 v8, 219136, v13
v_add_u32 v9, 254976, v13
s_lshl_b32 s18, s17, 13
s_mov_b32 s20, 7
s_add_u32 m0, s18, 18432
s_nop 0
buffer_load_dwordx4 v2, s[12:15], s21 offen offset:0  lds
buffer_load_dwordx4 v3, s[12:15], s21 offen offset:1024  lds
buffer_load_dwordx4 v4, s[12:15], s21 offen offset:2048  lds
buffer_load_dwordx4 v5, s[12:15], s21 offen offset:3072  lds
s_add_u32 m0, s18, 22528
s_nop 0
buffer_load_dwordx4 v6, s[12:15], s21 offen offset:0  lds
buffer_load_dwordx4 v7, s[12:15], s21 offen offset:1024  lds
buffer_load_dwordx4 v8, s[12:15], s21 offen offset:2048  lds
buffer_load_dwordx4 v9, s[12:15], s21 offen offset:3072  lds
s_add_u32 s21, s21, 589824
s_sub_u32 s60, s60, 1
s_cmp_eq_u32 s60, 0
s_cselect_b32 s62, 2359296, 0
s_cselect_b32 s60, 4, s60
s_sub_u32 s21, s21, s62
s_sub_u32 s61, s61, 1
s_cmp_eq_u32 s61, 0
s_cselect_b32 s62, 2359296, 0
s_cselect_b32 s61, 4, s61
s_add_u32 s21, s21, s62
s_add_u32 m0, s18, 55296
s_nop 0
buffer_load_dwordx4 v2, s[12:15], s21 offen offset:0  lds
buffer_load_dwordx4 v3, s[12:15], s21 offen offset:1024  lds
buffer_load_dwordx4 v4, s[12:15], s21 offen offset:2048  lds
buffer_load_dwordx4 v5, s[12:15], s21 offen offset:3072  lds
s_add_u32 m0, s18, 59392
s_nop 0
buffer_load_dwordx4 v6, s[12:15], s21 offen offset:0  lds
buffer_load_dwordx4 v7, s[12:15], s21 offen offset:1024  lds
buffer_load_dwordx4 v8, s[12:15], s21 offen offset:2048  lds
buffer_load_dwordx4 v9, s[12:15], s21 offen offset:3072  lds
s_add_u32 s21, s21, 589824
s_sub_u32 s60, s60, 1
s_cmp_eq_u32 s60, 0
s_cselect_b32 s62, 2359296, 0
s_cselect_b32 s60, 4, s60
s_sub_u32 s21, s21, s62
s_sub_u32 s61, s61, 1
s_cmp_eq_u32 s61, 0
s_cselect_b32 s62, 2359296, 0
s_cselect_b32 s61, 4, s61
s_add_u32 s21, s21, s62
s_add_u32 m0, s18, 92160
s_nop 0
buffer_load_dwordx4 v2, s[12:15], s21 offen offset:0  lds
buffer_load_dwordx4 v3, s[12:15], s21 offen offset:1024  lds
buffer_load_dwordx4 v4, s[12:15], s21 offen offset:2048  lds
buffer_load_dwordx4 v5, s[12:15], s21 offen offset:3072  lds
s_add_u32 m0, s18, 96256
s_nop 0
buffer_load_dwordx4 v6, s[12:15], s21 offen offset:0  lds
buffer_load_dwordx4 v7, s[12:15], s21 offen offset:1024  lds
buffer_load_dwordx4 v8, s[12:15], s21 offen offset:2048  lds
buffer_load_dwordx4 v9, s[12:15], s21 offen offset:3072  lds
s_add_u32 s21, s21, 589824
s_sub_u32 s60, s60, 1
s_cmp_eq_u32 s60, 0
s_cselect_b32 s62, 2359296, 0
s_cselect_b32 s60, 4, s60
s_sub_u32 s21, s21, s62
s_sub_u32 s61, s61, 1
s_cmp_eq_u32 s61, 0
s_cselect_b32 s62, 2359296, 0
s_cselect_b32 s61, 4, s61
s_add_u32 s21, s21, s62
s_lshr_b32 s56, s2, 3
s_lshl_b32 s3, s2, 1
s_add_u32 s56, s56, s3
s_and_b32 s56, s56, 3
s_mul_i32 s56, s56, 20
s_add_u32 s3, s56, 712
v_and_b32 v36, 63, v0
v_lshlrev_b32 v37, 4, v36
v_min_u32 v36, 19, v36
v_add_lshl_u32 v36, v36, s3, 7
s_sub_u32 s3, s16, 4
s_mul_i32 s55, s3, 46080
s_add_u32 s55, s55, 8192
v_add_u32 v33, s55, v37
s_lshl_b32 s3, s3, 10
v_add_u32 v37, s3, v37
v_add_u32 v23, 4096, v37
Ll_14:
s_waitcnt vmcnt(16)
s_barrier
s_add_u32 m0, s18, 129024
s_nop 0
buffer_load_dwordx4 v2, s[12:15], s21 offen offset:0  lds
buffer_load_dwordx4 v3, s[12:15], s21 offen offset:1024  lds
buffer_load_dwordx4 v4, s[12:15], s21 offen offset:2048  lds
buffer_load_dwordx4 v5, s[12:15], s21 offen offset:3072  lds
s_add_u32 m0, s18, 133120
s_nop 0
buffer_load_dwordx4 v6, s[12:15], s21 offen offset:0  lds
buffer_load_dwordx4 v7, s[12:15], s21 offen offset:1024  lds
buffer_load_dwordx4 v8, s[12:15], s21 offen offset:2048  lds
buffer_load_dwordx4 v9, s[12:15], s21 offen offset:3072  lds
s_add_u32 s21, s21, 589824
s_sub_u32 s60, s60, 1
s_cmp_eq_u32 s60, 0
s_cselect_b32 s62, 2359296, 0
s_cselect_b32 s60, 4, s60
s_sub_u32 s21, s21, s62
s_sub_u32 s61, s61, 1
s_cmp_eq_u32 s61, 0
s_cselect_b32 s62, 2359296, 0
s_cselect_b32 s61, 4, s61
s_add_u32 s21, s21, s62
s_waitcnt vmcnt(16)
s_barrier
s_add_u32 m0, s18, 18432
s_nop 0
buffer_load_dwordx4 v2, s[12:15], s21 offen offset:0  lds
buffer_load_dwordx4 v3, s[12:15], s21 offen offset:1024  lds
buffer_load_dwordx4 v4, s[12:15], s21 offen offset:2048  lds
buffer_load_dwordx4 v5, s[12:15], s21 offen offset:3072  lds
s_add_u32 m0, s18, 22528
s_nop 0
buffer_load_dwordx4 v6, s[12:15], s21 offen offset:0  lds
buffer_load_dwordx4 v7, s[12:15], s21 offen offset:1024  lds
buffer_load_dwordx4 v8, s[12:15], s21 offen offset:2048  lds
buffer_load_dwordx4 v9, s[12:15], s21 offen offset:3072  lds
s_add_u32 s21, s21, 589824
s_sub_u32 s60, s60, 1
s_cmp_eq_u32 s60, 0
s_cselect_b32 s62, 2359296, 0
s_cselect_b32 s60, 4, s60
s_sub_u32 s21, s21, s62
s_sub_u32 s61, s61, 1
s_cmp_eq_u32 s61, 0
s_cselect_b32 s62, 2359296, 0
s_cselect_b32 s61, 4, s61
s_add_u32 s21, s21, s62
s_cmp_lg_u32 s20, 7
s_cbranch_scc1 Lv_15
buffer_load_dwordx2 v[38:39], v36, s[96:99], 0 offen sc1
Lv_15:
Ll_14_2:
s_waitcnt vmcnt(16)
s_barrier
s_add_u32 m0, s18, 55296
s_nop 0
buffer_load_dwordx4 v2, s[12:15], s21 offen offset:0  lds
buffer_load_dwordx4 v3, s[12:15], s21 offen offset:1024  lds
buffer_load_dwordx4 v4, s[12:15], s21 offen offset:2048  lds
buffer_load_dwordx4 v5, s[12:15], s21 offen offset:3072  lds
s_add_u32 m0, s18, 59392
s_nop 0
buffer_load_dwordx4 v6, s[12:15], s21 offen offset:0  lds
buffer_load_dwordx4 v7, s[12:15], s21 offen offset:1024  lds
buffer_load_dwordx4 v8, s[12:15], s21 offen offset:2048  lds
buffer_load_dwordx4 v9, s[12:15], s21 offen offset:3072  lds
s_add_u32 s21, s21, 589824
s_sub_u32 s60, s60, 1
s_cmp_eq_u32 s60, 0
s_cselect_b32 s62, 2359296, 0
s_cselect_b32 s60, 4, s60
s_sub_u32 s21, s21, s62
s_sub_u32 s61, s61, 1
s_cmp_eq_u32 s61, 0
s_cselect_b32 s62, 2359296, 0
s_cselect_b32 s61, 4, s61
s_add_u32 s21, s21, s62
Ll_14_3:
s_waitcnt vmcnt(16)
s_barrier
s_add_u32 m0, s18, 92160
s_nop 0
buffer_load_dwordx4 v2, s[12:15], s21 offen offset:0  lds
buffer_load_dwordx4 v3, s[12:15], s21 offen offset:1024  lds
buffer_load_dwordx4 v4, s[12:15], s21 offen offset:2048  lds
buffer_load_dwordx4 v5, s[12:15], s21 offen offset:3072  lds
s_add_u32 m0, s18, 96256
s_nop 0
buffer_load_dwordx4 v6, s[12:15], s21 offen offset:0  lds
buffer_load_dwordx4 v7, s[12:15], s21 offen offset:1024  lds
buffer_load_dwordx4 v8, s[12:15], s21 offen offset:2048  lds
buffer_load_dwordx4 v9, s[12:15], s21 offen offset:3072  lds
s_add_u32 s21, s21, 589824
s_sub_u32 s60, s60, 1
s_cmp_eq_u32 s60, 0
s_cselect_b32 s62, 2359296, 0
s_cselect_b32 s60, 4, s60
s_sub_u32 s21, s21, s62
s_sub_u32 s61, s61, 1
s_cmp_eq_u32 s61, 0
s_cselect_b32 s62, 2359296, 0
s_cselect_b32 s61, 4, s61
s_add_u32 s21, s21, s62
s_cmp_lg_u32 s20, 7
s_cbranch_scc1 Lv_16
s_waitcnt vmcnt(16)
v_cmp_ne_u64 vcc, s[100:101], v[38:39]
s_nop 4
s_cbranch_vccz Lw_17
s_mov_b32 s63, 60000
Lp_18:
buffer_load_dwordx2 v[38:39], v36, s[96:99], 0 offen sc1
s_waitcnt vmcnt(0)
v_cmp_ne_u64 vcc, s[100:101], v[38:39]
s_sub_u32 s63, s63, 1
s_cbranch_scc1 Lx_19
s_nop 2
s_cbranch_vccz Lx_19
s_mov_b64 exec, vcc
s_sleep 2
s_branch Lp_18
Lx_19:
s_mov_b64 exec, -1
Lw_17:
s_add_u32 s92, s26, 19922944
s_addc_u32 s93, s27, 0
s_mov_b32 s94, 737280
s_mov_b32 s95, 0x20000
s_add_u32 s56, s56, 2
s_mul_i32 s56, s56, 9216
s_sub_u32 s3, s16, 4
s_lshl_b32 s3, s3, 10
s_add_u32 m0, s3, 147456
s_mov_b32 s3, s56
buffer_load_dwordx4 v33, s[92:95], s56 offen sc1 lds
buffer_load_dwordx4 v[40:43], v37, s[92:95], s3 offen sc1
buffer_load_dwordx4 v[44:47], v23, s[92:95], s3 offen sc1
s_add_u32 s3, s3, 46080
buffer_load_dwordx4 v[48:51], v37, s[92:95], s3 offen sc1
buffer_load_dwordx4 v[52:55], v23, s[92:95], s3 offen sc1
s_add_u32 s3, s3, 46080
buffer_load_dwordx4 v[56:59], v37, s[92:95], s3 offen sc1
buffer_load_dwordx4 v[60:63], v23, s[92:95], s3 offen sc1
s_add_u32 s3, s3, 46080
buffer_load_dwordx4 v[64:67], v37, s[92:95], s3 offen sc1
buffer_load_dwordx4 v[68:71], v23, s[92:95], s3 offen sc1
s_add_u32 s56, s56, 9216
Lv_16:
s_sub_u32 s20, s20, 1
s_cmp_lg_u32 s20, 0
s_cbranch_scc1 Ll_14
Ll_14_e:
s_waitcnt vmcnt(16)
s_barrier
s_add_u32 m0, s18, 129024
s_nop 0
buffer_load_dwordx4 v2, s[12:15], s21 offen offset:0  lds
buffer_load_dwordx4 v3, s[12:15], s21 offen offset:1024  lds
buffer_load_dwordx4 v4, s[12:15], s21 offen offset:2048  lds
buffer_load_dwordx4 v5, s[12:15], s21 offen offset:3072  lds
s_add_u32 m0, s18, 133120
s_nop 0
buffer_load_dwordx4 v6, s[12:15], s21 offen offset:0  lds
buffer_load_dwordx4 v7, s[12:15], s21 offen offset:1024  lds
buffer_load_dwordx4 v8, s[12:15], s21 offen offset:2048  lds
buffer_load_dwordx4 v9, s[12:15], s21 offen offset:3072  lds
s_add_u32 s21, s21, 589824
s_sub_u32 s60, s60, 1
s_cmp_eq_u32 s60, 0
s_cselect_b32 s62, 2359296, 0
s_cselect_b32 s60, 4, s60
s_sub_u32 s21, s21, s62
s_sub_u32 s61, s61, 1
s_cmp_eq_u32 s61, 0
s_cselect_b32 s62, 2359296, 0
s_cselect_b32 s61, 4, s61
s_add_u32 s21, s21, s62
s_waitcnt vmcnt(16)
s_barrier
v_and_b32 v1, 63, v0
v_lshrrev_b32 v10, 4, v1
v_and_b32 v11, 15, v1
s_lshl_b32 s18, s17, 5
v_add_u32 v12, s18, v10
s_mov_b32 s3, 4096
v_mul_lo_u32 v12, v12, s3
v_or_b32 v13, 0, v10
v_lshlrev_b32 v13, 1, v13
v_xor_b32 v13, v13, v11
v_lshl_add_u32 v13, v13, 4, v12
v_add_u32 v2, 0, v13
v_add_u32 v4, 30720, v13
v_add_u32 v6, 65536, v13
v_add_u32 v8, 96256, v13
v_or_b32 v13, 4, v10
v_lshlrev_b32 v13, 1, v13
v_xor_b32 v13, v13, v11
v_lshl_add_u32 v13, v13, 4, v12
v_add_u32 v3, 15360, v13
v_add_u32 v5, 46080, v13
v_add_u32 v7, 80896, v13
v_add_u32 v9, 111616, v13
s_lshl_b32 s18, s17, 13
s_mov_b32 s12, s50
s_mov_b32 s13, s51
s_mov_b32 s14, 18874368
s_mov_b32 s15, 0x20000
s_mul_i32 s21, s23, 524288
s_and_b32 s3, s2, 1
s_lshl_b32 s3, s3, 11
s_add_u32 s21, s21, s3
s_lshr_b32 s3, s2, 5
s_lshl_b32 s3, s3, 8
s_add_u32 s21, s21, s3
s_add_u32 m0, s18, 18432
s_nop 0
buffer_load_dwordx4 v2, s[12:15], s21 offen offset:0  lds
buffer_load_dwordx4 v3, s[12:15], s21 offen offset:1024  lds
buffer_load_dwordx4 v4, s[12:15], s21 offen offset:2048  lds
buffer_load_dwordx4 v5, s[12:15], s21 offen offset:3072  lds
s_add_u32 m0, s18, 22528
s_nop 0
buffer_load_dwordx4 v6, s[12:15], s21 offen offset:0  lds
buffer_load_dwordx4 v7, s[12:15], s21 offen offset:1024  lds
buffer_load_dwordx4 v8, s[12:15], s21 offen offset:2048  lds
buffer_load_dwordx4 v9, s[12:15], s21 offen offset:3072  lds
s_add_u32 s21, s21, 262144
s_waitcnt vmcnt(16)
s_barrier
s_add_u32 m0, s18, 55296
s_nop 0
buffer_load_dwordx4 v2, s[12:15], s21 offen offset:0  lds
buffer_load_dwordx4 v3, s[12:15], s21 offen offset:1024  lds
buffer_load_dwordx4 v4, s[12:15], s21 offen offset:2048  lds
buffer_load_dwordx4 v5, s[12:15], s21 offen offset:3072  lds
s_add_u32 m0, s18, 59392
s_nop 0
buffer_load_dwordx4 v6, s[12:15], s21 offen offset:0  lds
buffer_load_dwordx4 v7, s[12:15], s21 offen offset:1024  lds
buffer_load_dwordx4 v8, s[12:15], s21 offen offset:2048  lds
buffer_load_dwordx4 v9, s[12:15], s21 offen offset:3072  lds
s_add_u32 s21, s21, 262144
s_waitcnt vmcnt(16)
s_barrier
Lz_20:
K1_ldseam:
s_barrier
s_mov_b32 s49, 2147483648
s_mov_b32 s24, s23
s_branch K2_ld
K1_notg1:
s_sub_u32 s18, s18, 18
s_and_b32 s22, s18, 3
s_lshr_b32 s19, s17, 1
s_lshl_b32 s19, s19, 2
s_add_u32 s22, s22, s19
s_lshr_b32 s18, s18, 2
s_and_b32 s17, s17, 1
s_lshl_b32 s19, s17, 1
s_add_u32 s23, s19, s18
s_add_u32 s17, s17, 4
s_cmp_eq_u32 s18, 2
s_cselect_b32 s23, s17, s23
s_waitcnt lgkmcnt(0)
s_cmp_ge_u32 s16, 6
s_cbranch_scc1 K1_ldX
s_cmp_ge_u32 s16, 4
s_cbranch_scc1 K1_ldF
v_and_b32 v1, 63, v0
v_lshlrev_b32 v2, 4, v1
v_add_u32 v3, 73728, v2
v_lshrrev_b32 v8, 5, v1
v_lshlrev_b32 v8, 12, v8
v_bfe_u32 v9, v1, 4, 1
v_lshl_add_u32 v8, v9, 7, v8
v_bfe_u32 v9, v1, 2, 2
v_lshl_add_u32 v8, v9, 4, v8
v_bfe_u32 v9, v1, 1, 1
v_mul_u32_u24 v9, 320, v9
v_add_u32 v8, v8, v9
v_and_b32 v9, 1, v1
v_lshl_add_u32 v8, v9, 3, v8
s_lshl_b32 s3, s16, 10
s_add_u32 s3, s3, 18432
v_add_u32 v4, s3, v8
v_xor_b32 v5, 64, v4
v_add_u32 v6, 73728, v4
v_add_u32 v7, 73728, v5
v_pk_mov_b32 v[96:97], 0, 0
v_pk_mov_b32 v[98:99], 0, 0
v_pk_mov_b32 v[100:101], 0, 0
v_pk_mov_b32 v[102:103], 0, 0
v_pk_mov_b32 v[104:105], 0, 0
v_pk_mov_b32 v[106:107], 0, 0
v_pk_mov_b32 v[108:109], 0, 0
v_pk_mov_b32 v[110:111], 0, 0
v_pk_mov_b32 v[112:113], 0, 0
v_pk_mov_b32 v[114:115], 0, 0
v_pk_mov_b32 v[116:117], 0, 0
v_pk_mov_b32 v[118:119], 0, 0
v_pk_mov_b32 v[120:121], 0, 0
v_pk_mov_b32 v[122:123], 0, 0
v_pk_mov_b32 v[124:125], 0, 0
v_pk_mov_b32 v[126:127], 0, 0
v_pk_mov_b32 v[128:129], 0, 0
v_pk_mov_b32 v[130:131], 0, 0
v_pk_mov_b32 v[132:133], 0, 0
v_pk_mov_b32 v[134:135], 0, 0
v_pk_mov_b32 v[136:137], 0, 0
v_pk_mov_b32 v[138:139], 0, 0
v_pk_mov_b32 v[140:141], 0, 0
v_pk_mov_b32 v[142:143], 0, 0
v_pk_mov_b32 v[144:145], 0, 0
v_pk_mov_b32 v[146:147], 0, 0
v_pk_mov_b32 v[148:149], 0, 0
v_pk_mov_b32 v[150:151], 0, 0
v_pk_mov_b32 v[152:153], 0, 0
v_pk_mov_b32 v[154:155], 0, 0
v_pk_mov_b32 v[156:157], 0, 0
v_pk_mov_b32 v[158:159], 0, 0
v_pk_mov_b32 v[160:161], 0, 0
v_pk_mov_b32 v[162:163], 0, 0
v_pk_mov_b32 v[164:165], 0, 0
v_pk_mov_b32 v[166:167], 0, 0
v_pk_mov_b32 v[168:169], 0, 0
v_pk_mov_b32 v[170:171], 0, 0
v_pk_mov_b32 v[172:173], 0, 0
v_pk_mov_b32 v[174:175], 0, 0
v_pk_mov_b32 v[176:177], 0, 0
v_pk_mov_b32 v[178:179], 0, 0
v_pk_mov_b32 v[180:181], 0, 0
v_pk_mov_b32 v[182:183], 0, 0
v_pk_mov_b32 v[184:185], 0, 0
v_pk_mov_b32 v[186:187], 0, 0
v_pk_mov_b32 v[188:189], 0, 0
v_pk_mov_b32 v[190:191], 0, 0
v_pk_mov_b32 v[192:193], 0, 0
v_pk_mov_b32 v[194:195], 0, 0
v_pk_mov_b32 v[196:197], 0, 0
v_pk_mov_b32 v[198:199], 0, 0
v_pk_mov_b32 v[200:201], 0, 0
v_pk_mov_b32 v[202:203], 0, 0
v_pk_mov_b32 v[204:205], 0, 0
v_pk_mov_b32 v[206:207], 0, 0
v_pk_mov_b32 v[208:209], 0, 0
v_pk_mov_b32 v[210:211], 0, 0
v_pk_mov_b32 v[212:213], 0, 0
v_pk_mov_b32 v[214:215], 0, 0
v_pk_mov_b32 v[216:217], 0, 0
v_pk_mov_b32 v[218:219], 0, 0
v_pk_mov_b32 v[220:221], 0, 0
v_pk_mov_b32 v[222:223], 0, 0
v_pk_mov_b32 v[224:225], 0, 0
v_pk_mov_b32 v[226:227], 0, 0
v_pk_mov_b32 v[228:229], 0, 0
v_pk_mov_b32 v[230:231], 0, 0
v_pk_mov_b32 v[232:233], 0, 0
v_pk_mov_b32 v[234:235], 0, 0
v_pk_mov_b32 v[236:237], 0, 0
v_pk_mov_b32 v[238:239], 0, 0
s_add_u32 s32, s26, 0
s_addc_u32 s33, s27, 0
s_mov_b32 s34, 16384
s_mov_b32 s35, 0x20000
s_lshl_b32 s30, s22, 2
s_add_u32 s30, s30, s16
s_lshl_b32 s30, s30, 8
v_and_b32 v252, 15, v1
v_lshlrev_b32 v252, 2, v252
v_and_b32 v253, 48, v1
s_cmp_ge_u32 s23, 4
s_cbranch_scc1 K1_q
s_mul_i32 s3, s16, 9216
s_add_u32 s3, s3, 114688
v_add_u32 v254, s3, v2
s_barrier
buffer_load_dword v240, v252, s[32:35], s30 offen offset:0 sc1
buffer_load_dwordx4 v[244:247], v253, s[32:35], s30 offen offset:0 sc1
buffer_load_dword v242, v252, s[32:35], s30 offen offset:128 sc1
buffer_load_dwordx4 v[248:251], v253, s[32:35], s30 offen offset:128 sc1
ds_read_b64_tr_b16 v[80:81], v4 offset:0
ds_read_b64_tr_b16 v[82:83], v5 offset:0
ds_read_b64_tr_b16 v[84:85], v4 offset:512
ds_read_b64_tr_b16 v[86:87], v5 offset:512
ds_read_b128 v[8:11], v2 offset:0
ds_read_b128 v[12:15], v2 offset:1024
ds_read_b128 v[16:19], v2 offset:2048
ds_read_b128 v[20:23], v2 offset:3072
ds_read_b128 v[24:27], v2 offset:4096
ds_read_b128 v[28:31], v2 offset:5120
ds_read_b128 v[32:35], v2 offset:6144
ds_read_b128 v[36:39], v2 offset:7168
ds_read_b128 v[40:43], v2 offset:8192
s_mov_b32 s20, 4
Lc_21:
s_waitcnt lgkmcnt(0)
v_mfma_f32_16x16x32_bf16 v[96:99], v[8:11], v[80:83], v[96:99]
ds_read_b128 v[44:47], v2 offset:9216
v_mfma_f32_16x16x32_bf16 v[100:103], v[8:11], v[84:87], v[100:103]
ds_read_b128 v[48:51], v2 offset:10240
v_mfma_f32_16x16x32_bf16 v[104:107], v[12:15], v[80:83], v[104:107]
ds_read_b128 v[52:55], v2 offset:11264
v_mfma_f32_16x16x32_bf16 v[108:111], v[12:15], v[84:87], v[108:111]
ds_read_b128 v[56:59], v2 offset:12288
v_mfma_f32_16x16x32_bf16 v[112:115], v[16:19], v[80:83], v[112:115]
ds_read_b128 v[60:63], v2 offset:13312
v_mfma_f32_16x16x32_bf16 v[116:119], v[16:19], v[84:87], v[116:119]
ds_read_b128 v[64:67], v2 offset:14336
v_mfma_f32_16x16x32_bf16 v[120:123], v[20:23], v[80:83], v[120:123]
ds_read_b128 v[68:71], v2 offset:15360
v_mfma_f32_16x16x32_bf16 v[124:127], v[20:23], v[84:87], v[124:127]
ds_read_b128 v[72:75], v2 offset:16384
v_mfma_f32_16x16x32_bf16 v[128:131], v[24:27], v[80:83], v[128:131]
ds_read_b128 v[76:79], v2 offset:17408
v_mfma_f32_16x16x32_bf16 v[132:135], v[24:27], v[84:87], v[132:135]
v_mfma_f32_16x16x32_bf16 v[136:139], v[28:31], v[80:83], v[136:139]
v_mfma_f32_16x16x32_bf16 v[140:143], v[28:31], v[84:87], v[140:143]
v_mfma_f32_16x16x32_bf16 v[144:147], v[32:35], v[80:83], v[144:147]
v_mfma_f32_16x16x32_bf16 v[148:151], v[32:35], v[84:87], v[148:151]
v_mfma_f32_16x16x32_bf16 v[152:155], v[36:39], v[80:83], v[152:155]
v_mfma_f32_16x16x32_bf16 v[156:159], v[36:39], v[84:87], v[156:159]
v_mfma_f32_16x16x32_bf16 v[160:163], v[40:43], v[80:83], v[160:163]
v_mfma_f32_16x16x32_bf16 v[164:167], v[40:43], v[84:87], v[164:167]
s_waitcnt lgkmcnt(0)
s_barrier
v_mfma_f32_16x16x32_bf16 v[168:171], v[80:83], v[44:47], v[168:171]
ds_read_b64_tr_b16 v[88:89], v4 offset:36864
v_mfma_f32_16x16x32_bf16 v[172:175], v[84:87], v[44:47], v[172:175]
ds_read_b64_tr_b16 v[90:91], v5 offset:36864
v_mfma_f32_16x16x32_bf16 v[176:179], v[80:83], v[48:51], v[176:179]
ds_read_b64_tr_b16 v[92:93], v4 offset:37376
v_mfma_f32_16x16x32_bf16 v[180:183], v[84:87], v[48:51], v[180:183]
ds_read_b64_tr_b16 v[94:95], v5 offset:37376
v_mfma_f32_16x16x32_bf16 v[184:187], v[80:83], v[52:55], v[184:187]
ds_read_b128 v[8:11], v2 offset:36864
v_mfma_f32_16x16x32_bf16 v[188:191], v[84:87], v[52:55], v[188:191]
ds_read_b128 v[12:15], v2 offset:37888
v_mfma_f32_16x16x32_bf16 v[192:195], v[80:83], v[56:59], v[192:195]
ds_read_b128 v[16:19], v2 offset:38912
v_mfma_f32_16x16x32_bf16 v[196:199], v[84:87], v[56:59], v[196:199]
ds_read_b128 v[20:23], v2 offset:39936
v_mfma_f32_16x16x32_bf16 v[200:203], v[80:83], v[60:63], v[200:203]
ds_read_b128 v[24:27], v2 offset:40960
v_mfma_f32_16x16x32_bf16 v[204:207], v[84:87], v[60:63], v[204:207]
ds_read_b128 v[28:31], v2 offset:41984
v_mfma_f32_16x16x32_bf16 v[208:211], v[80:83], v[64:67], v[208:211]
ds_read_b128 v[32:35], v2 offset:43008
v_mfma_f32_16x16x32_bf16 v[212:215], v[84:87], v[64:67], v[212:215]
ds_read_b128 v[36:39], v2 offset:44032
v_mfma_f32_16x16x32_bf16 v[216:219], v[80:83], v[68:71], v[216:219]
ds_read_b128 v[40:43], v2 offset:45056
v_mfma_f32_16x16x32_bf16 v[220:223], v[84:87], v[68:71], v[220:223]
v_mfma_f32_16x16x32_bf16 v[224:227], v[80:83], v[72:75], v[224:227]
v_mfma_f32_16x16x32_bf16 v[228:231], v[84:87], v[72:75], v[228:231]
v_mfma_f32_16x16x32_bf16 v[232:235], v[80:83], v[76:79], v[232:235]
v_mfma_f32_16x16x32_bf16 v[236:239], v[84:87], v[76:79], v[236:239]
s_waitcnt lgkmcnt(0)
v_mfma_f32_16x16x32_bf16 v[96:99], v[8:11], v[88:91], v[96:99]
ds_read_b128 v[44:47], v2 offset:46080
v_mfma_f32_16x16x32_bf16 v[100:103], v[8:11], v[92:95], v[100:103]
ds_read_b128 v[48:51], v2 offset:47104
v_mfma_f32_16x16x32_bf16 v[104:107], v[12:15], v[88:91], v[104:107]
ds_read_b128 v[52:55], v2 offset:48128
v_mfma_f32_16x16x32_bf16 v[108:111], v[12:15], v[92:95], v[108:111]
ds_read_b128 v[56:59], v2 offset:49152
v_mfma_f32_16x16x32_bf16 v[112:115], v[16:19], v[88:91], v[112:115]
ds_read_b128 v[60:63], v2 offset:50176
v_mfma_f32_16x16x32_bf16 v[116:119], v[16:19], v[92:95], v[116:119]
ds_read_b128 v[64:67], v2 offset:51200
v_mfma_f32_16x16x32_bf16 v[120:123], v[20:23], v[88:91], v[120:123]
ds_read_b128 v[68:71], v2 offset:52224
v_mfma_f32_16x16x32_bf16 v[124:127], v[20:23], v[92:95], v[124:127]
ds_read_b128 v[72:75], v2 offset:53248
v_mfma_f32_16x16x32_bf16 v[128:131], v[24:27], v[88:91], v[128:131]
ds_read_b128 v[76:79], v2 offset:54272
v_mfma_f32_16x16x32_bf16 v[132:135], v[24:27], v[92:95], v[132:135]
v_mfma_f32_16x16x32_bf16 v[136:139], v[28:31], v[88:91], v[136:139]
v_mfma_f32_16x16x32_bf16 v[140:143], v[28:31], v[92:95], v[140:143]
v_mfma_f32_16x16x32_bf16 v[144:147], v[32:35], v[88:91], v[144:147]
v_mfma_f32_16x16x32_bf16 v[148:151], v[32:35], v[92:95], v[148:151]
v_mfma_f32_16x16x32_bf16 v[152:155], v[36:39], v[88:91], v[152:155]
v_mfma_f32_16x16x32_bf16 v[156:159], v[36:39], v[92:95], v[156:159]
v_mfma_f32_16x16x32_bf16 v[160:163], v[40:43], v[88:91], v[160:163]
v_mfma_f32_16x16x32_bf16 v[164:167], v[40:43], v[92:95], v[164:167]
s_waitcnt lgkmcnt(0)
s_barrier
v_mfma_f32_16x16x32_bf16 v[168:171], v[88:91], v[44:47], v[168:171]
ds_read_b64_tr_b16 v[80:81], v6 offset:0
v_mfma_f32_16x16x32_bf16 v[172:175], v[92:95], v[44:47], v[172:175]
ds_read_b64_tr_b16 v[82:83], v7 offset:0
v_mfma_f32_16x16x32_bf16 v[176:179], v[88:91], v[48:51], v[176:179]
ds_read_b64_tr_b16 v[84:85], v6 offset:512
v_mfma_f32_16x16x32_bf16 v[180:183], v[92:95], v[48:51], v[180:183]
ds_read_b64_tr_b16 v[86:87], v7 offset:512
v_mfma_f32_16x16x32_bf16 v[184:187], v[88:91], v[52:55], v[184:187]
ds_read_b128 v[8:11], v3 offset:0
v_mfma_f32_16x16x32_bf16 v[188:191], v[92:95], v[52:55], v[188:191]
ds_read_b128 v[12:15], v3 offset:1024
v_mfma_f32_16x16x32_bf16 v[192:195], v[88:91], v[56:59], v[192:195]
ds_read_b128 v[16:19], v3 offset:2048
v_mfma_f32_16x16x32_bf16 v[196:199], v[92:95], v[56:59], v[196:199]
ds_read_b128 v[20:23], v3 offset:3072
v_mfma_f32_16x16x32_bf16 v[200:203], v[88:91], v[60:63], v[200:203]
ds_read_b128 v[24:27], v3 offset:4096
v_mfma_f32_16x16x32_bf16 v[204:207], v[92:95], v[60:63], v[204:207]
ds_read_b128 v[28:31], v3 offset:5120
v_mfma_f32_16x16x32_bf16 v[208:211], v[88:91], v[64:67], v[208:211]
ds_read_b128 v[32:35], v3 offset:6144
v_mfma_f32_16x16x32_bf16 v[212:215], v[92:95], v[64:67], v[212:215]
ds_read_b128 v[36:39], v3 offset:7168
v_mfma_f32_16x16x32_bf16 v[216:219], v[88:91], v[68:71], v[216:219]
ds_read_b128 v[40:43], v3 offset:8192
v_mfma_f32_16x16x32_bf16 v[220:223], v[92:95], v[68:71], v[220:223]
v_mfma_f32_16x16x32_bf16 v[224:227], v[88:91], v[72:75], v[224:227]
v_mfma_f32_16x16x32_bf16 v[228:231], v[92:95], v[72:75], v[228:231]
v_mfma_f32_16x16x32_bf16 v[232:235], v[88:91], v[76:79], v[232:235]
v_mfma_f32_16x16x32_bf16 v[236:239], v[92:95], v[76:79], v[236:239]
s_waitcnt lgkmcnt(0)
v_mfma_f32_16x16x32_bf16 v[96:99], v[8:11], v[80:83], v[96:99]
ds_read_b128 v[44:47], v3 offset:9216
v_mfma_f32_16x16x32_bf16 v[100:103], v[8:11], v[84:87], v[100:103]
ds_read_b128 v[48:51], v3 offset:10240
v_mfma_f32_16x16x32_bf16 v[104:107], v[12:15], v[80:83], v[104:107]
ds_read_b128 v[52:55], v3 offset:11264
v_mfma_f32_16x16x32_bf16 v[108:111], v[12:15], v[84:87], v[108:111]
ds_read_b128 v[56:59], v3 offset:12288
v_mfma_f32_16x16x32_bf16 v[112:115], v[16:19], v[80:83], v[112:115]
ds_read_b128 v[60:63], v3 offset:13312
v_mfma_f32_16x16x32_bf16 v[116:119], v[16:19], v[84:87], v[116:119]
ds_read_b128 v[64:67], v3 offset:14336
v_mfma_f32_16x16x32_bf16 v[120:123], v[20:23], v[80:83], v[120:123]
ds_read_b128 v[68:71], v3 offset:15360
v_mfma_f32_16x16x32_bf16 v[124:127], v[20:23], v[84:87], v[124:127]
ds_read_b128 v[72:75], v3 offset:16384
v_mfma_f32_16x16x32_bf16 v[128:131], v[24:27], v[80:83], v[128:131]
ds_read_b128 v[76:79], v3 offset:17408
v_mfma_f32_16x16x32_bf16 v[132:135], v[24:27], v[84:87], v[132:135]
v_mfma_f32_16x16x32_bf16 v[136:139], v[28:31], v[80:83], v[136:139]
v_mfma_f32_16x16x32_bf16 v[140:143], v[28:31], v[84:87], v[140:143]
v_mfma_f32_16x16x32_bf16 v[144:147], v[32:35], v[80:83], v[144:147]
v_mfma_f32_16x16x32_bf16 v[148:151], v[32:35], v[84:87], v[148:151]
v_mfma_f32_16x16x32_bf16 v[152:155], v[36:39], v[80:83], v[152:155]
v_mfma_f32_16x16x32_bf16 v[156:159], v[36:39], v[84:87], v[156:159]
v_mfma_f32_16x16x32_bf16 v[160:163], v[40:43], v[80:83], v[160:163]
v_mfma_f32_16x16x32_bf16 v[164:167], v[40:43], v[84:87], v[164:167]
s_waitcnt lgkmcnt(0)
s_barrier
v_mfma_f32_16x16x32_bf16 v[168:171], v[80:83], v[44:47], v[168:171]
ds_read_b64_tr_b16 v[88:89], v6 offset:36864
v_mfma_f32_16x16x32_bf16 v[172:175], v[84:87], v[44:47], v[172:175]
ds_read_b64_tr_b16 v[90:91], v7 offset:36864
v_mfma_f32_16x16x32_bf16 v[176:179], v[80:83], v[48:51], v[176:179]
ds_read_b64_tr_b16 v[92:93], v6 offset:37376
v_mfma_f32_16x16x32_bf16 v[180:183], v[84:87], v[48:51], v[180:183]
ds_read_b64_tr_b16 v[94:95], v7 offset:37376
v_mfma_f32_16x16x32_bf16 v[184:187], v[80:83], v[52:55], v[184:187]
ds_read_b128 v[8:11], v3 offset:36864
v_mfma_f32_16x16x32_bf16 v[188:191], v[84:87], v[52:55], v[188:191]
ds_read_b128 v[12:15], v3 offset:37888
v_mfma_f32_16x16x32_bf16 v[192:195], v[80:83], v[56:59], v[192:195]
ds_read_b128 v[16:19], v3 offset:38912
v_mfma_f32_16x16x32_bf16 v[196:199], v[84:87], v[56:59], v[196:199]
ds_read_b128 v[20:23], v3 offset:39936
v_mfma_f32_16x16x32_bf16 v[200:203], v[80:83], v[60:63], v[200:203]
ds_read_b128 v[24:27], v3 offset:40960
v_mfma_f32_16x16x32_bf16 v[204:207], v[84:87], v[60:63], v[204:207]
ds_read_b128 v[28:31], v3 offset:41984
v_mfma_f32_16x16x32_bf16 v[208:211], v[80:83], v[64:67], v[208:211]
ds_read_b128 v[32:35], v3 offset:43008
v_mfma_f32_16x16x32_bf16 v[212:215], v[84:87], v[64:67], v[212:215]
ds_read_b128 v[36:39], v3 offset:44032
v_mfma_f32_16x16x32_bf16 v[216:219], v[80:83], v[68:71], v[216:219]
ds_read_b128 v[40:43], v3 offset:45056
v_mfma_f32_16x16x32_bf16 v[220:223], v[84:87], v[68:71], v[220:223]
v_mfma_f32_16x16x32_bf16 v[224:227], v[80:83], v[72:75], v[224:227]
v_mfma_f32_16x16x32_bf16 v[228:231], v[84:87], v[72:75], v[228:231]
v_mfma_f32_16x16x32_bf16 v[232:235], v[80:83], v[76:79], v[232:235]
v_mfma_f32_16x16x32_bf16 v[236:239], v[84:87], v[76:79], v[236:239]
s_waitcnt lgkmcnt(0)
v_mfma_f32_16x16x32_bf16 v[96:99], v[8:11], v[88:91], v[96:99]
ds_read_b128 v[44:47], v3 offset:46080
v_mfma_f32_16x16x32_bf16 v[100:103], v[8:11], v[92:95], v[100:103]
ds_read_b128 v[48:51], v3 offset:47104
v_mfma_f32_16x16x32_bf16 v[104:107], v[12:15], v[88:91], v[104:107]
ds_read_b128 v[52:55], v3 offset:48128
v_mfma_f32_16x16x32_bf16 v[108:111], v[12:15], v[92:95], v[108:111]
ds_read_b128 v[56:59], v3 offset:49152
v_mfma_f32_16x16x32_bf16 v[112:115], v[16:19], v[88:91], v[112:115]
ds_read_b128 v[60:63], v3 offset:50176
v_mfma_f32_16x16x32_bf16 v[116:119], v[16:19], v[92:95], v[116:119]
ds_read_b128 v[64:67], v3 offset:51200
v_mfma_f32_16x16x32_bf16 v[120:123], v[20:23], v[88:91], v[120:123]
ds_read_b128 v[68:71], v3 offset:52224
v_mfma_f32_16x16x32_bf16 v[124:127], v[20:23], v[92:95], v[124:127]
ds_read_b128 v[72:75], v3 offset:53248
v_mfma_f32_16x16x32_bf16 v[128:131], v[24:27], v[88:91], v[128:131]
ds_read_b128 v[76:79], v3 offset:54272
v_mfma_f32_16x16x32_bf16 v[132:135], v[24:27], v[92:95], v[132:135]
v_mfma_f32_16x16x32_bf16 v[136:139], v[28:31], v[88:91], v[136:139]
v_mfma_f32_16x16x32_bf16 v[140:143], v[28:31], v[92:95], v[140:143]
v_mfma_f32_16x16x32_bf16 v[144:147], v[32:35], v[88:91], v[144:147]
v_mfma_f32_16x16x32_bf16 v[148:151], v[32:35], v[92:95], v[148:151]
v_mfma_f32_16x16x32_bf16 v[152:155], v[36:39], v[88:91], v[152:155]
v_mfma_f32_16x16x32_bf16 v[156:159], v[36:39], v[92:95], v[156:159]
v_mfma_f32_16x16x32_bf16 v[160:163], v[40:43], v[88:91], v[160:163]
v_mfma_f32_16x16x32_bf16 v[164:167], v[40:43], v[92:95], v[164:167]
s_waitcnt lgkmcnt(0)
s_barrier
v_mfma_f32_16x16x32_bf16 v[168:171], v[88:91], v[44:47], v[168:171]
ds_read_b64_tr_b16 v[80:81], v4 offset:0
v_mfma_f32_16x16x32_bf16 v[172:175], v[92:95], v[44:47], v[172:175]
ds_read_b64_tr_b16 v[82:83], v5 offset:0
v_mfma_f32_16x16x32_bf16 v[176:179], v[88:91], v[48:51], v[176:179]
ds_read_b64_tr_b16 v[84:85], v4 offset:512
v_mfma_f32_16x16x32_bf16 v[180:183], v[92:95], v[48:51], v[180:183]
ds_read_b64_tr_b16 v[86:87], v5 offset:512
v_mfma_f32_16x16x32_bf16 v[184:187], v[88:91], v[52:55], v[184:187]
ds_read_b128 v[8:11], v2 offset:0
v_mfma_f32_16x16x32_bf16 v[188:191], v[92:95], v[52:55], v[188:191]
ds_read_b128 v[12:15], v2 offset:1024
v_mfma_f32_16x16x32_bf16 v[192:195], v[88:91], v[56:59], v[192:195]
ds_read_b128 v[16:19], v2 offset:2048
v_mfma_f32_16x16x32_bf16 v[196:199], v[92:95], v[56:59], v[196:199]
ds_read_b128 v[20:23], v2 offset:3072
v_mfma_f32_16x16x32_bf16 v[200:203], v[88:91], v[60:63], v[200:203]
ds_read_b128 v[24:27], v2 offset:4096
v_mfma_f32_16x16x32_bf16 v[204:207], v[92:95], v[60:63], v[204:207]
ds_read_b128 v[28:31], v2 offset:5120
v_mfma_f32_16x16x32_bf16 v[208:211], v[88:91], v[64:67], v[208:211]
ds_read_b128 v[32:35], v2 offset:6144
v_mfma_f32_16x16x32_bf16 v[212:215], v[92:95], v[64:67], v[212:215]
ds_read_b128 v[36:39], v2 offset:7168
v_mfma_f32_16x16x32_bf16 v[216:219], v[88:91], v[68:71], v[216:219]
ds_read_b128 v[40:43], v2 offset:8192
v_mfma_f32_16x16x32_bf16 v[220:223], v[92:95], v[68:71], v[220:223]
v_mfma_f32_16x16x32_bf16 v[224:227], v[88:91], v[72:75], v[224:227]
v_mfma_f32_16x16x32_bf16 v[228:231], v[92:95], v[72:75], v[228:231]
v_mfma_f32_16x16x32_bf16 v[232:235], v[88:91], v[76:79], v[232:235]
v_mfma_f32_16x16x32_bf16 v[236:239], v[92:95], v[76:79], v[236:239]
s_sub_u32 s20, s20, 1
s_cmp_lg_u32 s20, 0
s_cbranch_scc1 Lc_21
s_waitcnt lgkmcnt(0)
v_mfma_f32_16x16x32_bf16 v[96:99], v[8:11], v[80:83], v[96:99]
ds_read_b128 v[44:47], v2 offset:9216
v_mfma_f32_16x16x32_bf16 v[100:103], v[8:11], v[84:87], v[100:103]
ds_read_b128 v[48:51], v2 offset:10240
v_mfma_f32_16x16x32_bf16 v[104:107], v[12:15], v[80:83], v[104:107]
ds_read_b128 v[52:55], v2 offset:11264
v_mfma_f32_16x16x32_bf16 v[108:111], v[12:15], v[84:87], v[108:111]
ds_read_b128 v[56:59], v2 offset:12288
v_mfma_f32_16x16x32_bf16 v[112:115], v[16:19], v[80:83], v[112:115]
ds_read_b128 v[60:63], v2 offset:13312
v_mfma_f32_16x16x32_bf16 v[116:119], v[16:19], v[84:87], v[116:119]
ds_read_b128 v[64:67], v2 offset:14336
v_mfma_f32_16x16x32_bf16 v[120:123], v[20:23], v[80:83], v[120:123]
ds_read_b128 v[68:71], v2 offset:15360
v_mfma_f32_16x16x32_bf16 v[124:127], v[20:23], v[84:87], v[124:127]
ds_read_b128 v[72:75], v2 offset:16384
v_mfma_f32_16x16x32_bf16 v[128:131], v[24:27], v[80:83], v[128:131]
ds_read_b128 v[76:79], v2 offset:17408
v_mfma_f32_16x16x32_bf16 v[132:135], v[24:27], v[84:87], v[132:135]
v_mfma_f32_16x16x32_bf16 v[136:139], v[28:31], v[80:83], v[136:139]
v_mfma_f32_16x16x32_bf16 v[140:143], v[28:31], v[84:87], v[140:143]
v_mfma_f32_16x16x32_bf16 v[144:147], v[32:35], v[80:83], v[144:147]
v_mfma_f32_16x16x32_bf16 v[148:151], v[32:35], v[84:87], v[148:151]
v_mfma_f32_16x16x32_bf16 v[152:155], v[36:39], v[80:83], v[152:155]
v_mfma_f32_16x16x32_bf16 v[156:159], v[36:39], v[84:87], v[156:159]
v_mfma_f32_16x16x32_bf16 v[160:163], v[40:43], v[80:83], v[160:163]
v_mfma_f32_16x16x32_bf16 v[164:167], v[40:43], v[84:87], v[164:167]
s_waitcnt lgkmcnt(0)
s_barrier
v_mfma_f32_16x16x32_bf16 v[168:171], v[80:83], v[44:47], v[168:171]
ds_read_b64_tr_b16 v[88:89], v4 offset:36864
v_mfma_f32_16x16x32_bf16 v[172:175], v[84:87], v[44:47], v[172:175]
ds_read_b64_tr_b16 v[90:91], v5 offset:36864
v_mfma_f32_16x16x32_bf16 v[176:179], v[80:83], v[48:51], v[176:179]
ds_read_b64_tr_b16 v[92:93], v4 offset:37376
v_mfma_f32_16x16x32_bf16 v[180:183], v[84:87], v[48:51], v[180:183]
ds_read_b64_tr_b16 v[94:95], v5 offset:37376
v_mfma_f32_16x16x32_bf16 v[184:187], v[80:83], v[52:55], v[184:187]
ds_read_b128 v[8:11], v2 offset:36864
v_mfma_f32_16x16x32_bf16 v[188:191], v[84:87], v[52:55], v[188:191]
ds_read_b128 v[12:15], v2 offset:37888
v_mfma_f32_16x16x32_bf16 v[192:195], v[80:83], v[56:59], v[192:195]
ds_read_b128 v[16:19], v2 offset:38912
v_mfma_f32_16x16x32_bf16 v[196:199], v[84:87], v[56:59], v[196:199]
ds_read_b128 v[20:23], v2 offset:39936
v_mfma_f32_16x16x32_bf16 v[200:203], v[80:83], v[60:63], v[200:203]
ds_read_b128 v[24:27], v2 offset:40960
v_mfma_f32_16x16x32_bf16 v[204:207], v[84:87], v[60:63], v[204:207]
ds_read_b128 v[28:31], v2 offset:41984
v_mfma_f32_16x16x32_bf16 v[208:211], v[80:83], v[64:67], v[208:211]
ds_read_b128 v[32:35], v2 offset:43008
v_mfma_f32_16x16x32_bf16 v[212:215], v[84:87], v[64:67], v[212:215]
ds_read_b128 v[36:39], v2 offset:44032
v_mfma_f32_16x16x32_bf16 v[216:219], v[80:83], v[68:71], v[216:219]
ds_read_b128 v[40:43], v2 offset:45056
v_mfma_f32_16x16x32_bf16 v[220:223], v[84:87], v[68:71], v[220:223]
v_mfma_f32_16x16x32_bf16 v[224:227], v[80:83], v[72:75], v[224:227]
v_mfma_f32_16x16x32_bf16 v[228:231], v[84:87], v[72:75], v[228:231]
v_mfma_f32_16x16x32_bf16 v[232:235], v[80:83], v[76:79], v[232:235]
v_mfma_f32_16x16x32_bf16 v[236:239], v[84:87], v[76:79], v[236:239]
s_waitcnt lgkmcnt(0)
v_mfma_f32_16x16x32_bf16 v[96:99], v[8:11], v[88:91], v[96:99]
ds_read_b128 v[44:47], v2 offset:46080
v_mfma_f32_16x16x32_bf16 v[100:103], v[8:11], v[92:95], v[100:103]
ds_read_b128 v[48:51], v2 offset:47104
v_mfma_f32_16x16x32_bf16 v[104:107], v[12:15], v[88:91], v[104:107]
ds_read_b128 v[52:55], v2 offset:48128
v_mfma_f32_16x16x32_bf16 v[108:111], v[12:15], v[92:95], v[108:111]
ds_read_b128 v[56:59], v2 offset:49152
v_mfma_f32_16x16x32_bf16 v[112:115], v[16:19], v[88:91], v[112:115]
ds_read_b128 v[60:63], v2 offset:50176
v_mfma_f32_16x16x32_bf16 v[116:119], v[16:19], v[92:95], v[116:119]
ds_read_b128 v[64:67], v2 offset:51200
v_mfma_f32_16x16x32_bf16 v[120:123], v[20:23], v[88:91], v[120:123]
ds_read_b128 v[68:71], v2 offset:52224
v_mfma_f32_16x16x32_bf16 v[124:127], v[20:23], v[92:95], v[124:127]
ds_read_b128 v[72:75], v2 offset:53248
v_mfma_f32_16x16x32_bf16 v[128:131], v[24:27], v[88:91], v[128:131]
ds_read_b128 v[76:79], v2 offset:54272
v_mfma_f32_16x16x32_bf16 v[132:135], v[24:27], v[92:95], v[132:135]
v_mfma_f32_16x16x32_bf16 v[136:139], v[28:31], v[88:91], v[136:139]
v_mfma_f32_16x16x32_bf16 v[140:143], v[28:31], v[92:95], v[140:143]
v_mfma_f32_16x16x32_bf16 v[144:147], v[32:35], v[88:91], v[144:147]
v_mfma_f32_16x16x32_bf16 v[148:151], v[32:35], v[92:95], v[148:151]
v_mfma_f32_16x16x32_bf16 v[152:155], v[36:39], v[88:91], v[152:155]
v_mfma_f32_16x16x32_bf16 v[156:159], v[36:39], v[92:95], v[156:159]
v_mfma_f32_16x16x32_bf16 v[160:163], v[40:43], v[88:91], v[160:163]
v_mfma_f32_16x16x32_bf16 v[164:167], v[40:43], v[92:95], v[164:167]
s_waitcnt lgkmcnt(0)
v_mfma_f32_16x16x32_bf16 v[168:171], v[88:91], v[44:47], v[168:171]
ds_write_b128 v254, v[100:103] offset:0
v_mfma_f32_16x16x32_bf16 v[172:175], v[92:95], v[44:47], v[172:175]
ds_write_b128 v254, v[108:111] offset:1024
v_mfma_f32_16x16x32_bf16 v[176:179], v[88:91], v[48:51], v[176:179]
ds_write_b128 v254, v[116:119] offset:2048
v_mfma_f32_16x16x32_bf16 v[180:183], v[92:95], v[48:51], v[180:183]
ds_write_b128 v254, v[124:127] offset:3072
v_mfma_f32_16x16x32_bf16 v[184:187], v[88:91], v[52:55], v[184:187]
ds_write_b128 v254, v[132:135] offset:4096
v_mfma_f32_16x16x32_bf16 v[188:191], v[92:95], v[52:55], v[188:191]
ds_write_b128 v254, v[140:143] offset:5120
v_mfma_f32_16x16x32_bf16 v[192:195], v[88:91], v[56:59], v[192:195]
ds_write_b128 v254, v[148:151] offset:6144
v_mfma_f32_16x16x32_bf16 v[196:199], v[92:95], v[56:59], v[196:199]
ds_write_b128 v254, v[156:159] offset:7168
v_mfma_f32_16x16x32_bf16 v[200:203], v[88:91], v[60:63], v[200:203]
ds_write_b128 v254, v[164:167] offset:8192
v_mfma_f32_16x16x32_bf16 v[204:207], v[92:95], v[60:63], v[204:207]
v_mfma_f32_16x16x32_bf16 v[208:211], v[88:91], v[64:67], v[208:211]
v_mfma_f32_16x16x32_bf16 v[212:215], v[92:95], v[64:67], v[212:215]
v_mfma_f32_16x16x32_bf16 v[216:219], v[88:91], v[68:71], v[216:219]
v_mfma_f32_16x16x32_bf16 v[220:223], v[92:95], v[68:71], v[220:223]
v_mfma_f32_16x16x32_bf16 v[224:227], v[88:91], v[72:75], v[224:227]
v_mfma_f32_16x16x32_bf16 v[228:231], v[92:95], v[72:75], v[228:231]
v_mfma_f32_16x16x32_bf16 v[232:235], v[88:91], v[76:79], v[232:235]
v_mfma_f32_16x16x32_bf16 v[236:239], v[92:95], v[76:79], v[236:239]
v_subrev_u32 v5, 36864, v254
s_waitcnt vmcnt(0) lgkmcnt(0)
s_barrier
v_pk_mul_f32 v[168:169], v[168:169], v[244:245]
v_pk_mul_f32 v[170:171], v[170:171], v[246:247]
v_cvt_pk_bf16_f32 v84, v168, v169
v_cvt_pk_bf16_f32 v85, v170, v171
v_pk_mul_f32 v[172:173], v[172:173], v[248:249]
v_pk_mul_f32 v[174:175], v[174:175], v[250:251]
v_cvt_pk_bf16_f32 v86, v172, v173
v_cvt_pk_bf16_f32 v87, v174, v175
ds_write_b128 v5, v[84:87] offset:0
v_pk_mul_f32 v[176:177], v[176:177], v[244:245]
v_pk_mul_f32 v[178:179], v[178:179], v[246:247]
v_cvt_pk_bf16_f32 v88, v176, v177
v_cvt_pk_bf16_f32 v89, v178, v179
v_pk_mul_f32 v[180:181], v[180:181], v[248:249]
v_pk_mul_f32 v[182:183], v[182:183], v[250:251]
v_cvt_pk_bf16_f32 v90, v180, v181
v_cvt_pk_bf16_f32 v91, v182, v183
ds_write_b128 v5, v[88:91] offset:1024
v_pk_mul_f32 v[184:185], v[184:185], v[244:245]
v_pk_mul_f32 v[186:187], v[186:187], v[246:247]
v_cvt_pk_bf16_f32 v92, v184, v185
v_cvt_pk_bf16_f32 v93, v186, v187
v_pk_mul_f32 v[188:189], v[188:189], v[248:249]
v_pk_mul_f32 v[190:191], v[190:191], v[250:251]
v_cvt_pk_bf16_f32 v94, v188, v189
v_cvt_pk_bf16_f32 v95, v190, v191
ds_write_b128 v5, v[92:95] offset:2048
v_pk_mul_f32 v[192:193], v[192:193], v[244:245]
v_pk_mul_f32 v[194:195], v[194:195], v[246:247]
v_cvt_pk_bf16_f32 v84, v192, v193
v_cvt_pk_bf16_f32 v85, v194, v195
v_pk_mul_f32 v[196:197], v[196:197], v[248:249]
v_pk_mul_f32 v[198:199], v[198:199], v[250:251]
v_cvt_pk_bf16_f32 v86, v196, v197
v_cvt_pk_bf16_f32 v87, v198, v199
ds_write_b128 v5, v[84:87] offset:3072
v_pk_mul_f32 v[200:201], v[200:201], v[244:245]
v_pk_mul_f32 v[202:203], v[202:203], v[246:247]
v_cvt_pk_bf16_f32 v88, v200, v201
v_cvt_pk_bf16_f32 v89, v202, v203
v_pk_mul_f32 v[204:205], v[204:205], v[248:249]
v_pk_mul_f32 v[206:207], v[206:207], v[250:251]
v_cvt_pk_bf16_f32 v90, v204, v205
v_cvt_pk_bf16_f32 v91, v206, v207
ds_write_b128 v5, v[88:91] offset:4096
v_pk_mul_f32 v[208:209], v[208:209], v[244:245]
v_pk_mul_f32 v[210:211], v[210:211], v[246:247]
v_cvt_pk_bf16_f32 v92, v208, v209
v_cvt_pk_bf16_f32 v93, v210, v211
v_pk_mul_f32 v[212:213], v[212:213], v[248:249]
v_pk_mul_f32 v[214:215], v[214:215], v[250:251]
v_cvt_pk_bf16_f32 v94, v212, v213
v_cvt_pk_bf16_f32 v95, v214, v215
ds_write_b128 v5, v[92:95] offset:5120
v_pk_mul_f32 v[216:217], v[216:217], v[244:245]
v_pk_mul_f32 v[218:219], v[218:219], v[246:247]
v_cvt_pk_bf16_f32 v84, v216, v217
v_cvt_pk_bf16_f32 v85, v218, v219
v_pk_mul_f32 v[220:221], v[220:221], v[248:249]
v_pk_mul_f32 v[222:223], v[222:223], v[250:251]
v_cvt_pk_bf16_f32 v86, v220, v221
v_cvt_pk_bf16_f32 v87, v222, v223
ds_write_b128 v5, v[84:87] offset:6144
v_pk_mul_f32 v[224:225], v[224:225], v[244:245]
v_pk_mul_f32 v[226:227], v[226:227], v[246:247]
v_cvt_pk_bf16_f32 v88, v224, v225
v_cvt_pk_bf16_f32 v89, v226, v227
v_pk_mul_f32 v[228:229], v[228:229], v[248:249]
v_pk_mul_f32 v[230:231], v[230:231], v[250:251]
v_cvt_pk_bf16_f32 v90, v228, v229
v_cvt_pk_bf16_f32 v91, v230, v231
ds_write_b128 v5, v[88:91] offset:7168
v_pk_mul_f32 v[232:233], v[232:233], v[244:245]
v_pk_mul_f32 v[234:235], v[234:235], v[246:247]
v_cvt_pk_bf16_f32 v92, v232, v233
v_cvt_pk_bf16_f32 v93, v234, v235
v_pk_mul_f32 v[236:237], v[236:237], v[248:249]
v_pk_mul_f32 v[238:239], v[238:239], v[250:251]
v_cvt_pk_bf16_f32 v94, v236, v237
v_cvt_pk_bf16_f32 v95, v238, v239
ds_write_b128 v5, v[92:95] offset:8192
K1_kvsm:
s_and_b32 s30, s16, 3
s_lshr_b32 s31, s16, 2
v_and_b32 v2, 15, v1
v_lshrrev_b32 v3, 4, v1
s_lshl_b32 s3, s30, 1
s_add_u32 s33, s3, s31
s_lshl_b32 s3, s33, 4
v_add_u32 v4, s3, v2
v_mul_u32_u24 v4, 608, v4
v_mul_u32_u24 v5, 144, v3
v_add_u32 v4, v4, v5
v_max3_f32 v44, v96, v97, v98
v_min3_f32 v46, v96, v97, v98
v_max3_f32 v44, v44, v99, v104
v_min3_f32 v46, v46, v99, v104
v_max3_f32 v44, v44, v105, v106
v_min3_f32 v46, v46, v105, v106
v_max3_f32 v44, v44, v107, v112
v_min3_f32 v46, v46, v107, v112
v_max3_f32 v44, v44, v113, v114
v_min3_f32 v46, v46, v113, v114
v_max3_f32 v44, v44, v115, v120
v_min3_f32 v46, v46, v115, v120
v_max3_f32 v44, v44, v121, v122
v_min3_f32 v46, v46, v121, v122
v_max3_f32 v44, v44, v123, v128
v_min3_f32 v46, v46, v123, v128
v_max_f32 v44, v44, v129
v_min_f32 v46, v46, v129
v_mul_f32 v44, v44, v240
v_mul_f32 v46, v46, v240
v_pk_fma_f32 v[8:9], v[96:97], v[240:241], v[44:45] op_sel_hi:[1,0,0] neg_lo:[0,0,1] neg_hi:[0,0,1]
v_pk_fma_f32 v[26:27], v[96:97], v[240:241], v[46:47] op_sel_hi:[1,0,0] neg_lo:[1,0,0] neg_hi:[1,0,0]
v_pk_fma_f32 v[10:11], v[98:99], v[240:241], v[44:45] op_sel_hi:[1,0,0] neg_lo:[0,0,1] neg_hi:[0,0,1]
v_pk_fma_f32 v[28:29], v[98:99], v[240:241], v[46:47] op_sel_hi:[1,0,0] neg_lo:[1,0,0] neg_hi:[1,0,0]
v_pk_fma_f32 v[12:13], v[104:105], v[240:241], v[44:45] op_sel_hi:[1,0,0] neg_lo:[0,0,1] neg_hi:[0,0,1]
v_pk_fma_f32 v[30:31], v[104:105], v[240:241], v[46:47] op_sel_hi:[1,0,0] neg_lo:[1,0,0] neg_hi:[1,0,0]
v_pk_fma_f32 v[14:15], v[106:107], v[240:241], v[44:45] op_sel_hi:[1,0,0] neg_lo:[0,0,1] neg_hi:[0,0,1]
v_pk_fma_f32 v[32:33], v[106:107], v[240:241], v[46:47] op_sel_hi:[1,0,0] neg_lo:[1,0,0] neg_hi:[1,0,0]
v_pk_fma_f32 v[16:17], v[112:113], v[240:241], v[44:45] op_sel_hi:[1,0,0] neg_lo:[0,0,1] neg_hi:[0,0,1]
v_pk_fma_f32 v[34:35], v[112:113], v[240:241], v[46:47] op_sel_hi:[1,0,0] neg_lo:[1,0,0] neg_hi:[1,0,0]
v_pk_fma_f32 v[18:19], v[114:115], v[240:241], v[44:45] op_sel_hi:[1,0,0] neg_lo:[0,0,1] neg_hi:[0,0,1]
v_pk_fma_f32 v[36:37], v[114:115], v[240:241], v[46:47] op_sel_hi:[1,0,0] neg_lo:[1,0,0] neg_hi:[1,0,0]
v_pk_fma_f32 v[20:21], v[120:121], v[240:241], v[44:45] op_sel_hi:[1,0,0] neg_lo:[0,0,1] neg_hi:[0,0,1]
v_pk_fma_f32 v[38:39], v[120:121], v[240:241], v[46:47] op_sel_hi:[1,0,0] neg_lo:[1,0,0] neg_hi:[1,0,0]
v_pk_fma_f32 v[22:23], v[122:123], v[240:241], v[44:45] op_sel_hi:[1,0,0] neg_lo:[0,0,1] neg_hi:[0,0,1]
v_pk_fma_f32 v[40:41], v[122:123], v[240:241], v[46:47] op_sel_hi:[1,0,0] neg_lo:[1,0,0] neg_hi:[1,0,0]
v_pk_fma_f32 v[24:25], v[128:129], v[240:241], v[44:45] op_sel_hi:[1,0,0] neg_lo:[0,0,1] neg_hi:[0,0,1]
v_pk_fma_f32 v[42:43], v[128:129], v[240:241], v[46:47] op_sel_hi:[1,0,0] neg_lo:[1,0,0] neg_hi:[1,0,0]
v_exp_f32 v8, v8
v_exp_f32 v9, v9
v_exp_f32 v10, v10
v_exp_f32 v11, v11
v_exp_f32 v12, v12
v_exp_f32 v13, v13
v_exp_f32 v14, v14
v_exp_f32 v15, v15
v_exp_f32 v16, v16
v_exp_f32 v17, v17
v_exp_f32 v18, v18
v_exp_f32 v19, v19
v_exp_f32 v20, v20
v_exp_f32 v21, v21
v_exp_f32 v22, v22
v_exp_f32 v23, v23
v_exp_f32 v24, v24
v_exp_f32 v25, v25
v_exp_f32 v26, v26
v_exp_f32 v27, v27
v_exp_f32 v28, v28
v_exp_f32 v29, v29
v_exp_f32 v30, v30
v_exp_f32 v31, v31
v_exp_f32 v32, v32
v_exp_f32 v33, v33
v_exp_f32 v34, v34
v_exp_f32 v35, v35
v_exp_f32 v36, v36
v_exp_f32 v37, v37
v_exp_f32 v38, v38
v_exp_f32 v39, v39
v_exp_f32 v40, v40
v_exp_f32 v41, v41
v_exp_f32 v42, v42
v_exp_f32 v43, v43
v_pk_add_f32 v[44:45], v[8:9], v[10:11]
v_pk_add_f32 v[46:47], v[26:27], v[28:29]
v_pk_add_f32 v[44:45], v[44:45], v[12:13]
v_pk_add_f32 v[46:47], v[46:47], v[30:31]
v_pk_add_f32 v[44:45], v[44:45], v[14:15]
v_pk_add_f32 v[46:47], v[46:47], v[32:33]
v_pk_add_f32 v[44:45], v[44:45], v[16:17]
v_pk_add_f32 v[46:47], v[46:47], v[34:35]
v_pk_add_f32 v[44:45], v[44:45], v[18:19]
v_pk_add_f32 v[46:47], v[46:47], v[36:37]
v_pk_add_f32 v[44:45], v[44:45], v[20:21]
v_pk_add_f32 v[46:47], v[46:47], v[38:39]
v_pk_add_f32 v[44:45], v[44:45], v[22:23]
v_pk_add_f32 v[46:47], v[46:47], v[40:41]
v_pk_add_f32 v[44:45], v[44:45], v[24:25]
v_pk_add_f32 v[46:47], v[46:47], v[42:43]
v_add_f32 v44, v44, v45
v_add_f32 v46, v46, v47
v_rcp_f32 v44, v44
v_rcp_f32 v46, v46
s_nop 0
v_pk_mul_f32 v[8:9], v[8:9], v[44:45] op_sel_hi:[1,0]
v_pk_mul_f32 v[26:27], v[26:27], v[46:47] op_sel_hi:[1,0]
v_pk_mul_f32 v[10:11], v[10:11], v[44:45] op_sel_hi:[1,0]
v_pk_mul_f32 v[28:29], v[28:29], v[46:47] op_sel_hi:[1,0]
v_pk_mul_f32 v[12:13], v[12:13], v[44:45] op_sel_hi:[1,0]
v_pk_mul_f32 v[30:31], v[30:31], v[46:47] op_sel_hi:[1,0]
v_pk_mul_f32 v[14:15], v[14:15], v[44:45] op_sel_hi:[1,0]
v_pk_mul_f32 v[32:33], v[32:33], v[46:47] op_sel_hi:[1,0]
v_pk_mul_f32 v[16:17], v[16:17], v[44:45] op_sel_hi:[1,0]
v_pk_mul_f32 v[34:35], v[34:35], v[46:47] op_sel_hi:[1,0]
v_pk_mul_f32 v[18:19], v[18:19], v[44:45] op_sel_hi:[1,0]
v_pk_mul_f32 v[36:37], v[36:37], v[46:47] op_sel_hi:[1,0]
v_pk_mul_f32 v[20:21], v[20:21], v[44:45] op_sel_hi:[1,0]
v_pk_mul_f32 v[38:39], v[38:39], v[46:47] op_sel_hi:[1,0]
v_pk_mul_f32 v[22:23], v[22:23], v[44:45] op_sel_hi:[1,0]
v_pk_mul_f32 v[40:41], v[40:41], v[46:47] op_sel_hi:[1,0]
v_pk_mul_f32 v[24:25], v[24:25], v[44:45] op_sel_hi:[1,0]
v_pk_mul_f32 v[42:43], v[42:43], v[46:47] op_sel_hi:[1,0]
v_cvt_pk_bf16_f32 v48, v8, v9
v_cvt_pk_bf16_f32 v49, v10, v11
v_cvt_pk_bf16_f32 v50, v12, v13
v_cvt_pk_bf16_f32 v51, v14, v15
v_cvt_pk_bf16_f32 v52, v16, v17
v_cvt_pk_bf16_f32 v53, v18, v19
v_cvt_pk_bf16_f32 v54, v20, v21
v_cvt_pk_bf16_f32 v55, v22, v23
v_cvt_pk_bf16_f32 v56, v24, v25
v_cvt_pk_bf16_f32 v57, v26, v27
v_cvt_pk_bf16_f32 v58, v28, v29
v_cvt_pk_bf16_f32 v59, v30, v31
v_cvt_pk_bf16_f32 v60, v32, v33
v_cvt_pk_bf16_f32 v61, v34, v35
v_cvt_pk_bf16_f32 v62, v36, v37
v_cvt_pk_bf16_f32 v63, v38, v39
v_cvt_pk_bf16_f32 v64, v40, v41
v_cvt_pk_bf16_f32 v65, v42, v43
ds_write_b128 v4, v[48:51] offset:0
ds_write_b128 v4, v[52:55] offset:16
ds_write_b128 v4, v[56:59] offset:32
ds_write_b128 v4, v[60:63] offset:48
v_max3_f32 v44, v130, v131, v136
v_min3_f32 v46, v130, v131, v136
v_max3_f32 v44, v44, v137, v138
v_min3_f32 v46, v46, v137, v138
v_max3_f32 v44, v44, v139, v144
v_min3_f32 v46, v46, v139, v144
v_max3_f32 v44, v44, v145, v146
v_min3_f32 v46, v46, v145, v146
v_max3_f32 v44, v44, v147, v152
v_min3_f32 v46, v46, v147, v152
v_max3_f32 v44, v44, v153, v154
v_min3_f32 v46, v46, v153, v154
v_max3_f32 v44, v44, v155, v160
v_min3_f32 v46, v46, v155, v160
v_max3_f32 v44, v44, v161, v162
v_min3_f32 v46, v46, v161, v162
v_max_f32 v44, v44, v163
v_min_f32 v46, v46, v163
v_mul_f32 v44, v44, v240
v_mul_f32 v46, v46, v240
v_pk_fma_f32 v[8:9], v[130:131], v[240:241], v[44:45] op_sel_hi:[1,0,0] neg_lo:[0,0,1] neg_hi:[0,0,1]
v_pk_fma_f32 v[26:27], v[130:131], v[240:241], v[46:47] op_sel_hi:[1,0,0] neg_lo:[1,0,0] neg_hi:[1,0,0]
v_pk_fma_f32 v[10:11], v[136:137], v[240:241], v[44:45] op_sel_hi:[1,0,0] neg_lo:[0,0,1] neg_hi:[0,0,1]
v_pk_fma_f32 v[28:29], v[136:137], v[240:241], v[46:47] op_sel_hi:[1,0,0] neg_lo:[1,0,0] neg_hi:[1,0,0]
v_pk_fma_f32 v[12:13], v[138:139], v[240:241], v[44:45] op_sel_hi:[1,0,0] neg_lo:[0,0,1] neg_hi:[0,0,1]
v_pk_fma_f32 v[30:31], v[138:139], v[240:241], v[46:47] op_sel_hi:[1,0,0] neg_lo:[1,0,0] neg_hi:[1,0,0]
v_pk_fma_f32 v[14:15], v[144:145], v[240:241], v[44:45] op_sel_hi:[1,0,0] neg_lo:[0,0,1] neg_hi:[0,0,1]
v_pk_fma_f32 v[32:33], v[144:145], v[240:241], v[46:47] op_sel_hi:[1,0,0] neg_lo:[1,0,0] neg_hi:[1,0,0]
v_pk_fma_f32 v[16:17], v[146:147], v[240:241], v[44:45] op_sel_hi:[1,0,0] neg_lo:[0,0,1] neg_hi:[0,0,1]
v_pk_fma_f32 v[34:35], v[146:147], v[240:241], v[46:47] op_sel_hi:[1,0,0] neg_lo:[1,0,0] neg_hi:[1,0,0]
v_pk_fma_f32 v[18:19], v[152:153], v[240:241], v[44:45] op_sel_hi:[1,0,0] neg_lo:[0,0,1] neg_hi:[0,0,1]
v_pk_fma_f32 v[36:37], v[152:153], v[240:241], v[46:47] op_sel_hi:[1,0,0] neg_lo:[1,0,0] neg_hi:[1,0,0]
v_pk_fma_f32 v[20:21], v[154:155], v[240:241], v[44:45] op_sel_hi:[1,0,0] neg_lo:[0,0,1] neg_hi:[0,0,1]
v_pk_fma_f32 v[38:39], v[154:155], v[240:241], v[46:47] op_sel_hi:[1,0,0] neg_lo:[1,0,0] neg_hi:[1,0,0]
v_pk_fma_f32 v[22:23], v[160:161], v[240:241], v[44:45] op_sel_hi:[1,0,0] neg_lo:[0,0,1] neg_hi:[0,0,1]
v_pk_fma_f32 v[40:41], v[160:161], v[240:241], v[46:47] op_sel_hi:[1,0,0] neg_lo:[1,0,0] neg_hi:[1,0,0]
v_pk_fma_f32 v[24:25], v[162:163], v[240:241], v[44:45] op_sel_hi:[1,0,0] neg_lo:[0,0,1] neg_hi:[0,0,1]
v_pk_fma_f32 v[42:43], v[162:163], v[240:241], v[46:47] op_sel_hi:[1,0,0] neg_lo:[1,0,0] neg_hi:[1,0,0]
v_exp_f32 v8, v8
v_exp_f32 v9, v9
v_exp_f32 v10, v10
v_exp_f32 v11, v11
v_exp_f32 v12, v12
v_exp_f32 v13, v13
v_exp_f32 v14, v14
v_exp_f32 v15, v15
v_exp_f32 v16, v16
v_exp_f32 v17, v17
v_exp_f32 v18, v18
v_exp_f32 v19, v19
v_exp_f32 v20, v20
v_exp_f32 v21, v21
v_exp_f32 v22, v22
v_exp_f32 v23, v23
v_exp_f32 v24, v24
v_exp_f32 v25, v25
v_exp_f32 v26, v26
v_exp_f32 v27, v27
v_exp_f32 v28, v28
v_exp_f32 v29, v29
v_exp_f32 v30, v30
v_exp_f32 v31, v31
v_exp_f32 v32, v32
v_exp_f32 v33, v33
v_exp_f32 v34, v34
v_exp_f32 v35, v35
v_exp_f32 v36, v36
v_exp_f32 v37, v37
v_exp_f32 v38, v38
v_exp_f32 v39, v39
v_exp_f32 v40, v40
v_exp_f32 v41, v41
v_exp_f32 v42, v42
v_exp_f32 v43, v43
v_pk_add_f32 v[44:45], v[8:9], v[10:11]
v_pk_add_f32 v[46:47], v[26:27], v[28:29]
v_pk_add_f32 v[44:45], v[44:45], v[12:13]
v_pk_add_f32 v[46:47], v[46:47], v[30:31]
v_pk_add_f32 v[44:45], v[44:45], v[14:15]
v_pk_add_f32 v[46:47], v[46:47], v[32:33]
v_pk_add_f32 v[44:45], v[44:45], v[16:17]
v_pk_add_f32 v[46:47], v[46:47], v[34:35]
v_pk_add_f32 v[44:45], v[44:45], v[18:19]
v_pk_add_f32 v[46:47], v[46:47], v[36:37]
v_pk_add_f32 v[44:45], v[44:45], v[20:21]
v_pk_add_f32 v[46:47], v[46:47], v[38:39]
v_pk_add_f32 v[44:45], v[44:45], v[22:23]
v_pk_add_f32 v[46:47], v[46:47], v[40:41]
v_pk_add_f32 v[44:45], v[44:45], v[24:25]
v_pk_add_f32 v[46:47], v[46:47], v[42:43]
v_add_f32 v44, v44, v45
v_add_f32 v46, v46, v47
v_rcp_f32 v44, v44
v_rcp_f32 v46, v46
s_nop 0
v_pk_mul_f32 v[8:9], v[8:9], v[44:45] op_sel_hi:[1,0]
v_pk_mul_f32 v[26:27], v[26:27], v[46:47] op_sel_hi:[1,0]
v_pk_mul_f32 v[10:11], v[10:11], v[44:45] op_sel_hi:[1,0]
v_pk_mul_f32 v[28:29], v[28:29], v[46:47] op_sel_hi:[1,0]
v_pk_mul_f32 v[12:13], v[12:13], v[44:45] op_sel_hi:[1,0]
v_pk_mul_f32 v[30:31], v[30:31], v[46:47] op_sel_hi:[1,0]
v_pk_mul_f32 v[14:15], v[14:15], v[44:45] op_sel_hi:[1,0]
v_pk_mul_f32 v[32:33], v[32:33], v[46:47] op_sel_hi:[1,0]
v_pk_mul_f32 v[16:17], v[16:17], v[44:45] op_sel_hi:[1,0]
v_pk_mul_f32 v[34:35], v[34:35], v[46:47] op_sel_hi:[1,0]
v_pk_mul_f32 v[18:19], v[18:19], v[44:45] op_sel_hi:[1,0]
v_pk_mul_f32 v[36:37], v[36:37], v[46:47] op_sel_hi:[1,0]
v_pk_mul_f32 v[20:21], v[20:21], v[44:45] op_sel_hi:[1,0]
v_pk_mul_f32 v[38:39], v[38:39], v[46:47] op_sel_hi:[1,0]
v_pk_mul_f32 v[22:23], v[22:23], v[44:45] op_sel_hi:[1,0]
v_pk_mul_f32 v[40:41], v[40:41], v[46:47] op_sel_hi:[1,0]
v_pk_mul_f32 v[24:25], v[24:25], v[44:45] op_sel_hi:[1,0]
v_pk_mul_f32 v[42:43], v[42:43], v[46:47] op_sel_hi:[1,0]
v_cvt_pk_bf16_f32 v66, v8, v9
v_cvt_pk_bf16_f32 v67, v10, v11
v_cvt_pk_bf16_f32 v68, v12, v13
v_cvt_pk_bf16_f32 v69, v14, v15
v_cvt_pk_bf16_f32 v70, v16, v17
v_cvt_pk_bf16_f32 v71, v18, v19
v_cvt_pk_bf16_f32 v72, v20, v21
v_cvt_pk_bf16_f32 v73, v22, v23
v_cvt_pk_bf16_f32 v74, v24, v25
v_cvt_pk_bf16_f32 v75, v26, v27
v_cvt_pk_bf16_f32 v76, v28, v29
v_cvt_pk_bf16_f32 v77, v30, v31
v_cvt_pk_bf16_f32 v78, v32, v33
v_cvt_pk_bf16_f32 v79, v34, v35
v_cvt_pk_bf16_f32 v80, v36, v37
v_cvt_pk_bf16_f32 v81, v38, v39
v_cvt_pk_bf16_f32 v82, v40, v41
v_cvt_pk_bf16_f32 v83, v42, v43
ds_write_b128 v4, v[64:67] offset:64
ds_write_b128 v4, v[68:71] offset:80
ds_write_b128 v4, v[72:75] offset:96
ds_write_b128 v4, v[76:79] offset:112
ds_write_b128 v4, v[80:83] offset:128
v_lshrrev_b32 v6, 2, v1
v_mul_u32_u24 v6, 608, v6
v_and_b32 v7, 3, v1
v_lshl_add_u32 v6, v7, 3, v6
s_mul_i32 s3, s33, 72
v_add_u32 v6, s3, v6
s_lshl_b32 s3, s30, 3
v_subrev_u32 v7, s3, v6
v_add_u32 v8, 38912, v6
v_add_u32 v9, 38912, v7
s_lshl_b32 s3, s33, 10
s_add_u32 s3, s3, 77824
v_lshlrev_b32 v10, 4, v1
v_add_u32 v10, s3, v10
v_lshlrev_b32 v11, 8, v3
v_and_b32 v12, 1, v2
v_lshl_add_u32 v11, v12, 4, v11
s_lshl_b32 s3, s33, 5
s_add_u32 s3, s3, 86016
v_add_u32 v11, s3, v11
s_mov_b32 s40, 0x00030003
s_mov_b32 s41, 0x00030003
v_mov_b32 v12, 0x3f803f80
s_add_u32 s36, s26, 17301504
s_addc_u32 s37, s27, 0
s_mov_b32 s38, 1572864
s_mov_b32 s39, 0x20000
s_lshl_b32 s17, s22, 2
s_add_u32 s17, s17, s23
s_mul_i32 s17, s17, 24576
s_lshl_b32 s3, s31, 10
s_add_u32 s19, s17, s3
s_add_u32 s29, s19, 22528
s_add_u32 s19, s19, 16384
s_lshr_b32 s18, s33, 2
s_lshl_b32 s18, s18, 11
s_and_b32 s3, s33, 3
s_lshl_b32 s3, s3, 8
s_add_u32 s18, s18, s3
s_add_u32 s28, s17, s18
s_add_u32 s28, s28, 18432
s_lshl_b32 s18, s33, 11
s_add_u32 s17, s17, s18
v_lshlrev_b32 v4, 6, v3
v_lshl_add_u32 v4, v2, 4, v4
v_lshlrev_b32 v2, 4, v1
s_lshl_b32 s18, s30, 4
s_lshl_b64 s[42:43], 0xffff, s18
s_mov_b32 s44, 0x000f000f
s_mov_b32 s45, 0x000f000f
s_waitcnt lgkmcnt(0)
s_barrier
ds_read_b128 v[112:115], v11 offset:0
ds_read_b128 v[108:111], v10 offset:0
ds_read_b64_tr_b16 v[96:97], v6 offset:0
ds_read_b64_tr_b16 v[98:99], v6 offset:9728
ds_read_b64_tr_b16 v[100:101], v6 offset:32
ds_read_b64_tr_b16 v[102:103], v6 offset:9760
ds_read_b64_tr_b16 v[104:105], v7 offset:64
ds_read_b64_tr_b16 v[106:107], v7 offset:9792
ds_read_b128 v[132:135], v11 offset:9216
ds_read_b128 v[128:131], v10 offset:9216
ds_read_b64_tr_b16 v[116:117], v6 offset:19456
ds_read_b64_tr_b16 v[118:119], v6 offset:29184
ds_read_b64_tr_b16 v[120:121], v6 offset:19488
ds_read_b64_tr_b16 v[122:123], v6 offset:29216
ds_read_b64_tr_b16 v[124:125], v7 offset:19520
ds_read_b64_tr_b16 v[126:127], v7 offset:29248
s_waitcnt lgkmcnt(8)
v_cndmask_b32 v112, v12, v112, s[40:41]
v_cndmask_b32 v113, v12, v113, s[40:41]
v_cndmask_b32 v114, v12, v114, s[40:41]
v_cndmask_b32 v115, v12, v115, s[40:41]
v_mfma_f32_16x16x32_bf16 v[16:19], v[96:99], v[108:111], 0
v_mfma_f32_16x16x32_bf16 v[20:23], v[100:103], v[108:111], 0
v_mfma_f32_16x16x32_bf16 v[24:27], v[104:107], v[108:111], 0
v_mfma_f32_16x16x32_bf16 v[28:31], v[96:99], v[112:115], 0
v_mfma_f32_16x16x32_bf16 v[32:35], v[100:103], v[112:115], 0
v_mfma_f32_16x16x32_bf16 v[36:39], v[104:107], v[112:115], 0
ds_read_b128 v[152:155], v11 offset:18432
ds_read_b128 v[148:151], v10 offset:18432
ds_read_b64_tr_b16 v[136:137], v8 offset:0
ds_read_b64_tr_b16 v[138:139], v8 offset:9728
ds_read_b64_tr_b16 v[140:141], v8 offset:32
ds_read_b64_tr_b16 v[142:143], v8 offset:9760
ds_read_b64_tr_b16 v[144:145], v9 offset:64
ds_read_b64_tr_b16 v[146:147], v9 offset:9792
s_waitcnt lgkmcnt(8)
v_cndmask_b32 v132, v12, v132, s[40:41]
v_cndmask_b32 v133, v12, v133, s[40:41]
v_cndmask_b32 v134, v12, v134, s[40:41]
v_cndmask_b32 v135, v12, v135, s[40:41]
v_mfma_f32_16x16x32_bf16 v[16:19], v[116:119], v[128:131], v[16:19]
v_mfma_f32_16x16x32_bf16 v[20:23], v[120:123], v[128:131], v[20:23]
v_mfma_f32_16x16x32_bf16 v[24:27], v[124:127], v[128:131], v[24:27]
v_mfma_f32_16x16x32_bf16 v[28:31], v[116:119], v[132:135], v[28:31]
v_mfma_f32_16x16x32_bf16 v[32:35], v[120:123], v[132:135], v[32:35]
v_mfma_f32_16x16x32_bf16 v[36:39], v[124:127], v[132:135], v[36:39]
ds_read_b128 v[172:175], v11 offset:27648
ds_read_b128 v[168:171], v10 offset:27648
ds_read_b64_tr_b16 v[156:157], v8 offset:19456
ds_read_b64_tr_b16 v[158:159], v8 offset:29184
ds_read_b64_tr_b16 v[160:161], v8 offset:19488
ds_read_b64_tr_b16 v[162:163], v8 offset:29216
ds_read_b64_tr_b16 v[164:165], v9 offset:19520
ds_read_b64_tr_b16 v[166:167], v9 offset:29248
s_waitcnt lgkmcnt(8)
v_cndmask_b32 v152, v12, v152, s[40:41]
v_cndmask_b32 v153, v12, v153, s[40:41]
v_cndmask_b32 v154, v12, v154, s[40:41]
v_cndmask_b32 v155, v12, v155, s[40:41]
v_mfma_f32_16x16x32_bf16 v[16:19], v[136:139], v[148:151], v[16:19]
v_mfma_f32_16x16x32_bf16 v[20:23], v[140:143], v[148:151], v[20:23]
v_mfma_f32_16x16x32_bf16 v[24:27], v[144:147], v[148:151], v[24:27]
v_mfma_f32_16x16x32_bf16 v[28:31], v[136:139], v[152:155], v[28:31]
v_mfma_f32_16x16x32_bf16 v[32:35], v[140:143], v[152:155], v[32:35]
v_mfma_f32_16x16x32_bf16 v[36:39], v[144:147], v[152:155], v[36:39]
s_waitcnt lgkmcnt(0)
v_cndmask_b32 v172, v12, v172, s[40:41]
v_cndmask_b32 v173, v12, v173, s[40:41]
v_cndmask_b32 v174, v12, v174, s[40:41]
v_cndmask_b32 v175, v12, v175, s[40:41]
v_mfma_f32_16x16x32_bf16 v[16:19], v[156:159], v[168:171], v[16:19]
v_mfma_f32_16x16x32_bf16 v[20:23], v[160:163], v[168:171], v[20:23]
v_mfma_f32_16x16x32_bf16 v[24:27], v[164:167], v[168:171], v[24:27]
v_mfma_f32_16x16x32_bf16 v[28:31], v[156:159], v[172:175], v[28:31]
v_mfma_f32_16x16x32_bf16 v[32:35], v[160:163], v[172:175], v[32:35]
v_mfma_f32_16x16x32_bf16 v[36:39], v[164:167], v[172:175], v[36:39]
s_nop 4
buffer_store_dwordx4 v[16:19], v2, s[36:39], s17 offen offset:0 sc1
buffer_store_dwordx4 v[20:23], v2, s[36:39], s17 offen offset:1024 sc1
s_mov_b64 exec, s[42:43]
buffer_store_dwordx4 v[24:27], v2, s[36:39], s19 offen sc1
s_mov_b64 exec, s[44:45]
buffer_store_dwordx4 v[28:31], v4, s[36:39], s28 offen offset:0 sc1
buffer_store_dwordx4 v[32:35], v4, s[36:39], s28 offen offset:1024 sc1
s_and_b64 exec, s[42:43], s[44:45]
buffer_store_dwordx4 v[36:39], v4, s[36:39], s29 offen sc1
s_mov_b64 exec, -1
s_lshl_b32 s17, s23, 4
s_add_u32 s17, s17, 1416
s_add_u32 s18, s17, s22
s_lshl_b32 s18, s18, 7
s_mov_b32 s49, 2147483648
s_add_u32 s44, s26, 19660800
s_addc_u32 s45, s27, 0
s_mov_b32 s46, 49152
s_mov_b32 s47, 0x20000
s_waitcnt vmcnt(0)
s_barrier
s_cmp_ge_u32 s16, 4
s_cbranch_scc1 K2_ld
s_cmp_lg_u32 s16, 0
s_cbranch_scc1 K2_c
v_mov_b32 v4, s100
v_mov_b32 v5, s101
v_mov_b32 v6, s18
s_mov_b64 exec, 1
buffer_store_dwordx2 v[4:5], v6, s[96:99], 0 offen sc1
s_mov_b64 exec, -1
s_cmp_ge_u32 s22, 12
s_cbranch_scc1 K2_c
v_and_b32 v3, 15, v1
v_add_lshl_u32 v3, v3, s17, 7
s_mov_b32 s63, 60000
Lp_22:
buffer_load_dwordx2 v[4:5], v3, s[96:99], 0 offen sc1
s_waitcnt vmcnt(0)
v_cmp_ne_u64 vcc, s[100:101], v[4:5]
s_sub_u32 s63, s63, 1
s_cbranch_scc1 Lx_23
s_nop 2
s_cbranch_vccz Lx_23
s_mov_b64 exec, vcc
s_branch Lp_22
Lx_23:
s_mov_b64 exec, -1
s_mul_i32 s18, s23, 12
s_add_u32 s18, s18, s22
s_add_u32 s49, s18, 1368
s_lshl_b32 s49, s49, 7
s_lshl_b32 s17, s18, 11
s_lshl_b32 s18, s18, 10
s_cmp_eq_u32 s22, 11
s_cselect_b64 exec, 0xffff, -1
buffer_load_dwordx4 v[8:11], v2, s[36:39], s17 offen sc1
buffer_load_dwordx4 v[12:15], v2, s[36:39], s17 offen offset:1024 sc1
s_add_u32 s17, s17, 98304
buffer_load_dwordx4 v[16:19], v2, s[36:39], s17 offen sc1
buffer_load_dwordx4 v[20:23], v2, s[36:39], s17 offen offset:1024 sc1
s_add_u32 s17, s17, 98304
buffer_load_dwordx4 v[24:27], v2, s[36:39], s17 offen sc1
buffer_load_dwordx4 v[28:31], v2, s[36:39], s17 offen offset:1024 sc1
s_add_u32 s17, s17, 98304
buffer_load_dwordx4 v[32:35], v2, s[36:39], s17 offen sc1
buffer_load_dwordx4 v[36:39], v2, s[36:39], s17 offen offset:1024 sc1
s_add_u32 s17, s17, 98304
buffer_load_dwordx4 v[40:43], v2, s[36:39], s17 offen sc1
buffer_load_dwordx4 v[44:47], v2, s[36:39], s17 offen offset:1024 sc1
s_add_u32 s17, s17, 98304
buffer_load_dwordx4 v[48:51], v2, s[36:39], s17 offen sc1
buffer_load_dwordx4 v[52:55], v2, s[36:39], s17 offen offset:1024 sc1
s_add_u32 s17, s17, 98304
buffer_load_dwordx4 v[56:59], v2, s[36:39], s17 offen sc1
buffer_load_dwordx4 v[60:63], v2, s[36:39], s17 offen offset:1024 sc1
s_add_u32 s17, s17, 98304
buffer_load_dwordx4 v[64:67], v2, s[36:39], s17 offen sc1
buffer_load_dwordx4 v[68:71], v2, s[36:39], s17 offen offset:1024 sc1
s_add_u32 s17, s17, 98304
buffer_load_dwordx4 v[72:75], v2, s[36:39], s17 offen sc1
buffer_load_dwordx4 v[76:79], v2, s[36:39], s17 offen offset:1024 sc1
s_add_u32 s17, s17, 98304
buffer_load_dwordx4 v[80:83], v2, s[36:39], s17 offen sc1
buffer_load_dwordx4 v[84:87], v2, s[36:39], s17 offen offset:1024 sc1
s_add_u32 s17, s17, 98304
buffer_load_dwordx4 v[88:91], v2, s[36:39], s17 offen sc1
buffer_load_dwordx4 v[92:95], v2, s[36:39], s17 offen offset:1024 sc1
s_add_u32 s17, s17, 98304
buffer_load_dwordx4 v[96:99], v2, s[36:39], s17 offen sc1
buffer_load_dwordx4 v[100:103], v2, s[36:39], s17 offen offset:1024 sc1
s_add_u32 s17, s17, 98304
buffer_load_dwordx4 v[104:107], v2, s[36:39], s17 offen sc1
buffer_load_dwordx4 v[108:111], v2, s[36:39], s17 offen offset:1024 sc1
s_add_u32 s17, s17, 98304
buffer_load_dwordx4 v[112:115], v2, s[36:39], s17 offen sc1
buffer_load_dwordx4 v[116:119], v2, s[36:39], s17 offen offset:1024 sc1
s_add_u32 s17, s17, 98304
buffer_load_dwordx4 v[120:123], v2, s[36:39], s17 offen sc1
buffer_load_dwordx4 v[124:127], v2, s[36:39], s17 offen offset:1024 sc1
s_add_u32 s17, s17, 98304
buffer_load_dwordx4 v[128:131], v2, s[36:39], s17 offen sc1
buffer_load_dwordx4 v[132:135], v2, s[36:39], s17 offen offset:1024 sc1
s_add_u32 s17, s17, 98304
s_waitcnt vmcnt(28)
v_pk_add_f32 v[8:9], v[8:9], v[16:17]
v_pk_add_f32 v[10:11], v[10:11], v[18:19]
v_pk_add_f32 v[12:13], v[12:13], v[20:21]
v_pk_add_f32 v[14:15], v[14:15], v[22:23]
s_waitcnt vmcnt(26)
v_pk_add_f32 v[8:9], v[8:9], v[24:25]
v_pk_add_f32 v[10:11], v[10:11], v[26:27]
v_pk_add_f32 v[12:13], v[12:13], v[28:29]
v_pk_add_f32 v[14:15], v[14:15], v[30:31]
s_waitcnt vmcnt(24)
v_pk_add_f32 v[8:9], v[8:9], v[32:33]
v_pk_add_f32 v[10:11], v[10:11], v[34:35]
v_pk_add_f32 v[12:13], v[12:13], v[36:37]
v_pk_add_f32 v[14:15], v[14:15], v[38:39]
s_waitcnt vmcnt(22)
v_pk_add_f32 v[8:9], v[8:9], v[40:41]
v_pk_add_f32 v[10:11], v[10:11], v[42:43]
v_pk_add_f32 v[12:13], v[12:13], v[44:45]
v_pk_add_f32 v[14:15], v[14:15], v[46:47]
s_waitcnt vmcnt(20)
v_pk_add_f32 v[8:9], v[8:9], v[48:49]
v_pk_add_f32 v[10:11], v[10:11], v[50:51]
v_pk_add_f32 v[12:13], v[12:13], v[52:53]
v_pk_add_f32 v[14:15], v[14:15], v[54:55]
s_waitcnt vmcnt(18)
v_pk_add_f32 v[8:9], v[8:9], v[56:57]
v_pk_add_f32 v[10:11], v[10:11], v[58:59]
v_pk_add_f32 v[12:13], v[12:13], v[60:61]
v_pk_add_f32 v[14:15], v[14:15], v[62:63]
s_waitcnt vmcnt(16)
v_pk_add_f32 v[8:9], v[8:9], v[64:65]
v_pk_add_f32 v[10:11], v[10:11], v[66:67]
v_pk_add_f32 v[12:13], v[12:13], v[68:69]
v_pk_add_f32 v[14:15], v[14:15], v[70:71]
s_waitcnt vmcnt(14)
v_pk_add_f32 v[8:9], v[8:9], v[72:73]
v_pk_add_f32 v[10:11], v[10:11], v[74:75]
v_pk_add_f32 v[12:13], v[12:13], v[76:77]
v_pk_add_f32 v[14:15], v[14:15], v[78:79]
s_waitcnt vmcnt(12)
v_pk_add_f32 v[8:9], v[8:9], v[80:81]
v_pk_add_f32 v[10:11], v[10:11], v[82:83]
v_pk_add_f32 v[12:13], v[12:13], v[84:85]
v_pk_add_f32 v[14:15], v[14:15], v[86:87]
s_waitcnt vmcnt(10)
v_pk_add_f32 v[8:9], v[8:9], v[88:89]
v_pk_add_f32 v[10:11], v[10:11], v[90:91]
v_pk_add_f32 v[12:13], v[12:13], v[92:93]
v_pk_add_f32 v[14:15], v[14:15], v[94:95]
s_waitcnt vmcnt(8)
v_pk_add_f32 v[8:9], v[8:9], v[96:97]
v_pk_add_f32 v[10:11], v[10:11], v[98:99]
v_pk_add_f32 v[12:13], v[12:13], v[100:101]
v_pk_add_f32 v[14:15], v[14:15], v[102:103]
s_waitcnt vmcnt(6)
v_pk_add_f32 v[8:9], v[8:9], v[104:105]
v_pk_add_f32 v[10:11], v[10:11], v[106:107]
v_pk_add_f32 v[12:13], v[12:13], v[108:109]
v_pk_add_f32 v[14:15], v[14:15], v[110:111]
s_waitcnt vmcnt(4)
v_pk_add_f32 v[8:9], v[8:9], v[112:113]
v_pk_add_f32 v[10:11], v[10:11], v[114:115]
v_pk_add_f32 v[12:13], v[12:13], v[116:117]
v_pk_add_f32 v[14:15], v[14:15], v[118:119]
s_waitcnt vmcnt(2)
v_pk_add_f32 v[8:9], v[8:9], v[120:121]
v_pk_add_f32 v[10:11], v[10:11], v[122:123]
v_pk_add_f32 v[12:13], v[12:13], v[124:125]
v_pk_add_f32 v[14:15], v[14:15], v[126:127]
s_waitcnt vmcnt(0)
v_pk_add_f32 v[8:9], v[8:9], v[128:129]
v_pk_add_f32 v[10:11], v[10:11], v[130:131]
v_pk_add_f32 v[12:13], v[12:13], v[132:133]
v_pk_add_f32 v[14:15], v[14:15], v[134:135]
v_cvt_pk_bf16_f32 v4, v8, v9
v_cvt_pk_bf16_f32 v5, v10, v11
v_cvt_pk_bf16_f32 v6, v12, v13
v_cvt_pk_bf16_f32 v7, v14, v15
buffer_store_dwordx4 v[4:7], v2, s[44:47], s18 offen sc1
s_mov_b64 exec, -1
s_waitcnt vmcnt(0)
v_mov_b32 v8, s100
v_mov_b32 v9, s101
v_mov_b32 v10, s49
s_mov_b64 exec, 1
buffer_store_dwordx2 v[8:9], v10, s[96:99], 0 offen sc1
s_mov_b64 exec, -1
s_mov_b32 s49, 2147483648
s_branch K2_c
K1_q:
s_barrier
buffer_load_dword v240, v252, s[32:35], s30 offen offset:0 sc1
buffer_load_dwordx4 v[244:247], v253, s[32:35], s30 offen offset:0 sc1
buffer_load_dword v242, v252, s[32:35], s30 offen offset:128 sc1
buffer_load_dwordx4 v[248:251], v253, s[32:35], s30 offen offset:128 sc1
ds_read_b64_tr_b16 v[80:81], v4 offset:0
ds_read_b64_tr_b16 v[82:83], v5 offset:0
ds_read_b64_tr_b16 v[84:85], v4 offset:512
ds_read_b64_tr_b16 v[86:87], v5 offset:512
ds_read_b128 v[8:11], v2 offset:0
ds_read_b128 v[12:15], v2 offset:1024
ds_read_b128 v[16:19], v2 offset:2048
ds_read_b128 v[20:23], v2 offset:3072
ds_read_b128 v[24:27], v2 offset:4096
ds_read_b128 v[28:31], v2 offset:5120
ds_read_b128 v[32:35], v2 offset:6144
ds_read_b128 v[36:39], v2 offset:7168
ds_read_b128 v[40:43], v2 offset:8192
s_mov_b32 s20, 4
Lc_24:
s_waitcnt lgkmcnt(0)
v_mfma_f32_16x16x32_bf16 v[96:99], v[8:11], v[80:83], v[96:99]
ds_read_b128 v[44:47], v2 offset:9216
v_mfma_f32_16x16x32_bf16 v[100:103], v[8:11], v[84:87], v[100:103]
ds_read_b128 v[48:51], v2 offset:10240
v_mfma_f32_16x16x32_bf16 v[104:107], v[12:15], v[80:83], v[104:107]
ds_read_b128 v[52:55], v2 offset:11264
v_mfma_f32_16x16x32_bf16 v[108:111], v[12:15], v[84:87], v[108:111]
ds_read_b128 v[56:59], v2 offset:12288
v_mfma_f32_16x16x32_bf16 v[112:115], v[16:19], v[80:83], v[112:115]
ds_read_b128 v[60:63], v2 offset:13312
v_mfma_f32_16x16x32_bf16 v[116:119], v[16:19], v[84:87], v[116:119]
ds_read_b128 v[64:67], v2 offset:14336
v_mfma_f32_16x16x32_bf16 v[120:123], v[20:23], v[80:83], v[120:123]
ds_read_b128 v[68:71], v2 offset:15360
v_mfma_f32_16x16x32_bf16 v[124:127], v[20:23], v[84:87], v[124:127]
ds_read_b128 v[72:75], v2 offset:16384
v_mfma_f32_16x16x32_bf16 v[128:131], v[24:27], v[80:83], v[128:131]
ds_read_b128 v[76:79], v2 offset:17408
v_mfma_f32_16x16x32_bf16 v[132:135], v[24:27], v[84:87], v[132:135]
v_mfma_f32_16x16x32_bf16 v[136:139], v[28:31], v[80:83], v[136:139]
v_mfma_f32_16x16x32_bf16 v[140:143], v[28:31], v[84:87], v[140:143]
v_mfma_f32_16x16x32_bf16 v[144:147], v[32:35], v[80:83], v[144:147]
v_mfma_f32_16x16x32_bf16 v[148:151], v[32:35], v[84:87], v[148:151]
v_mfma_f32_16x16x32_bf16 v[152:155], v[36:39], v[80:83], v[152:155]
v_mfma_f32_16x16x32_bf16 v[156:159], v[36:39], v[84:87], v[156:159]
v_mfma_f32_16x16x32_bf16 v[160:163], v[40:43], v[80:83], v[160:163]
v_mfma_f32_16x16x32_bf16 v[164:167], v[40:43], v[84:87], v[164:167]
s_waitcnt lgkmcnt(0)
s_barrier
v_mfma_f32_16x16x32_bf16 v[168:171], v[44:47], v[80:83], v[168:171]
ds_read_b64_tr_b16 v[88:89], v4 offset:36864
v_mfma_f32_16x16x32_bf16 v[172:175], v[44:47], v[84:87], v[172:175]
ds_read_b64_tr_b16 v[90:91], v5 offset:36864
v_mfma_f32_16x16x32_bf16 v[176:179], v[48:51], v[80:83], v[176:179]
ds_read_b64_tr_b16 v[92:93], v4 offset:37376
v_mfma_f32_16x16x32_bf16 v[180:183], v[48:51], v[84:87], v[180:183]
ds_read_b64_tr_b16 v[94:95], v5 offset:37376
v_mfma_f32_16x16x32_bf16 v[184:187], v[52:55], v[80:83], v[184:187]
ds_read_b128 v[8:11], v2 offset:36864
v_mfma_f32_16x16x32_bf16 v[188:191], v[52:55], v[84:87], v[188:191]
ds_read_b128 v[12:15], v2 offset:37888
v_mfma_f32_16x16x32_bf16 v[192:195], v[56:59], v[80:83], v[192:195]
ds_read_b128 v[16:19], v2 offset:38912
v_mfma_f32_16x16x32_bf16 v[196:199], v[56:59], v[84:87], v[196:199]
ds_read_b128 v[20:23], v2 offset:39936
v_mfma_f32_16x16x32_bf16 v[200:203], v[60:63], v[80:83], v[200:203]
ds_read_b128 v[24:27], v2 offset:40960
v_mfma_f32_16x16x32_bf16 v[204:207], v[60:63], v[84:87], v[204:207]
ds_read_b128 v[28:31], v2 offset:41984
v_mfma_f32_16x16x32_bf16 v[208:211], v[64:67], v[80:83], v[208:211]
ds_read_b128 v[32:35], v2 offset:43008
v_mfma_f32_16x16x32_bf16 v[212:215], v[64:67], v[84:87], v[212:215]
ds_read_b128 v[36:39], v2 offset:44032
v_mfma_f32_16x16x32_bf16 v[216:219], v[68:71], v[80:83], v[216:219]
ds_read_b128 v[40:43], v2 offset:45056
v_mfma_f32_16x16x32_bf16 v[220:223], v[68:71], v[84:87], v[220:223]
v_mfma_f32_16x16x32_bf16 v[224:227], v[72:75], v[80:83], v[224:227]
v_mfma_f32_16x16x32_bf16 v[228:231], v[72:75], v[84:87], v[228:231]
v_mfma_f32_16x16x32_bf16 v[232:235], v[76:79], v[80:83], v[232:235]
v_mfma_f32_16x16x32_bf16 v[236:239], v[76:79], v[84:87], v[236:239]
s_waitcnt lgkmcnt(0)
v_mfma_f32_16x16x32_bf16 v[96:99], v[8:11], v[88:91], v[96:99]
ds_read_b128 v[44:47], v2 offset:46080
v_mfma_f32_16x16x32_bf16 v[100:103], v[8:11], v[92:95], v[100:103]
ds_read_b128 v[48:51], v2 offset:47104
v_mfma_f32_16x16x32_bf16 v[104:107], v[12:15], v[88:91], v[104:107]
ds_read_b128 v[52:55], v2 offset:48128
v_mfma_f32_16x16x32_bf16 v[108:111], v[12:15], v[92:95], v[108:111]
ds_read_b128 v[56:59], v2 offset:49152
v_mfma_f32_16x16x32_bf16 v[112:115], v[16:19], v[88:91], v[112:115]
ds_read_b128 v[60:63], v2 offset:50176
v_mfma_f32_16x16x32_bf16 v[116:119], v[16:19], v[92:95], v[116:119]
ds_read_b128 v[64:67], v2 offset:51200
v_mfma_f32_16x16x32_bf16 v[120:123], v[20:23], v[88:91], v[120:123]
ds_read_b128 v[68:71], v2 offset:52224
v_mfma_f32_16x16x32_bf16 v[124:127], v[20:23], v[92:95], v[124:127]
ds_read_b128 v[72:75], v2 offset:53248
v_mfma_f32_16x16x32_bf16 v[128:131], v[24:27], v[88:91], v[128:131]
ds_read_b128 v[76:79], v2 offset:54272
v_mfma_f32_16x16x32_bf16 v[132:135], v[24:27], v[92:95], v[132:135]
v_mfma_f32_16x16x32_bf16 v[136:139], v[28:31], v[88:91], v[136:139]
v_mfma_f32_16x16x32_bf16 v[140:143], v[28:31], v[92:95], v[140:143]
v_mfma_f32_16x16x32_bf16 v[144:147], v[32:35], v[88:91], v[144:147]
v_mfma_f32_16x16x32_bf16 v[148:151], v[32:35], v[92:95], v[148:151]
v_mfma_f32_16x16x32_bf16 v[152:155], v[36:39], v[88:91], v[152:155]
v_mfma_f32_16x16x32_bf16 v[156:159], v[36:39], v[92:95], v[156:159]
v_mfma_f32_16x16x32_bf16 v[160:163], v[40:43], v[88:91], v[160:163]
v_mfma_f32_16x16x32_bf16 v[164:167], v[40:43], v[92:95], v[164:167]
s_waitcnt lgkmcnt(0)
s_barrier
v_mfma_f32_16x16x32_bf16 v[168:171], v[44:47], v[88:91], v[168:171]
ds_read_b64_tr_b16 v[80:81], v6 offset:0
v_mfma_f32_16x16x32_bf16 v[172:175], v[44:47], v[92:95], v[172:175]
ds_read_b64_tr_b16 v[82:83], v7 offset:0
v_mfma_f32_16x16x32_bf16 v[176:179], v[48:51], v[88:91], v[176:179]
ds_read_b64_tr_b16 v[84:85], v6 offset:512
v_mfma_f32_16x16x32_bf16 v[180:183], v[48:51], v[92:95], v[180:183]
ds_read_b64_tr_b16 v[86:87], v7 offset:512
v_mfma_f32_16x16x32_bf16 v[184:187], v[52:55], v[88:91], v[184:187]
ds_read_b128 v[8:11], v3 offset:0
v_mfma_f32_16x16x32_bf16 v[188:191], v[52:55], v[92:95], v[188:191]
ds_read_b128 v[12:15], v3 offset:1024
v_mfma_f32_16x16x32_bf16 v[192:195], v[56:59], v[88:91], v[192:195]
ds_read_b128 v[16:19], v3 offset:2048
v_mfma_f32_16x16x32_bf16 v[196:199], v[56:59], v[92:95], v[196:199]
ds_read_b128 v[20:23], v3 offset:3072
v_mfma_f32_16x16x32_bf16 v[200:203], v[60:63], v[88:91], v[200:203]
ds_read_b128 v[24:27], v3 offset:4096
v_mfma_f32_16x16x32_bf16 v[204:207], v[60:63], v[92:95], v[204:207]
ds_read_b128 v[28:31], v3 offset:5120
v_mfma_f32_16x16x32_bf16 v[208:211], v[64:67], v[88:91], v[208:211]
ds_read_b128 v[32:35], v3 offset:6144
v_mfma_f32_16x16x32_bf16 v[212:215], v[64:67], v[92:95], v[212:215]
ds_read_b128 v[36:39], v3 offset:7168
v_mfma_f32_16x16x32_bf16 v[216:219], v[68:71], v[88:91], v[216:219]
ds_read_b128 v[40:43], v3 offset:8192
v_mfma_f32_16x16x32_bf16 v[220:223], v[68:71], v[92:95], v[220:223]
v_mfma_f32_16x16x32_bf16 v[224:227], v[72:75], v[88:91], v[224:227]
v_mfma_f32_16x16x32_bf16 v[228:231], v[72:75], v[92:95], v[228:231]
v_mfma_f32_16x16x32_bf16 v[232:235], v[76:79], v[88:91], v[232:235]
v_mfma_f32_16x16x32_bf16 v[236:239], v[76:79], v[92:95], v[236:239]
s_waitcnt lgkmcnt(0)
v_mfma_f32_16x16x32_bf16 v[96:99], v[8:11], v[80:83], v[96:99]
ds_read_b128 v[44:47], v3 offset:9216
v_mfma_f32_16x16x32_bf16 v[100:103], v[8:11], v[84:87], v[100:103]
ds_read_b128 v[48:51], v3 offset:10240
v_mfma_f32_16x16x32_bf16 v[104:107], v[12:15], v[80:83], v[104:107]
ds_read_b128 v[52:55], v3 offset:11264
v_mfma_f32_16x16x32_bf16 v[108:111], v[12:15], v[84:87], v[108:111]
ds_read_b128 v[56:59], v3 offset:12288
v_mfma_f32_16x16x32_bf16 v[112:115], v[16:19], v[80:83], v[112:115]
ds_read_b128 v[60:63], v3 offset:13312
v_mfma_f32_16x16x32_bf16 v[116:119], v[16:19], v[84:87], v[116:119]
ds_read_b128 v[64:67], v3 offset:14336
v_mfma_f32_16x16x32_bf16 v[120:123], v[20:23], v[80:83], v[120:123]
ds_read_b128 v[68:71], v3 offset:15360
v_mfma_f32_16x16x32_bf16 v[124:127], v[20:23], v[84:87], v[124:127]
ds_read_b128 v[72:75], v3 offset:16384
v_mfma_f32_16x16x32_bf16 v[128:131], v[24:27], v[80:83], v[128:131]
ds_read_b128 v[76:79], v3 offset:17408
v_mfma_f32_16x16x32_bf16 v[132:135], v[24:27], v[84:87], v[132:135]
v_mfma_f32_16x16x32_bf16 v[136:139], v[28:31], v[80:83], v[136:139]
v_mfma_f32_16x16x32_bf16 v[140:143], v[28:31], v[84:87], v[140:143]
v_mfma_f32_16x16x32_bf16 v[144:147], v[32:35], v[80:83], v[144:147]
v_mfma_f32_16x16x32_bf16 v[148:151], v[32:35], v[84:87], v[148:151]
v_mfma_f32_16x16x32_bf16 v[152:155], v[36:39], v[80:83], v[152:155]
v_mfma_f32_16x16x32_bf16 v[156:159], v[36:39], v[84:87], v[156:159]
v_mfma_f32_16x16x32_bf16 v[160:163], v[40:43], v[80:83], v[160:163]
v_mfma_f32_16x16x32_bf16 v[164:167], v[40:43], v[84:87], v[164:167]
s_waitcnt lgkmcnt(0)
s_barrier
v_mfma_f32_16x16x32_bf16 v[168:171], v[44:47], v[80:83], v[168:171]
ds_read_b64_tr_b16 v[88:89], v6 offset:36864
v_mfma_f32_16x16x32_bf16 v[172:175], v[44:47], v[84:87], v[172:175]
ds_read_b64_tr_b16 v[90:91], v7 offset:36864
v_mfma_f32_16x16x32_bf16 v[176:179], v[48:51], v[80:83], v[176:179]
ds_read_b64_tr_b16 v[92:93], v6 offset:37376
v_mfma_f32_16x16x32_bf16 v[180:183], v[48:51], v[84:87], v[180:183]
ds_read_b64_tr_b16 v[94:95], v7 offset:37376
v_mfma_f32_16x16x32_bf16 v[184:187], v[52:55], v[80:83], v[184:187]
ds_read_b128 v[8:11], v3 offset:36864
v_mfma_f32_16x16x32_bf16 v[188:191], v[52:55], v[84:87], v[188:191]
ds_read_b128 v[12:15], v3 offset:37888
v_mfma_f32_16x16x32_bf16 v[192:195], v[56:59], v[80:83], v[192:195]
ds_read_b128 v[16:19], v3 offset:38912
v_mfma_f32_16x16x32_bf16 v[196:199], v[56:59], v[84:87], v[196:199]
ds_read_b128 v[20:23], v3 offset:39936
v_mfma_f32_16x16x32_bf16 v[200:203], v[60:63], v[80:83], v[200:203]
ds_read_b128 v[24:27], v3 offset:40960
v_mfma_f32_16x16x32_bf16 v[204:207], v[60:63], v[84:87], v[204:207]
ds_read_b128 v[28:31], v3 offset:41984
v_mfma_f32_16x16x32_bf16 v[208:211], v[64:67], v[80:83], v[208:211]
ds_read_b128 v[32:35], v3 offset:43008
v_mfma_f32_16x16x32_bf16 v[212:215], v[64:67], v[84:87], v[212:215]
ds_read_b128 v[36:39], v3 offset:44032
v_mfma_f32_16x16x32_bf16 v[216:219], v[68:71], v[80:83], v[216:219]
ds_read_b128 v[40:43], v3 offset:45056
v_mfma_f32_16x16x32_bf16 v[220:223], v[68:71], v[84:87], v[220:223]
v_mfma_f32_16x16x32_bf16 v[224:227], v[72:75], v[80:83], v[224:227]
v_mfma_f32_16x16x32_bf16 v[228:231], v[72:75], v[84:87], v[228:231]
v_mfma_f32_16x16x32_bf16 v[232:235], v[76:79], v[80:83], v[232:235]
v_mfma_f32_16x16x32_bf16 v[236:239], v[76:79], v[84:87], v[236:239]
s_waitcnt lgkmcnt(0)
v_mfma_f32_16x16x32_bf16 v[96:99], v[8:11], v[88:91], v[96:99]
ds_read_b128 v[44:47], v3 offset:46080
v_mfma_f32_16x16x32_bf16 v[100:103], v[8:11], v[92:95], v[100:103]
ds_read_b128 v[48:51], v3 offset:47104
v_mfma_f32_16x16x32_bf16 v[104:107], v[12:15], v[88:91], v[104:107]
ds_read_b128 v[52:55], v3 offset:48128
v_mfma_f32_16x16x32_bf16 v[108:111], v[12:15], v[92:95], v[108:111]
ds_read_b128 v[56:59], v3 offset:49152
v_mfma_f32_16x16x32_bf16 v[112:115], v[16:19], v[88:91], v[112:115]
ds_read_b128 v[60:63], v3 offset:50176
v_mfma_f32_16x16x32_bf16 v[116:119], v[16:19], v[92:95], v[116:119]
ds_read_b128 v[64:67], v3 offset:51200
v_mfma_f32_16x16x32_bf16 v[120:123], v[20:23], v[88:91], v[120:123]
ds_read_b128 v[68:71], v3 offset:52224
v_mfma_f32_16x16x32_bf16 v[124:127], v[20:23], v[92:95], v[124:127]
ds_read_b128 v[72:75], v3 offset:53248
v_mfma_f32_16x16x32_bf16 v[128:131], v[24:27], v[88:91], v[128:131]
ds_read_b128 v[76:79], v3 offset:54272
v_mfma_f32_16x16x32_bf16 v[132:135], v[24:27], v[92:95], v[132:135]
v_mfma_f32_16x16x32_bf16 v[136:139], v[28:31], v[88:91], v[136:139]
v_mfma_f32_16x16x32_bf16 v[140:143], v[28:31], v[92:95], v[140:143]
v_mfma_f32_16x16x32_bf16 v[144:147], v[32:35], v[88:91], v[144:147]
v_mfma_f32_16x16x32_bf16 v[148:151], v[32:35], v[92:95], v[148:151]
v_mfma_f32_16x16x32_bf16 v[152:155], v[36:39], v[88:91], v[152:155]
v_mfma_f32_16x16x32_bf16 v[156:159], v[36:39], v[92:95], v[156:159]
v_mfma_f32_16x16x32_bf16 v[160:163], v[40:43], v[88:91], v[160:163]
v_mfma_f32_16x16x32_bf16 v[164:167], v[40:43], v[92:95], v[164:167]
s_waitcnt lgkmcnt(0)
s_barrier
v_mfma_f32_16x16x32_bf16 v[168:171], v[44:47], v[88:91], v[168:171]
ds_read_b64_tr_b16 v[80:81], v4 offset:0
v_mfma_f32_16x16x32_bf16 v[172:175], v[44:47], v[92:95], v[172:175]
ds_read_b64_tr_b16 v[82:83], v5 offset:0
v_mfma_f32_16x16x32_bf16 v[176:179], v[48:51], v[88:91], v[176:179]
ds_read_b64_tr_b16 v[84:85], v4 offset:512
v_mfma_f32_16x16x32_bf16 v[180:183], v[48:51], v[92:95], v[180:183]
ds_read_b64_tr_b16 v[86:87], v5 offset:512
v_mfma_f32_16x16x32_bf16 v[184:187], v[52:55], v[88:91], v[184:187]
ds_read_b128 v[8:11], v2 offset:0
v_mfma_f32_16x16x32_bf16 v[188:191], v[52:55], v[92:95], v[188:191]
ds_read_b128 v[12:15], v2 offset:1024
v_mfma_f32_16x16x32_bf16 v[192:195], v[56:59], v[88:91], v[192:195]
ds_read_b128 v[16:19], v2 offset:2048
v_mfma_f32_16x16x32_bf16 v[196:199], v[56:59], v[92:95], v[196:199]
ds_read_b128 v[20:23], v2 offset:3072
v_mfma_f32_16x16x32_bf16 v[200:203], v[60:63], v[88:91], v[200:203]
ds_read_b128 v[24:27], v2 offset:4096
v_mfma_f32_16x16x32_bf16 v[204:207], v[60:63], v[92:95], v[204:207]
ds_read_b128 v[28:31], v2 offset:5120
v_mfma_f32_16x16x32_bf16 v[208:211], v[64:67], v[88:91], v[208:211]
ds_read_b128 v[32:35], v2 offset:6144
v_mfma_f32_16x16x32_bf16 v[212:215], v[64:67], v[92:95], v[212:215]
ds_read_b128 v[36:39], v2 offset:7168
v_mfma_f32_16x16x32_bf16 v[216:219], v[68:71], v[88:91], v[216:219]
ds_read_b128 v[40:43], v2 offset:8192
v_mfma_f32_16x16x32_bf16 v[220:223], v[68:71], v[92:95], v[220:223]
v_mfma_f32_16x16x32_bf16 v[224:227], v[72:75], v[88:91], v[224:227]
v_mfma_f32_16x16x32_bf16 v[228:231], v[72:75], v[92:95], v[228:231]
v_mfma_f32_16x16x32_bf16 v[232:235], v[76:79], v[88:91], v[232:235]
v_mfma_f32_16x16x32_bf16 v[236:239], v[76:79], v[92:95], v[236:239]
s_sub_u32 s20, s20, 1
s_cmp_lg_u32 s20, 0
s_cbranch_scc1 Lc_24
s_waitcnt lgkmcnt(0)
v_mfma_f32_16x16x32_bf16 v[96:99], v[8:11], v[80:83], v[96:99]
ds_read_b128 v[44:47], v2 offset:9216
v_mfma_f32_16x16x32_bf16 v[100:103], v[8:11], v[84:87], v[100:103]
ds_read_b128 v[48:51], v2 offset:10240
v_mfma_f32_16x16x32_bf16 v[104:107], v[12:15], v[80:83], v[104:107]
ds_read_b128 v[52:55], v2 offset:11264
v_mfma_f32_16x16x32_bf16 v[108:111], v[12:15], v[84:87], v[108:111]
ds_read_b128 v[56:59], v2 offset:12288
v_mfma_f32_16x16x32_bf16 v[112:115], v[16:19], v[80:83], v[112:115]
ds_read_b128 v[60:63], v2 offset:13312
v_mfma_f32_16x16x32_bf16 v[116:119], v[16:19], v[84:87], v[116:119]
ds_read_b128 v[64:67], v2 offset:14336
v_mfma_f32_16x16x32_bf16 v[120:123], v[20:23], v[80:83], v[120:123]
ds_read_b128 v[68:71], v2 offset:15360
v_mfma_f32_16x16x32_bf16 v[124:127], v[20:23], v[84:87], v[124:127]
ds_read_b128 v[72:75], v2 offset:16384
v_mfma_f32_16x16x32_bf16 v[128:131], v[24:27], v[80:83], v[128:131]
ds_read_b128 v[76:79], v2 offset:17408
v_mfma_f32_16x16x32_bf16 v[132:135], v[24:27], v[84:87], v[132:135]
v_mfma_f32_16x16x32_bf16 v[136:139], v[28:31], v[80:83], v[136:139]
v_mfma_f32_16x16x32_bf16 v[140:143], v[28:31], v[84:87], v[140:143]
v_mfma_f32_16x16x32_bf16 v[144:147], v[32:35], v[80:83], v[144:147]
v_mfma_f32_16x16x32_bf16 v[148:151], v[32:35], v[84:87], v[148:151]
v_mfma_f32_16x16x32_bf16 v[152:155], v[36:39], v[80:83], v[152:155]
v_mfma_f32_16x16x32_bf16 v[156:159], v[36:39], v[84:87], v[156:159]
v_mfma_f32_16x16x32_bf16 v[160:163], v[40:43], v[80:83], v[160:163]
v_mfma_f32_16x16x32_bf16 v[164:167], v[40:43], v[84:87], v[164:167]
s_waitcnt lgkmcnt(0)
s_barrier
v_mfma_f32_16x16x32_bf16 v[168:171], v[44:47], v[80:83], v[168:171]
ds_read_b64_tr_b16 v[88:89], v4 offset:36864
v_mfma_f32_16x16x32_bf16 v[172:175], v[44:47], v[84:87], v[172:175]
ds_read_b64_tr_b16 v[90:91], v5 offset:36864
v_mfma_f32_16x16x32_bf16 v[176:179], v[48:51], v[80:83], v[176:179]
ds_read_b64_tr_b16 v[92:93], v4 offset:37376
v_mfma_f32_16x16x32_bf16 v[180:183], v[48:51], v[84:87], v[180:183]
ds_read_b64_tr_b16 v[94:95], v5 offset:37376
v_mfma_f32_16x16x32_bf16 v[184:187], v[52:55], v[80:83], v[184:187]
ds_read_b128 v[8:11], v2 offset:36864
v_mfma_f32_16x16x32_bf16 v[188:191], v[52:55], v[84:87], v[188:191]
ds_read_b128 v[12:15], v2 offset:37888
v_mfma_f32_16x16x32_bf16 v[192:195], v[56:59], v[80:83], v[192:195]
ds_read_b128 v[16:19], v2 offset:38912
v_mfma_f32_16x16x32_bf16 v[196:199], v[56:59], v[84:87], v[196:199]
ds_read_b128 v[20:23], v2 offset:39936
v_mfma_f32_16x16x32_bf16 v[200:203], v[60:63], v[80:83], v[200:203]
ds_read_b128 v[24:27], v2 offset:40960
v_mfma_f32_16x16x32_bf16 v[204:207], v[60:63], v[84:87], v[204:207]
ds_read_b128 v[28:31], v2 offset:41984
v_mfma_f32_16x16x32_bf16 v[208:211], v[64:67], v[80:83], v[208:211]
ds_read_b128 v[32:35], v2 offset:43008
v_mfma_f32_16x16x32_bf16 v[212:215], v[64:67], v[84:87], v[212:215]
ds_read_b128 v[36:39], v2 offset:44032
v_mfma_f32_16x16x32_bf16 v[216:219], v[68:71], v[80:83], v[216:219]
ds_read_b128 v[40:43], v2 offset:45056
v_mfma_f32_16x16x32_bf16 v[220:223], v[68:71], v[84:87], v[220:223]
v_mfma_f32_16x16x32_bf16 v[224:227], v[72:75], v[80:83], v[224:227]
v_mfma_f32_16x16x32_bf16 v[228:231], v[72:75], v[84:87], v[228:231]
v_mfma_f32_16x16x32_bf16 v[232:235], v[76:79], v[80:83], v[232:235]
v_mfma_f32_16x16x32_bf16 v[236:239], v[76:79], v[84:87], v[236:239]
s_waitcnt lgkmcnt(0)
v_mfma_f32_16x16x32_bf16 v[96:99], v[8:11], v[88:91], v[96:99]
ds_read_b128 v[44:47], v2 offset:46080
v_mfma_f32_16x16x32_bf16 v[100:103], v[8:11], v[92:95], v[100:103]
ds_read_b128 v[48:51], v2 offset:47104
v_mfma_f32_16x16x32_bf16 v[104:107], v[12:15], v[88:91], v[104:107]
ds_read_b128 v[52:55], v2 offset:48128
v_mfma_f32_16x16x32_bf16 v[108:111], v[12:15], v[92:95], v[108:111]
ds_read_b128 v[56:59], v2 offset:49152
v_mfma_f32_16x16x32_bf16 v[112:115], v[16:19], v[88:91], v[112:115]
ds_read_b128 v[60:63], v2 offset:50176
v_mfma_f32_16x16x32_bf16 v[116:119], v[16:19], v[92:95], v[116:119]
ds_read_b128 v[64:67], v2 offset:51200
v_mfma_f32_16x16x32_bf16 v[120:123], v[20:23], v[88:91], v[120:123]
ds_read_b128 v[68:71], v2 offset:52224
v_mfma_f32_16x16x32_bf16 v[124:127], v[20:23], v[92:95], v[124:127]
ds_read_b128 v[72:75], v2 offset:53248
v_mfma_f32_16x16x32_bf16 v[128:131], v[24:27], v[88:91], v[128:131]
ds_read_b128 v[76:79], v2 offset:54272
v_mfma_f32_16x16x32_bf16 v[132:135], v[24:27], v[92:95], v[132:135]
v_mfma_f32_16x16x32_bf16 v[136:139], v[28:31], v[88:91], v[136:139]
v_mfma_f32_16x16x32_bf16 v[140:143], v[28:31], v[92:95], v[140:143]
v_mfma_f32_16x16x32_bf16 v[144:147], v[32:35], v[88:91], v[144:147]
v_mfma_f32_16x16x32_bf16 v[148:151], v[32:35], v[92:95], v[148:151]
v_mfma_f32_16x16x32_bf16 v[152:155], v[36:39], v[88:91], v[152:155]
v_mfma_f32_16x16x32_bf16 v[156:159], v[36:39], v[92:95], v[156:159]
v_mfma_f32_16x16x32_bf16 v[160:163], v[40:43], v[88:91], v[160:163]
v_mfma_f32_16x16x32_bf16 v[164:167], v[40:43], v[92:95], v[164:167]
s_waitcnt lgkmcnt(0)
v_mfma_f32_16x16x32_bf16 v[168:171], v[44:47], v[88:91], v[168:171]
v_mfma_f32_16x16x32_bf16 v[172:175], v[44:47], v[92:95], v[172:175]
v_mfma_f32_16x16x32_bf16 v[176:179], v[48:51], v[88:91], v[176:179]
v_mfma_f32_16x16x32_bf16 v[180:183], v[48:51], v[92:95], v[180:183]
v_mfma_f32_16x16x32_bf16 v[184:187], v[52:55], v[88:91], v[184:187]
v_mfma_f32_16x16x32_bf16 v[188:191], v[52:55], v[92:95], v[188:191]
v_mfma_f32_16x16x32_bf16 v[192:195], v[56:59], v[88:91], v[192:195]
v_mfma_f32_16x16x32_bf16 v[196:199], v[56:59], v[92:95], v[196:199]
v_mfma_f32_16x16x32_bf16 v[200:203], v[60:63], v[88:91], v[200:203]
v_mfma_f32_16x16x32_bf16 v[204:207], v[60:63], v[92:95], v[204:207]
v_mfma_f32_16x16x32_bf16 v[208:211], v[64:67], v[88:91], v[208:211]
v_mfma_f32_16x16x32_bf16 v[212:215], v[64:67], v[92:95], v[212:215]
v_mfma_f32_16x16x32_bf16 v[216:219], v[68:71], v[88:91], v[216:219]
v_mfma_f32_16x16x32_bf16 v[220:223], v[68:71], v[92:95], v[220:223]
v_mfma_f32_16x16x32_bf16 v[224:227], v[72:75], v[88:91], v[224:227]
v_mfma_f32_16x16x32_bf16 v[228:231], v[72:75], v[92:95], v[228:231]
v_mfma_f32_16x16x32_bf16 v[232:235], v[76:79], v[88:91], v[232:235]
v_mfma_f32_16x16x32_bf16 v[236:239], v[76:79], v[92:95], v[236:239]
s_waitcnt vmcnt(0)
s_barrier
v_and_b32 v6, 15, v1
v_lshrrev_b32 v7, 4, v1
v_lshlrev_b32 v3, 11, v7
v_lshl_add_u32 v3, v6, 4, v3
s_lshr_b32 s3, s16, 1
s_mul_i32 s3, s3, 18432
s_mul_i32 s17, s16, 9216
s_add_u32 s3, s3, s17
v_add_u32 v3, s3, v3
v_add_u32 v4, s3, v2
v_max3_f32 v44, v96, v97, v98
v_min3_f32 v46, v96, v97, v98
v_max3_f32 v44, v44, v99, v104
v_min3_f32 v46, v46, v99, v104
v_max3_f32 v44, v44, v105, v106
v_min3_f32 v46, v46, v105, v106
v_max3_f32 v44, v44, v107, v112
v_min3_f32 v46, v46, v107, v112
v_max3_f32 v44, v44, v113, v114
v_min3_f32 v46, v46, v113, v114
v_max3_f32 v44, v44, v115, v120
v_min3_f32 v46, v46, v115, v120
v_max3_f32 v44, v44, v121, v122
v_min3_f32 v46, v46, v121, v122
v_max3_f32 v44, v44, v123, v128
v_min3_f32 v46, v46, v123, v128
v_max_f32 v44, v44, v129
v_min_f32 v46, v46, v129
v_mul_f32 v44, v44, v240
v_mul_f32 v46, v46, v240
v_pk_fma_f32 v[8:9], v[96:97], v[240:241], v[44:45] op_sel_hi:[1,0,0] neg_lo:[0,0,1] neg_hi:[0,0,1]
v_pk_fma_f32 v[26:27], v[96:97], v[240:241], v[46:47] op_sel_hi:[1,0,0] neg_lo:[1,0,0] neg_hi:[1,0,0]
v_pk_fma_f32 v[10:11], v[98:99], v[240:241], v[44:45] op_sel_hi:[1,0,0] neg_lo:[0,0,1] neg_hi:[0,0,1]
v_pk_fma_f32 v[28:29], v[98:99], v[240:241], v[46:47] op_sel_hi:[1,0,0] neg_lo:[1,0,0] neg_hi:[1,0,0]
v_pk_fma_f32 v[12:13], v[104:105], v[240:241], v[44:45] op_sel_hi:[1,0,0] neg_lo:[0,0,1] neg_hi:[0,0,1]
v_pk_fma_f32 v[30:31], v[104:105], v[240:241], v[46:47] op_sel_hi:[1,0,0] neg_lo:[1,0,0] neg_hi:[1,0,0]
v_pk_fma_f32 v[14:15], v[106:107], v[240:241], v[44:45] op_sel_hi:[1,0,0] neg_lo:[0,0,1] neg_hi:[0,0,1]
v_pk_fma_f32 v[32:33], v[106:107], v[240:241], v[46:47] op_sel_hi:[1,0,0] neg_lo:[1,0,0] neg_hi:[1,0,0]
v_pk_fma_f32 v[16:17], v[112:113], v[240:241], v[44:45] op_sel_hi:[1,0,0] neg_lo:[0,0,1] neg_hi:[0,0,1]
v_pk_fma_f32 v[34:35], v[112:113], v[240:241], v[46:47] op_sel_hi:[1,0,0] neg_lo:[1,0,0] neg_hi:[1,0,0]
v_pk_fma_f32 v[18:19], v[114:115], v[240:241], v[44:45] op_sel_hi:[1,0,0] neg_lo:[0,0,1] neg_hi:[0,0,1]
v_pk_fma_f32 v[36:37], v[114:115], v[240:241], v[46:47] op_sel_hi:[1,0,0] neg_lo:[1,0,0] neg_hi:[1,0,0]
v_pk_fma_f32 v[20:21], v[120:121], v[240:241], v[44:45] op_sel_hi:[1,0,0] neg_lo:[0,0,1] neg_hi:[0,0,1]
v_pk_fma_f32 v[38:39], v[120:121], v[240:241], v[46:47] op_sel_hi:[1,0,0] neg_lo:[1,0,0] neg_hi:[1,0,0]
v_pk_fma_f32 v[22:23], v[122:123], v[240:241], v[44:45] op_sel_hi:[1,0,0] neg_lo:[0,0,1] neg_hi:[0,0,1]
v_pk_fma_f32 v[40:41], v[122:123], v[240:241], v[46:47] op_sel_hi:[1,0,0] neg_lo:[1,0,0] neg_hi:[1,0,0]
v_pk_fma_f32 v[24:25], v[128:129], v[240:241], v[44:45] op_sel_hi:[1,0,0] neg_lo:[0,0,1] neg_hi:[0,0,1]
v_pk_fma_f32 v[42:43], v[128:129], v[240:241], v[46:47] op_sel_hi:[1,0,0] neg_lo:[1,0,0] neg_hi:[1,0,0]
v_exp_f32 v8, v8
v_exp_f32 v9, v9
v_exp_f32 v10, v10
v_exp_f32 v11, v11
v_exp_f32 v12, v12
v_exp_f32 v13, v13
v_exp_f32 v14, v14
v_exp_f32 v15, v15
v_exp_f32 v16, v16
v_exp_f32 v17, v17
v_exp_f32 v18, v18
v_exp_f32 v19, v19
v_exp_f32 v20, v20
v_exp_f32 v21, v21
v_exp_f32 v22, v22
v_exp_f32 v23, v23
v_exp_f32 v24, v24
v_exp_f32 v25, v25
v_exp_f32 v26, v26
v_exp_f32 v27, v27
v_exp_f32 v28, v28
v_exp_f32 v29, v29
v_exp_f32 v30, v30
v_exp_f32 v31, v31
v_exp_f32 v32, v32
v_exp_f32 v33, v33
v_exp_f32 v34, v34
v_exp_f32 v35, v35
v_exp_f32 v36, v36
v_exp_f32 v37, v37
v_exp_f32 v38, v38
v_exp_f32 v39, v39
v_exp_f32 v40, v40
v_exp_f32 v41, v41
v_exp_f32 v42, v42
v_exp_f32 v43, v43
v_pk_add_f32 v[44:45], v[8:9], v[10:11]
v_pk_add_f32 v[46:47], v[26:27], v[28:29]
v_pk_add_f32 v[44:45], v[44:45], v[12:13]
v_pk_add_f32 v[46:47], v[46:47], v[30:31]
v_pk_add_f32 v[44:45], v[44:45], v[14:15]
v_pk_add_f32 v[46:47], v[46:47], v[32:33]
v_pk_add_f32 v[44:45], v[44:45], v[16:17]
v_pk_add_f32 v[46:47], v[46:47], v[34:35]
v_pk_add_f32 v[44:45], v[44:45], v[18:19]
v_pk_add_f32 v[46:47], v[46:47], v[36:37]
v_pk_add_f32 v[44:45], v[44:45], v[20:21]
v_pk_add_f32 v[46:47], v[46:47], v[38:39]
v_pk_add_f32 v[44:45], v[44:45], v[22:23]
v_pk_add_f32 v[46:47], v[46:47], v[40:41]
v_pk_add_f32 v[44:45], v[44:45], v[24:25]
v_pk_add_f32 v[46:47], v[46:47], v[42:43]
v_add_f32 v44, v44, v45
v_add_f32 v46, v46, v47
v_rcp_f32 v44, v44
v_rcp_f32 v46, v46
s_nop 0
v_pk_mul_f32 v[8:9], v[8:9], v[44:45] op_sel_hi:[1,0]
v_pk_mul_f32 v[26:27], v[26:27], v[46:47] op_sel_hi:[1,0]
v_pk_mul_f32 v[10:11], v[10:11], v[44:45] op_sel_hi:[1,0]
v_pk_mul_f32 v[28:29], v[28:29], v[46:47] op_sel_hi:[1,0]
v_pk_mul_f32 v[12:13], v[12:13], v[44:45] op_sel_hi:[1,0]
v_pk_mul_f32 v[30:31], v[30:31], v[46:47] op_sel_hi:[1,0]
v_pk_mul_f32 v[14:15], v[14:15], v[44:45] op_sel_hi:[1,0]
v_pk_mul_f32 v[32:33], v[32:33], v[46:47] op_sel_hi:[1,0]
v_pk_mul_f32 v[16:17], v[16:17], v[44:45] op_sel_hi:[1,0]
v_pk_mul_f32 v[34:35], v[34:35], v[46:47] op_sel_hi:[1,0]
v_pk_mul_f32 v[18:19], v[18:19], v[44:45] op_sel_hi:[1,0]
v_pk_mul_f32 v[36:37], v[36:37], v[46:47] op_sel_hi:[1,0]
v_pk_mul_f32 v[20:21], v[20:21], v[44:45] op_sel_hi:[1,0]
v_pk_mul_f32 v[38:39], v[38:39], v[46:47] op_sel_hi:[1,0]
v_pk_mul_f32 v[22:23], v[22:23], v[44:45] op_sel_hi:[1,0]
v_pk_mul_f32 v[40:41], v[40:41], v[46:47] op_sel_hi:[1,0]
v_pk_mul_f32 v[24:25], v[24:25], v[44:45] op_sel_hi:[1,0]
v_pk_mul_f32 v[42:43], v[42:43], v[46:47] op_sel_hi:[1,0]
v_cvt_pk_bf16_f32 v48, v8, v9
v_cvt_pk_bf16_f32 v49, v10, v11
v_cvt_pk_bf16_f32 v52, v12, v13
v_cvt_pk_bf16_f32 v53, v14, v15
v_cvt_pk_bf16_f32 v56, v16, v17
v_cvt_pk_bf16_f32 v57, v18, v19
v_cvt_pk_bf16_f32 v60, v20, v21
v_cvt_pk_bf16_f32 v61, v22, v23
v_cvt_pk_bf16_f32 v50, v24, v25
v_cvt_pk_bf16_f32 v51, v26, v27
v_cvt_pk_bf16_f32 v54, v28, v29
v_cvt_pk_bf16_f32 v55, v30, v31
v_cvt_pk_bf16_f32 v58, v32, v33
v_cvt_pk_bf16_f32 v59, v34, v35
v_cvt_pk_bf16_f32 v62, v36, v37
v_cvt_pk_bf16_f32 v63, v38, v39
v_cvt_pk_bf16_f32 v80, v40, v41
v_cvt_pk_bf16_f32 v81, v42, v43
ds_write_b128 v3, v[48:51] offset:0
ds_write_b128 v3, v[52:55] offset:256
ds_write_b128 v3, v[56:59] offset:512
ds_write_b128 v3, v[60:63] offset:768
v_max3_f32 v44, v130, v131, v136
v_min3_f32 v46, v130, v131, v136
v_max3_f32 v44, v44, v137, v138
v_min3_f32 v46, v46, v137, v138
v_max3_f32 v44, v44, v139, v144
v_min3_f32 v46, v46, v139, v144
v_max3_f32 v44, v44, v145, v146
v_min3_f32 v46, v46, v145, v146
v_max3_f32 v44, v44, v147, v152
v_min3_f32 v46, v46, v147, v152
v_max3_f32 v44, v44, v153, v154
v_min3_f32 v46, v46, v153, v154
v_max3_f32 v44, v44, v155, v160
v_min3_f32 v46, v46, v155, v160
v_max3_f32 v44, v44, v161, v162
v_min3_f32 v46, v46, v161, v162
v_max_f32 v44, v44, v163
v_min_f32 v46, v46, v163
v_mul_f32 v44, v44, v240
v_mul_f32 v46, v46, v240
v_pk_fma_f32 v[8:9], v[130:131], v[240:241], v[44:45] op_sel_hi:[1,0,0] neg_lo:[0,0,1] neg_hi:[0,0,1]
v_pk_fma_f32 v[26:27], v[130:131], v[240:241], v[46:47] op_sel_hi:[1,0,0] neg_lo:[1,0,0] neg_hi:[1,0,0]
v_pk_fma_f32 v[10:11], v[136:137], v[240:241], v[44:45] op_sel_hi:[1,0,0] neg_lo:[0,0,1] neg_hi:[0,0,1]
v_pk_fma_f32 v[28:29], v[136:137], v[240:241], v[46:47] op_sel_hi:[1,0,0] neg_lo:[1,0,0] neg_hi:[1,0,0]
v_pk_fma_f32 v[12:13], v[138:139], v[240:241], v[44:45] op_sel_hi:[1,0,0] neg_lo:[0,0,1] neg_hi:[0,0,1]
v_pk_fma_f32 v[30:31], v[138:139], v[240:241], v[46:47] op_sel_hi:[1,0,0] neg_lo:[1,0,0] neg_hi:[1,0,0]
v_pk_fma_f32 v[14:15], v[144:145], v[240:241], v[44:45] op_sel_hi:[1,0,0] neg_lo:[0,0,1] neg_hi:[0,0,1]
v_pk_fma_f32 v[32:33], v[144:145], v[240:241], v[46:47] op_sel_hi:[1,0,0] neg_lo:[1,0,0] neg_hi:[1,0,0]
v_pk_fma_f32 v[16:17], v[146:147], v[240:241], v[44:45] op_sel_hi:[1,0,0] neg_lo:[0,0,1] neg_hi:[0,0,1]
v_pk_fma_f32 v[34:35], v[146:147], v[240:241], v[46:47] op_sel_hi:[1,0,0] neg_lo:[1,0,0] neg_hi:[1,0,0]
v_pk_fma_f32 v[18:19], v[152:153], v[240:241], v[44:45] op_sel_hi:[1,0,0] neg_lo:[0,0,1] neg_hi:[0,0,1]
v_pk_fma_f32 v[36:37], v[152:153], v[240:241], v[46:47] op_sel_hi:[1,0,0] neg_lo:[1,0,0] neg_hi:[1,0,0]
v_pk_fma_f32 v[20:21], v[154:155], v[240:241], v[44:45] op_sel_hi:[1,0,0] neg_lo:[0,0,1] neg_hi:[0,0,1]
v_pk_fma_f32 v[38:39], v[154:155], v[240:241], v[46:47] op_sel_hi:[1,0,0] neg_lo:[1,0,0] neg_hi:[1,0,0]
v_pk_fma_f32 v[22:23], v[160:161], v[240:241], v[44:45] op_sel_hi:[1,0,0] neg_lo:[0,0,1] neg_hi:[0,0,1]
v_pk_fma_f32 v[40:41], v[160:161], v[240:241], v[46:47] op_sel_hi:[1,0,0] neg_lo:[1,0,0] neg_hi:[1,0,0]
v_pk_fma_f32 v[24:25], v[162:163], v[240:241], v[44:45] op_sel_hi:[1,0,0] neg_lo:[0,0,1] neg_hi:[0,0,1]
v_pk_fma_f32 v[42:43], v[162:163], v[240:241], v[46:47] op_sel_hi:[1,0,0] neg_lo:[1,0,0] neg_hi:[1,0,0]
v_exp_f32 v8, v8
v_exp_f32 v9, v9
v_exp_f32 v10, v10
v_exp_f32 v11, v11
v_exp_f32 v12, v12
v_exp_f32 v13, v13
v_exp_f32 v14, v14
v_exp_f32 v15, v15
v_exp_f32 v16, v16
v_exp_f32 v17, v17
v_exp_f32 v18, v18
v_exp_f32 v19, v19
v_exp_f32 v20, v20
v_exp_f32 v21, v21
v_exp_f32 v22, v22
v_exp_f32 v23, v23
v_exp_f32 v24, v24
v_exp_f32 v25, v25
v_exp_f32 v26, v26
v_exp_f32 v27, v27
v_exp_f32 v28, v28
v_exp_f32 v29, v29
v_exp_f32 v30, v30
v_exp_f32 v31, v31
v_exp_f32 v32, v32
v_exp_f32 v33, v33
v_exp_f32 v34, v34
v_exp_f32 v35, v35
v_exp_f32 v36, v36
v_exp_f32 v37, v37
v_exp_f32 v38, v38
v_exp_f32 v39, v39
v_exp_f32 v40, v40
v_exp_f32 v41, v41
v_exp_f32 v42, v42
v_exp_f32 v43, v43
v_pk_add_f32 v[44:45], v[8:9], v[10:11]
v_pk_add_f32 v[46:47], v[26:27], v[28:29]
v_pk_add_f32 v[44:45], v[44:45], v[12:13]
v_pk_add_f32 v[46:47], v[46:47], v[30:31]
v_pk_add_f32 v[44:45], v[44:45], v[14:15]
v_pk_add_f32 v[46:47], v[46:47], v[32:33]
v_pk_add_f32 v[44:45], v[44:45], v[16:17]
v_pk_add_f32 v[46:47], v[46:47], v[34:35]
v_pk_add_f32 v[44:45], v[44:45], v[18:19]
v_pk_add_f32 v[46:47], v[46:47], v[36:37]
v_pk_add_f32 v[44:45], v[44:45], v[20:21]
v_pk_add_f32 v[46:47], v[46:47], v[38:39]
v_pk_add_f32 v[44:45], v[44:45], v[22:23]
v_pk_add_f32 v[46:47], v[46:47], v[40:41]
v_pk_add_f32 v[44:45], v[44:45], v[24:25]
v_pk_add_f32 v[46:47], v[46:47], v[42:43]
v_add_f32 v44, v44, v45
v_add_f32 v46, v46, v47
v_rcp_f32 v44, v44
v_rcp_f32 v46, v46
s_nop 0
v_pk_mul_f32 v[8:9], v[8:9], v[44:45] op_sel_hi:[1,0]
v_pk_mul_f32 v[26:27], v[26:27], v[46:47] op_sel_hi:[1,0]
v_pk_mul_f32 v[10:11], v[10:11], v[44:45] op_sel_hi:[1,0]
v_pk_mul_f32 v[28:29], v[28:29], v[46:47] op_sel_hi:[1,0]
v_pk_mul_f32 v[12:13], v[12:13], v[44:45] op_sel_hi:[1,0]
v_pk_mul_f32 v[30:31], v[30:31], v[46:47] op_sel_hi:[1,0]
v_pk_mul_f32 v[14:15], v[14:15], v[44:45] op_sel_hi:[1,0]
v_pk_mul_f32 v[32:33], v[32:33], v[46:47] op_sel_hi:[1,0]
v_pk_mul_f32 v[16:17], v[16:17], v[44:45] op_sel_hi:[1,0]
v_pk_mul_f32 v[34:35], v[34:35], v[46:47] op_sel_hi:[1,0]
v_pk_mul_f32 v[18:19], v[18:19], v[44:45] op_sel_hi:[1,0]
v_pk_mul_f32 v[36:37], v[36:37], v[46:47] op_sel_hi:[1,0]
v_pk_mul_f32 v[20:21], v[20:21], v[44:45] op_sel_hi:[1,0]
v_pk_mul_f32 v[38:39], v[38:39], v[46:47] op_sel_hi:[1,0]
v_pk_mul_f32 v[22:23], v[22:23], v[44:45] op_sel_hi:[1,0]
v_pk_mul_f32 v[40:41], v[40:41], v[46:47] op_sel_hi:[1,0]
v_pk_mul_f32 v[24:25], v[24:25], v[44:45] op_sel_hi:[1,0]
v_pk_mul_f32 v[42:43], v[42:43], v[46:47] op_sel_hi:[1,0]
v_cvt_pk_bf16_f32 v64, v8, v9
v_cvt_pk_bf16_f32 v65, v10, v11
v_cvt_pk_bf16_f32 v68, v12, v13
v_cvt_pk_bf16_f32 v69, v14, v15
v_cvt_pk_bf16_f32 v72, v16, v17
v_cvt_pk_bf16_f32 v73, v18, v19
v_cvt_pk_bf16_f32 v76, v20, v21
v_cvt_pk_bf16_f32 v77, v22, v23
v_cvt_pk_bf16_f32 v66, v24, v25
v_cvt_pk_bf16_f32 v67, v26, v27
v_cvt_pk_bf16_f32 v70, v28, v29
v_cvt_pk_bf16_f32 v71, v30, v31
v_cvt_pk_bf16_f32 v74, v32, v33
v_cvt_pk_bf16_f32 v75, v34, v35
v_cvt_pk_bf16_f32 v78, v36, v37
v_cvt_pk_bf16_f32 v79, v38, v39
v_cvt_pk_bf16_f32 v82, v40, v41
v_cvt_pk_bf16_f32 v83, v42, v43
ds_write_b128 v3, v[64:67] offset:1024
ds_write_b128 v3, v[68:71] offset:1280
ds_write_b128 v3, v[72:75] offset:1536
ds_write_b128 v3, v[76:79] offset:1792
ds_read_b128 v[96:99], v4 offset:0
ds_read_b128 v[104:107], v4 offset:1024
ds_read_b128 v[112:115], v4 offset:2048
ds_read_b128 v[120:123], v4 offset:3072
ds_read_b128 v[128:131], v4 offset:4096
ds_read_b128 v[136:139], v4 offset:5120
ds_read_b128 v[144:147], v4 offset:6144
ds_read_b128 v[152:155], v4 offset:7168
v_pk_mov_b32 v[160:161], v[80:81], v[80:81] op_sel:[0,1]
v_pk_mov_b32 v[162:163], v[82:83], v[82:83] op_sel:[0,1]
v_max3_f32 v44, v100, v101, v102
v_min3_f32 v46, v100, v101, v102
v_max3_f32 v44, v44, v103, v108
v_min3_f32 v46, v46, v103, v108
v_max3_f32 v44, v44, v109, v110
v_min3_f32 v46, v46, v109, v110
v_max3_f32 v44, v44, v111, v116
v_min3_f32 v46, v46, v111, v116
v_max3_f32 v44, v44, v117, v118
v_min3_f32 v46, v46, v117, v118
v_max3_f32 v44, v44, v119, v124
v_min3_f32 v46, v46, v119, v124
v_max3_f32 v44, v44, v125, v126
v_min3_f32 v46, v46, v125, v126
v_max3_f32 v44, v44, v127, v132
v_min3_f32 v46, v46, v127, v132
v_max_f32 v44, v44, v133
v_min_f32 v46, v46, v133
v_mul_f32 v44, v44, v242
v_mul_f32 v46, v46, v242
v_pk_fma_f32 v[8:9], v[100:101], v[242:243], v[44:45] op_sel_hi:[1,0,0] neg_lo:[0,0,1] neg_hi:[0,0,1]
v_pk_fma_f32 v[26:27], v[100:101], v[242:243], v[46:47] op_sel_hi:[1,0,0] neg_lo:[1,0,0] neg_hi:[1,0,0]
v_pk_fma_f32 v[10:11], v[102:103], v[242:243], v[44:45] op_sel_hi:[1,0,0] neg_lo:[0,0,1] neg_hi:[0,0,1]
v_pk_fma_f32 v[28:29], v[102:103], v[242:243], v[46:47] op_sel_hi:[1,0,0] neg_lo:[1,0,0] neg_hi:[1,0,0]
v_pk_fma_f32 v[12:13], v[108:109], v[242:243], v[44:45] op_sel_hi:[1,0,0] neg_lo:[0,0,1] neg_hi:[0,0,1]
v_pk_fma_f32 v[30:31], v[108:109], v[242:243], v[46:47] op_sel_hi:[1,0,0] neg_lo:[1,0,0] neg_hi:[1,0,0]
v_pk_fma_f32 v[14:15], v[110:111], v[242:243], v[44:45] op_sel_hi:[1,0,0] neg_lo:[0,0,1] neg_hi:[0,0,1]
v_pk_fma_f32 v[32:33], v[110:111], v[242:243], v[46:47] op_sel_hi:[1,0,0] neg_lo:[1,0,0] neg_hi:[1,0,0]
v_pk_fma_f32 v[16:17], v[116:117], v[242:243], v[44:45] op_sel_hi:[1,0,0] neg_lo:[0,0,1] neg_hi:[0,0,1]
v_pk_fma_f32 v[34:35], v[116:117], v[242:243], v[46:47] op_sel_hi:[1,0,0] neg_lo:[1,0,0] neg_hi:[1,0,0]
v_pk_fma_f32 v[18:19], v[118:119], v[242:243], v[44:45] op_sel_hi:[1,0,0] neg_lo:[0,0,1] neg_hi:[0,0,1]
v_pk_fma_f32 v[36:37], v[118:119], v[242:243], v[46:47] op_sel_hi:[1,0,0] neg_lo:[1,0,0] neg_hi:[1,0,0]
v_pk_fma_f32 v[20:21], v[124:125], v[242:243], v[44:45] op_sel_hi:[1,0,0] neg_lo:[0,0,1] neg_hi:[0,0,1]
v_pk_fma_f32 v[38:39], v[124:125], v[242:243], v[46:47] op_sel_hi:[1,0,0] neg_lo:[1,0,0] neg_hi:[1,0,0]
v_pk_fma_f32 v[22:23], v[126:127], v[242:243], v[44:45] op_sel_hi:[1,0,0] neg_lo:[0,0,1] neg_hi:[0,0,1]
v_pk_fma_f32 v[40:41], v[126:127], v[242:243], v[46:47] op_sel_hi:[1,0,0] neg_lo:[1,0,0] neg_hi:[1,0,0]
v_pk_fma_f32 v[24:25], v[132:133], v[242:243], v[44:45] op_sel_hi:[1,0,0] neg_lo:[0,0,1] neg_hi:[0,0,1]
v_pk_fma_f32 v[42:43], v[132:133], v[242:243], v[46:47] op_sel_hi:[1,0,0] neg_lo:[1,0,0] neg_hi:[1,0,0]
v_exp_f32 v8, v8
v_exp_f32 v9, v9
v_exp_f32 v10, v10
v_exp_f32 v11, v11
v_exp_f32 v12, v12
v_exp_f32 v13, v13
v_exp_f32 v14, v14
v_exp_f32 v15, v15
v_exp_f32 v16, v16
v_exp_f32 v17, v17
v_exp_f32 v18, v18
v_exp_f32 v19, v19
v_exp_f32 v20, v20
v_exp_f32 v21, v21
v_exp_f32 v22, v22
v_exp_f32 v23, v23
v_exp_f32 v24, v24
v_exp_f32 v25, v25
v_exp_f32 v26, v26
v_exp_f32 v27, v27
v_exp_f32 v28, v28
v_exp_f32 v29, v29
v_exp_f32 v30, v30
v_exp_f32 v31, v31
v_exp_f32 v32, v32
v_exp_f32 v33, v33
v_exp_f32 v34, v34
v_exp_f32 v35, v35
v_exp_f32 v36, v36
v_exp_f32 v37, v37
v_exp_f32 v38, v38
v_exp_f32 v39, v39
v_exp_f32 v40, v40
v_exp_f32 v41, v41
v_exp_f32 v42, v42
v_exp_f32 v43, v43
v_pk_add_f32 v[44:45], v[8:9], v[10:11]
v_pk_add_f32 v[46:47], v[26:27], v[28:29]
v_pk_add_f32 v[44:45], v[44:45], v[12:13]
v_pk_add_f32 v[46:47], v[46:47], v[30:31]
v_pk_add_f32 v[44:45], v[44:45], v[14:15]
v_pk_add_f32 v[46:47], v[46:47], v[32:33]
v_pk_add_f32 v[44:45], v[44:45], v[16:17]
v_pk_add_f32 v[46:47], v[46:47], v[34:35]
v_pk_add_f32 v[44:45], v[44:45], v[18:19]
v_pk_add_f32 v[46:47], v[46:47], v[36:37]
v_pk_add_f32 v[44:45], v[44:45], v[20:21]
v_pk_add_f32 v[46:47], v[46:47], v[38:39]
v_pk_add_f32 v[44:45], v[44:45], v[22:23]
v_pk_add_f32 v[46:47], v[46:47], v[40:41]
v_pk_add_f32 v[44:45], v[44:45], v[24:25]
v_pk_add_f32 v[46:47], v[46:47], v[42:43]
v_add_f32 v44, v44, v45
v_add_f32 v46, v46, v47
v_rcp_f32 v44, v44
v_rcp_f32 v46, v46
s_nop 0
v_pk_mul_f32 v[8:9], v[8:9], v[44:45] op_sel_hi:[1,0]
v_pk_mul_f32 v[26:27], v[26:27], v[46:47] op_sel_hi:[1,0]
v_pk_mul_f32 v[10:11], v[10:11], v[44:45] op_sel_hi:[1,0]
v_pk_mul_f32 v[28:29], v[28:29], v[46:47] op_sel_hi:[1,0]
v_pk_mul_f32 v[12:13], v[12:13], v[44:45] op_sel_hi:[1,0]
v_pk_mul_f32 v[30:31], v[30:31], v[46:47] op_sel_hi:[1,0]
v_pk_mul_f32 v[14:15], v[14:15], v[44:45] op_sel_hi:[1,0]
v_pk_mul_f32 v[32:33], v[32:33], v[46:47] op_sel_hi:[1,0]
v_pk_mul_f32 v[16:17], v[16:17], v[44:45] op_sel_hi:[1,0]
v_pk_mul_f32 v[34:35], v[34:35], v[46:47] op_sel_hi:[1,0]
v_pk_mul_f32 v[18:19], v[18:19], v[44:45] op_sel_hi:[1,0]
v_pk_mul_f32 v[36:37], v[36:37], v[46:47] op_sel_hi:[1,0]
v_pk_mul_f32 v[20:21], v[20:21], v[44:45] op_sel_hi:[1,0]
v_pk_mul_f32 v[38:39], v[38:39], v[46:47] op_sel_hi:[1,0]
v_pk_mul_f32 v[22:23], v[22:23], v[44:45] op_sel_hi:[1,0]
v_pk_mul_f32 v[40:41], v[40:41], v[46:47] op_sel_hi:[1,0]
v_pk_mul_f32 v[24:25], v[24:25], v[44:45] op_sel_hi:[1,0]
v_pk_mul_f32 v[42:43], v[42:43], v[46:47] op_sel_hi:[1,0]
v_cvt_pk_bf16_f32 v48, v8, v9
v_cvt_pk_bf16_f32 v49, v10, v11
v_cvt_pk_bf16_f32 v52, v12, v13
v_cvt_pk_bf16_f32 v53, v14, v15
v_cvt_pk_bf16_f32 v56, v16, v17
v_cvt_pk_bf16_f32 v57, v18, v19
v_cvt_pk_bf16_f32 v60, v20, v21
v_cvt_pk_bf16_f32 v61, v22, v23
v_cvt_pk_bf16_f32 v50, v24, v25
v_cvt_pk_bf16_f32 v51, v26, v27
v_cvt_pk_bf16_f32 v54, v28, v29
v_cvt_pk_bf16_f32 v55, v30, v31
v_cvt_pk_bf16_f32 v58, v32, v33
v_cvt_pk_bf16_f32 v59, v34, v35
v_cvt_pk_bf16_f32 v62, v36, v37
v_cvt_pk_bf16_f32 v63, v38, v39
v_cvt_pk_bf16_f32 v80, v40, v41
v_cvt_pk_bf16_f32 v81, v42, v43
ds_write_b128 v3, v[48:51] offset:0
ds_write_b128 v3, v[52:55] offset:256
ds_write_b128 v3, v[56:59] offset:512
ds_write_b128 v3, v[60:63] offset:768
v_max3_f32 v44, v134, v135, v140
v_min3_f32 v46, v134, v135, v140
v_max3_f32 v44, v44, v141, v142
v_min3_f32 v46, v46, v141, v142
v_max3_f32 v44, v44, v143, v148
v_min3_f32 v46, v46, v143, v148
v_max3_f32 v44, v44, v149, v150
v_min3_f32 v46, v46, v149, v150
v_max3_f32 v44, v44, v151, v156
v_min3_f32 v46, v46, v151, v156
v_max3_f32 v44, v44, v157, v158
v_min3_f32 v46, v46, v157, v158
v_max3_f32 v44, v44, v159, v164
v_min3_f32 v46, v46, v159, v164
v_max3_f32 v44, v44, v165, v166
v_min3_f32 v46, v46, v165, v166
v_max_f32 v44, v44, v167
v_min_f32 v46, v46, v167
v_mul_f32 v44, v44, v242
v_mul_f32 v46, v46, v242
v_pk_fma_f32 v[8:9], v[134:135], v[242:243], v[44:45] op_sel_hi:[1,0,0] neg_lo:[0,0,1] neg_hi:[0,0,1]
v_pk_fma_f32 v[26:27], v[134:135], v[242:243], v[46:47] op_sel_hi:[1,0,0] neg_lo:[1,0,0] neg_hi:[1,0,0]
v_pk_fma_f32 v[10:11], v[140:141], v[242:243], v[44:45] op_sel_hi:[1,0,0] neg_lo:[0,0,1] neg_hi:[0,0,1]
v_pk_fma_f32 v[28:29], v[140:141], v[242:243], v[46:47] op_sel_hi:[1,0,0] neg_lo:[1,0,0] neg_hi:[1,0,0]
v_pk_fma_f32 v[12:13], v[142:143], v[242:243], v[44:45] op_sel_hi:[1,0,0] neg_lo:[0,0,1] neg_hi:[0,0,1]
v_pk_fma_f32 v[30:31], v[142:143], v[242:243], v[46:47] op_sel_hi:[1,0,0] neg_lo:[1,0,0] neg_hi:[1,0,0]
v_pk_fma_f32 v[14:15], v[148:149], v[242:243], v[44:45] op_sel_hi:[1,0,0] neg_lo:[0,0,1] neg_hi:[0,0,1]
v_pk_fma_f32 v[32:33], v[148:149], v[242:243], v[46:47] op_sel_hi:[1,0,0] neg_lo:[1,0,0] neg_hi:[1,0,0]
v_pk_fma_f32 v[16:17], v[150:151], v[242:243], v[44:45] op_sel_hi:[1,0,0] neg_lo:[0,0,1] neg_hi:[0,0,1]
v_pk_fma_f32 v[34:35], v[150:151], v[242:243], v[46:47] op_sel_hi:[1,0,0] neg_lo:[1,0,0] neg_hi:[1,0,0]
v_pk_fma_f32 v[18:19], v[156:157], v[242:243], v[44:45] op_sel_hi:[1,0,0] neg_lo:[0,0,1] neg_hi:[0,0,1]
v_pk_fma_f32 v[36:37], v[156:157], v[242:243], v[46:47] op_sel_hi:[1,0,0] neg_lo:[1,0,0] neg_hi:[1,0,0]
v_pk_fma_f32 v[20:21], v[158:159], v[242:243], v[44:45] op_sel_hi:[1,0,0] neg_lo:[0,0,1] neg_hi:[0,0,1]
v_pk_fma_f32 v[38:39], v[158:159], v[242:243], v[46:47] op_sel_hi:[1,0,0] neg_lo:[1,0,0] neg_hi:[1,0,0]
v_pk_fma_f32 v[22:23], v[164:165], v[242:243], v[44:45] op_sel_hi:[1,0,0] neg_lo:[0,0,1] neg_hi:[0,0,1]
v_pk_fma_f32 v[40:41], v[164:165], v[242:243], v[46:47] op_sel_hi:[1,0,0] neg_lo:[1,0,0] neg_hi:[1,0,0]
v_pk_fma_f32 v[24:25], v[166:167], v[242:243], v[44:45] op_sel_hi:[1,0,0] neg_lo:[0,0,1] neg_hi:[0,0,1]
v_pk_fma_f32 v[42:43], v[166:167], v[242:243], v[46:47] op_sel_hi:[1,0,0] neg_lo:[1,0,0] neg_hi:[1,0,0]
v_exp_f32 v8, v8
v_exp_f32 v9, v9
v_exp_f32 v10, v10
v_exp_f32 v11, v11
v_exp_f32 v12, v12
v_exp_f32 v13, v13
v_exp_f32 v14, v14
v_exp_f32 v15, v15
v_exp_f32 v16, v16
v_exp_f32 v17, v17
v_exp_f32 v18, v18
v_exp_f32 v19, v19
v_exp_f32 v20, v20
v_exp_f32 v21, v21
v_exp_f32 v22, v22
v_exp_f32 v23, v23
v_exp_f32 v24, v24
v_exp_f32 v25, v25
v_exp_f32 v26, v26
v_exp_f32 v27, v27
v_exp_f32 v28, v28
v_exp_f32 v29, v29
v_exp_f32 v30, v30
v_exp_f32 v31, v31
v_exp_f32 v32, v32
v_exp_f32 v33, v33
v_exp_f32 v34, v34
v_exp_f32 v35, v35
v_exp_f32 v36, v36
v_exp_f32 v37, v37
v_exp_f32 v38, v38
v_exp_f32 v39, v39
v_exp_f32 v40, v40
v_exp_f32 v41, v41
v_exp_f32 v42, v42
v_exp_f32 v43, v43
v_pk_add_f32 v[44:45], v[8:9], v[10:11]
v_pk_add_f32 v[46:47], v[26:27], v[28:29]
v_pk_add_f32 v[44:45], v[44:45], v[12:13]
v_pk_add_f32 v[46:47], v[46:47], v[30:31]
v_pk_add_f32 v[44:45], v[44:45], v[14:15]
v_pk_add_f32 v[46:47], v[46:47], v[32:33]
v_pk_add_f32 v[44:45], v[44:45], v[16:17]
v_pk_add_f32 v[46:47], v[46:47], v[34:35]
v_pk_add_f32 v[44:45], v[44:45], v[18:19]
v_pk_add_f32 v[46:47], v[46:47], v[36:37]
v_pk_add_f32 v[44:45], v[44:45], v[20:21]
v_pk_add_f32 v[46:47], v[46:47], v[38:39]
v_pk_add_f32 v[44:45], v[44:45], v[22:23]
v_pk_add_f32 v[46:47], v[46:47], v[40:41]
v_pk_add_f32 v[44:45], v[44:45], v[24:25]
v_pk_add_f32 v[46:47], v[46:47], v[42:43]
v_add_f32 v44, v44, v45
v_add_f32 v46, v46, v47
v_rcp_f32 v44, v44
v_rcp_f32 v46, v46
s_nop 0
v_pk_mul_f32 v[8:9], v[8:9], v[44:45] op_sel_hi:[1,0]
v_pk_mul_f32 v[26:27], v[26:27], v[46:47] op_sel_hi:[1,0]
v_pk_mul_f32 v[10:11], v[10:11], v[44:45] op_sel_hi:[1,0]
v_pk_mul_f32 v[28:29], v[28:29], v[46:47] op_sel_hi:[1,0]
v_pk_mul_f32 v[12:13], v[12:13], v[44:45] op_sel_hi:[1,0]
v_pk_mul_f32 v[30:31], v[30:31], v[46:47] op_sel_hi:[1,0]
v_pk_mul_f32 v[14:15], v[14:15], v[44:45] op_sel_hi:[1,0]
v_pk_mul_f32 v[32:33], v[32:33], v[46:47] op_sel_hi:[1,0]
v_pk_mul_f32 v[16:17], v[16:17], v[44:45] op_sel_hi:[1,0]
v_pk_mul_f32 v[34:35], v[34:35], v[46:47] op_sel_hi:[1,0]
v_pk_mul_f32 v[18:19], v[18:19], v[44:45] op_sel_hi:[1,0]
v_pk_mul_f32 v[36:37], v[36:37], v[46:47] op_sel_hi:[1,0]
v_pk_mul_f32 v[20:21], v[20:21], v[44:45] op_sel_hi:[1,0]
v_pk_mul_f32 v[38:39], v[38:39], v[46:47] op_sel_hi:[1,0]
v_pk_mul_f32 v[22:23], v[22:23], v[44:45] op_sel_hi:[1,0]
v_pk_mul_f32 v[40:41], v[40:41], v[46:47] op_sel_hi:[1,0]
v_pk_mul_f32 v[24:25], v[24:25], v[44:45] op_sel_hi:[1,0]
v_pk_mul_f32 v[42:43], v[42:43], v[46:47] op_sel_hi:[1,0]
v_cvt_pk_bf16_f32 v64, v8, v9
v_cvt_pk_bf16_f32 v65, v10, v11
v_cvt_pk_bf16_f32 v68, v12, v13
v_cvt_pk_bf16_f32 v69, v14, v15
v_cvt_pk_bf16_f32 v72, v16, v17
v_cvt_pk_bf16_f32 v73, v18, v19
v_cvt_pk_bf16_f32 v76, v20, v21
v_cvt_pk_bf16_f32 v77, v22, v23
v_cvt_pk_bf16_f32 v66, v24, v25
v_cvt_pk_bf16_f32 v67, v26, v27
v_cvt_pk_bf16_f32 v70, v28, v29
v_cvt_pk_bf16_f32 v71, v30, v31
v_cvt_pk_bf16_f32 v74, v32, v33
v_cvt_pk_bf16_f32 v75, v34, v35
v_cvt_pk_bf16_f32 v78, v36, v37
v_cvt_pk_bf16_f32 v79, v38, v39
v_cvt_pk_bf16_f32 v82, v40, v41
v_cvt_pk_bf16_f32 v83, v42, v43
ds_write_b128 v3, v[64:67] offset:1024
ds_write_b128 v3, v[68:71] offset:1280
ds_write_b128 v3, v[72:75] offset:1536
ds_write_b128 v3, v[76:79] offset:1792
ds_read_b128 v[100:103], v4 offset:0
ds_read_b128 v[108:111], v4 offset:1024
ds_read_b128 v[116:119], v4 offset:2048
ds_read_b128 v[124:127], v4 offset:3072
ds_read_b128 v[132:135], v4 offset:4096
ds_read_b128 v[140:143], v4 offset:5120
ds_read_b128 v[148:151], v4 offset:6144
ds_read_b128 v[156:159], v4 offset:7168
v_pk_mov_b32 v[164:165], v[80:81], v[80:81] op_sel:[0,1]
v_pk_mov_b32 v[166:167], v[82:83], v[82:83] op_sel:[0,1]
v_max3_f32 v44, v168, v169, v170
v_min3_f32 v46, v168, v169, v170
v_max3_f32 v44, v44, v171, v176
v_min3_f32 v46, v46, v171, v176
v_max3_f32 v44, v44, v177, v178
v_min3_f32 v46, v46, v177, v178
v_max3_f32 v44, v44, v179, v184
v_min3_f32 v46, v46, v179, v184
v_max3_f32 v44, v44, v185, v186
v_min3_f32 v46, v46, v185, v186
v_max3_f32 v44, v44, v187, v192
v_min3_f32 v46, v46, v187, v192
v_max3_f32 v44, v44, v193, v194
v_min3_f32 v46, v46, v193, v194
v_max3_f32 v44, v44, v195, v200
v_min3_f32 v46, v46, v195, v200
v_max_f32 v44, v44, v201
v_min_f32 v46, v46, v201
v_mul_f32 v44, v44, v240
v_mul_f32 v46, v46, v240
v_pk_fma_f32 v[8:9], v[168:169], v[240:241], v[44:45] op_sel_hi:[1,0,0] neg_lo:[0,0,1] neg_hi:[0,0,1]
v_pk_fma_f32 v[26:27], v[168:169], v[240:241], v[46:47] op_sel_hi:[1,0,0] neg_lo:[1,0,0] neg_hi:[1,0,0]
v_pk_fma_f32 v[10:11], v[170:171], v[240:241], v[44:45] op_sel_hi:[1,0,0] neg_lo:[0,0,1] neg_hi:[0,0,1]
v_pk_fma_f32 v[28:29], v[170:171], v[240:241], v[46:47] op_sel_hi:[1,0,0] neg_lo:[1,0,0] neg_hi:[1,0,0]
v_pk_fma_f32 v[12:13], v[176:177], v[240:241], v[44:45] op_sel_hi:[1,0,0] neg_lo:[0,0,1] neg_hi:[0,0,1]
v_pk_fma_f32 v[30:31], v[176:177], v[240:241], v[46:47] op_sel_hi:[1,0,0] neg_lo:[1,0,0] neg_hi:[1,0,0]
v_pk_fma_f32 v[14:15], v[178:179], v[240:241], v[44:45] op_sel_hi:[1,0,0] neg_lo:[0,0,1] neg_hi:[0,0,1]
v_pk_fma_f32 v[32:33], v[178:179], v[240:241], v[46:47] op_sel_hi:[1,0,0] neg_lo:[1,0,0] neg_hi:[1,0,0]
v_pk_fma_f32 v[16:17], v[184:185], v[240:241], v[44:45] op_sel_hi:[1,0,0] neg_lo:[0,0,1] neg_hi:[0,0,1]
v_pk_fma_f32 v[34:35], v[184:185], v[240:241], v[46:47] op_sel_hi:[1,0,0] neg_lo:[1,0,0] neg_hi:[1,0,0]
v_pk_fma_f32 v[18:19], v[186:187], v[240:241], v[44:45] op_sel_hi:[1,0,0] neg_lo:[0,0,1] neg_hi:[0,0,1]
v_pk_fma_f32 v[36:37], v[186:187], v[240:241], v[46:47] op_sel_hi:[1,0,0] neg_lo:[1,0,0] neg_hi:[1,0,0]
v_pk_fma_f32 v[20:21], v[192:193], v[240:241], v[44:45] op_sel_hi:[1,0,0] neg_lo:[0,0,1] neg_hi:[0,0,1]
v_pk_fma_f32 v[38:39], v[192:193], v[240:241], v[46:47] op_sel_hi:[1,0,0] neg_lo:[1,0,0] neg_hi:[1,0,0]
v_pk_fma_f32 v[22:23], v[194:195], v[240:241], v[44:45] op_sel_hi:[1,0,0] neg_lo:[0,0,1] neg_hi:[0,0,1]
v_pk_fma_f32 v[40:41], v[194:195], v[240:241], v[46:47] op_sel_hi:[1,0,0] neg_lo:[1,0,0] neg_hi:[1,0,0]
v_pk_fma_f32 v[24:25], v[200:201], v[240:241], v[44:45] op_sel_hi:[1,0,0] neg_lo:[0,0,1] neg_hi:[0,0,1]
v_pk_fma_f32 v[42:43], v[200:201], v[240:241], v[46:47] op_sel_hi:[1,0,0] neg_lo:[1,0,0] neg_hi:[1,0,0]
v_exp_f32 v8, v8
v_exp_f32 v9, v9
v_exp_f32 v10, v10
v_exp_f32 v11, v11
v_exp_f32 v12, v12
v_exp_f32 v13, v13
v_exp_f32 v14, v14
v_exp_f32 v15, v15
v_exp_f32 v16, v16
v_exp_f32 v17, v17
v_exp_f32 v18, v18
v_exp_f32 v19, v19
v_exp_f32 v20, v20
v_exp_f32 v21, v21
v_exp_f32 v22, v22
v_exp_f32 v23, v23
v_exp_f32 v24, v24
v_exp_f32 v25, v25
v_exp_f32 v26, v26
v_exp_f32 v27, v27
v_exp_f32 v28, v28
v_exp_f32 v29, v29
v_exp_f32 v30, v30
v_exp_f32 v31, v31
v_exp_f32 v32, v32
v_exp_f32 v33, v33
v_exp_f32 v34, v34
v_exp_f32 v35, v35
v_exp_f32 v36, v36
v_exp_f32 v37, v37
v_exp_f32 v38, v38
v_exp_f32 v39, v39
v_exp_f32 v40, v40
v_exp_f32 v41, v41
v_exp_f32 v42, v42
v_exp_f32 v43, v43
v_pk_add_f32 v[44:45], v[8:9], v[10:11]
v_pk_add_f32 v[46:47], v[26:27], v[28:29]
v_pk_add_f32 v[44:45], v[44:45], v[12:13]
v_pk_add_f32 v[46:47], v[46:47], v[30:31]
v_pk_add_f32 v[44:45], v[44:45], v[14:15]
v_pk_add_f32 v[46:47], v[46:47], v[32:33]
v_pk_add_f32 v[44:45], v[44:45], v[16:17]
v_pk_add_f32 v[46:47], v[46:47], v[34:35]
v_pk_add_f32 v[44:45], v[44:45], v[18:19]
v_pk_add_f32 v[46:47], v[46:47], v[36:37]
v_pk_add_f32 v[44:45], v[44:45], v[20:21]
v_pk_add_f32 v[46:47], v[46:47], v[38:39]
v_pk_add_f32 v[44:45], v[44:45], v[22:23]
v_pk_add_f32 v[46:47], v[46:47], v[40:41]
v_pk_add_f32 v[44:45], v[44:45], v[24:25]
v_pk_add_f32 v[46:47], v[46:47], v[42:43]
v_add_f32 v44, v44, v45
v_add_f32 v46, v46, v47
v_rcp_f32 v44, v44
v_rcp_f32 v46, v46
s_nop 0
v_pk_mul_f32 v[8:9], v[8:9], v[44:45] op_sel_hi:[1,0]
v_pk_mul_f32 v[26:27], v[26:27], v[46:47] op_sel_hi:[1,0]
v_pk_mul_f32 v[10:11], v[10:11], v[44:45] op_sel_hi:[1,0]
v_pk_mul_f32 v[28:29], v[28:29], v[46:47] op_sel_hi:[1,0]
v_pk_mul_f32 v[12:13], v[12:13], v[44:45] op_sel_hi:[1,0]
v_pk_mul_f32 v[30:31], v[30:31], v[46:47] op_sel_hi:[1,0]
v_pk_mul_f32 v[14:15], v[14:15], v[44:45] op_sel_hi:[1,0]
v_pk_mul_f32 v[32:33], v[32:33], v[46:47] op_sel_hi:[1,0]
v_pk_mul_f32 v[16:17], v[16:17], v[44:45] op_sel_hi:[1,0]
v_pk_mul_f32 v[34:35], v[34:35], v[46:47] op_sel_hi:[1,0]
v_pk_mul_f32 v[18:19], v[18:19], v[44:45] op_sel_hi:[1,0]
v_pk_mul_f32 v[36:37], v[36:37], v[46:47] op_sel_hi:[1,0]
v_pk_mul_f32 v[20:21], v[20:21], v[44:45] op_sel_hi:[1,0]
v_pk_mul_f32 v[38:39], v[38:39], v[46:47] op_sel_hi:[1,0]
v_pk_mul_f32 v[22:23], v[22:23], v[44:45] op_sel_hi:[1,0]
v_pk_mul_f32 v[40:41], v[40:41], v[46:47] op_sel_hi:[1,0]
v_pk_mul_f32 v[24:25], v[24:25], v[44:45] op_sel_hi:[1,0]
v_pk_mul_f32 v[42:43], v[42:43], v[46:47] op_sel_hi:[1,0]
v_cvt_pk_bf16_f32 v48, v8, v9
v_cvt_pk_bf16_f32 v49, v10, v11
v_cvt_pk_bf16_f32 v52, v12, v13
v_cvt_pk_bf16_f32 v53, v14, v15
v_cvt_pk_bf16_f32 v56, v16, v17
v_cvt_pk_bf16_f32 v57, v18, v19
v_cvt_pk_bf16_f32 v60, v20, v21
v_cvt_pk_bf16_f32 v61, v22, v23
v_cvt_pk_bf16_f32 v50, v24, v25
v_cvt_pk_bf16_f32 v51, v26, v27
v_cvt_pk_bf16_f32 v54, v28, v29
v_cvt_pk_bf16_f32 v55, v30, v31
v_cvt_pk_bf16_f32 v58, v32, v33
v_cvt_pk_bf16_f32 v59, v34, v35
v_cvt_pk_bf16_f32 v62, v36, v37
v_cvt_pk_bf16_f32 v63, v38, v39
v_cvt_pk_bf16_f32 v80, v40, v41
v_cvt_pk_bf16_f32 v81, v42, v43
ds_write_b128 v3, v[48:51] offset:0
ds_write_b128 v3, v[52:55] offset:256
ds_write_b128 v3, v[56:59] offset:512
ds_write_b128 v3, v[60:63] offset:768
v_max3_f32 v44, v202, v203, v208
v_min3_f32 v46, v202, v203, v208
v_max3_f32 v44, v44, v209, v210
v_min3_f32 v46, v46, v209, v210
v_max3_f32 v44, v44, v211, v216
v_min3_f32 v46, v46, v211, v216
v_max3_f32 v44, v44, v217, v218
v_min3_f32 v46, v46, v217, v218
v_max3_f32 v44, v44, v219, v224
v_min3_f32 v46, v46, v219, v224
v_max3_f32 v44, v44, v225, v226
v_min3_f32 v46, v46, v225, v226
v_max3_f32 v44, v44, v227, v232
v_min3_f32 v46, v46, v227, v232
v_max3_f32 v44, v44, v233, v234
v_min3_f32 v46, v46, v233, v234
v_max_f32 v44, v44, v235
v_min_f32 v46, v46, v235
v_mul_f32 v44, v44, v240
v_mul_f32 v46, v46, v240
v_pk_fma_f32 v[8:9], v[202:203], v[240:241], v[44:45] op_sel_hi:[1,0,0] neg_lo:[0,0,1] neg_hi:[0,0,1]
v_pk_fma_f32 v[26:27], v[202:203], v[240:241], v[46:47] op_sel_hi:[1,0,0] neg_lo:[1,0,0] neg_hi:[1,0,0]
v_pk_fma_f32 v[10:11], v[208:209], v[240:241], v[44:45] op_sel_hi:[1,0,0] neg_lo:[0,0,1] neg_hi:[0,0,1]
v_pk_fma_f32 v[28:29], v[208:209], v[240:241], v[46:47] op_sel_hi:[1,0,0] neg_lo:[1,0,0] neg_hi:[1,0,0]
v_pk_fma_f32 v[12:13], v[210:211], v[240:241], v[44:45] op_sel_hi:[1,0,0] neg_lo:[0,0,1] neg_hi:[0,0,1]
v_pk_fma_f32 v[30:31], v[210:211], v[240:241], v[46:47] op_sel_hi:[1,0,0] neg_lo:[1,0,0] neg_hi:[1,0,0]
v_pk_fma_f32 v[14:15], v[216:217], v[240:241], v[44:45] op_sel_hi:[1,0,0] neg_lo:[0,0,1] neg_hi:[0,0,1]
v_pk_fma_f32 v[32:33], v[216:217], v[240:241], v[46:47] op_sel_hi:[1,0,0] neg_lo:[1,0,0] neg_hi:[1,0,0]
v_pk_fma_f32 v[16:17], v[218:219], v[240:241], v[44:45] op_sel_hi:[1,0,0] neg_lo:[0,0,1] neg_hi:[0,0,1]
v_pk_fma_f32 v[34:35], v[218:219], v[240:241], v[46:47] op_sel_hi:[1,0,0] neg_lo:[1,0,0] neg_hi:[1,0,0]
v_pk_fma_f32 v[18:19], v[224:225], v[240:241], v[44:45] op_sel_hi:[1,0,0] neg_lo:[0,0,1] neg_hi:[0,0,1]
v_pk_fma_f32 v[36:37], v[224:225], v[240:241], v[46:47] op_sel_hi:[1,0,0] neg_lo:[1,0,0] neg_hi:[1,0,0]
v_pk_fma_f32 v[20:21], v[226:227], v[240:241], v[44:45] op_sel_hi:[1,0,0] neg_lo:[0,0,1] neg_hi:[0,0,1]
v_pk_fma_f32 v[38:39], v[226:227], v[240:241], v[46:47] op_sel_hi:[1,0,0] neg_lo:[1,0,0] neg_hi:[1,0,0]
v_pk_fma_f32 v[22:23], v[232:233], v[240:241], v[44:45] op_sel_hi:[1,0,0] neg_lo:[0,0,1] neg_hi:[0,0,1]
v_pk_fma_f32 v[40:41], v[232:233], v[240:241], v[46:47] op_sel_hi:[1,0,0] neg_lo:[1,0,0] neg_hi:[1,0,0]
v_pk_fma_f32 v[24:25], v[234:235], v[240:241], v[44:45] op_sel_hi:[1,0,0] neg_lo:[0,0,1] neg_hi:[0,0,1]
v_pk_fma_f32 v[42:43], v[234:235], v[240:241], v[46:47] op_sel_hi:[1,0,0] neg_lo:[1,0,0] neg_hi:[1,0,0]
v_exp_f32 v8, v8
v_exp_f32 v9, v9
v_exp_f32 v10, v10
v_exp_f32 v11, v11
v_exp_f32 v12, v12
v_exp_f32 v13, v13
v_exp_f32 v14, v14
v_exp_f32 v15, v15
v_exp_f32 v16, v16
v_exp_f32 v17, v17
v_exp_f32 v18, v18
v_exp_f32 v19, v19
v_exp_f32 v20, v20
v_exp_f32 v21, v21
v_exp_f32 v22, v22
v_exp_f32 v23, v23
v_exp_f32 v24, v24
v_exp_f32 v25, v25
v_exp_f32 v26, v26
v_exp_f32 v27, v27
v_exp_f32 v28, v28
v_exp_f32 v29, v29
v_exp_f32 v30, v30
v_exp_f32 v31, v31
v_exp_f32 v32, v32
v_exp_f32 v33, v33
v_exp_f32 v34, v34
v_exp_f32 v35, v35
v_exp_f32 v36, v36
v_exp_f32 v37, v37
v_exp_f32 v38, v38
v_exp_f32 v39, v39
v_exp_f32 v40, v40
v_exp_f32 v41, v41
v_exp_f32 v42, v42
v_exp_f32 v43, v43
v_pk_add_f32 v[44:45], v[8:9], v[10:11]
v_pk_add_f32 v[46:47], v[26:27], v[28:29]
v_pk_add_f32 v[44:45], v[44:45], v[12:13]
v_pk_add_f32 v[46:47], v[46:47], v[30:31]
v_pk_add_f32 v[44:45], v[44:45], v[14:15]
v_pk_add_f32 v[46:47], v[46:47], v[32:33]
v_pk_add_f32 v[44:45], v[44:45], v[16:17]
v_pk_add_f32 v[46:47], v[46:47], v[34:35]
v_pk_add_f32 v[44:45], v[44:45], v[18:19]
v_pk_add_f32 v[46:47], v[46:47], v[36:37]
v_pk_add_f32 v[44:45], v[44:45], v[20:21]
v_pk_add_f32 v[46:47], v[46:47], v[38:39]
v_pk_add_f32 v[44:45], v[44:45], v[22:23]
v_pk_add_f32 v[46:47], v[46:47], v[40:41]
v_pk_add_f32 v[44:45], v[44:45], v[24:25]
v_pk_add_f32 v[46:47], v[46:47], v[42:43]
v_add_f32 v44, v44, v45
v_add_f32 v46, v46, v47
v_rcp_f32 v44, v44
v_rcp_f32 v46, v46
s_nop 0
v_pk_mul_f32 v[8:9], v[8:9], v[44:45] op_sel_hi:[1,0]
v_pk_mul_f32 v[26:27], v[26:27], v[46:47] op_sel_hi:[1,0]
v_pk_mul_f32 v[10:11], v[10:11], v[44:45] op_sel_hi:[1,0]
v_pk_mul_f32 v[28:29], v[28:29], v[46:47] op_sel_hi:[1,0]
v_pk_mul_f32 v[12:13], v[12:13], v[44:45] op_sel_hi:[1,0]
v_pk_mul_f32 v[30:31], v[30:31], v[46:47] op_sel_hi:[1,0]
v_pk_mul_f32 v[14:15], v[14:15], v[44:45] op_sel_hi:[1,0]
v_pk_mul_f32 v[32:33], v[32:33], v[46:47] op_sel_hi:[1,0]
v_pk_mul_f32 v[16:17], v[16:17], v[44:45] op_sel_hi:[1,0]
v_pk_mul_f32 v[34:35], v[34:35], v[46:47] op_sel_hi:[1,0]
v_pk_mul_f32 v[18:19], v[18:19], v[44:45] op_sel_hi:[1,0]
v_pk_mul_f32 v[36:37], v[36:37], v[46:47] op_sel_hi:[1,0]
v_pk_mul_f32 v[20:21], v[20:21], v[44:45] op_sel_hi:[1,0]
v_pk_mul_f32 v[38:39], v[38:39], v[46:47] op_sel_hi:[1,0]
v_pk_mul_f32 v[22:23], v[22:23], v[44:45] op_sel_hi:[1,0]
v_pk_mul_f32 v[40:41], v[40:41], v[46:47] op_sel_hi:[1,0]
v_pk_mul_f32 v[24:25], v[24:25], v[44:45] op_sel_hi:[1,0]
v_pk_mul_f32 v[42:43], v[42:43], v[46:47] op_sel_hi:[1,0]
v_cvt_pk_bf16_f32 v64, v8, v9
v_cvt_pk_bf16_f32 v65, v10, v11
v_cvt_pk_bf16_f32 v68, v12, v13
v_cvt_pk_bf16_f32 v69, v14, v15
v_cvt_pk_bf16_f32 v72, v16, v17
v_cvt_pk_bf16_f32 v73, v18, v19
v_cvt_pk_bf16_f32 v76, v20, v21
v_cvt_pk_bf16_f32 v77, v22, v23
v_cvt_pk_bf16_f32 v66, v24, v25
v_cvt_pk_bf16_f32 v67, v26, v27
v_cvt_pk_bf16_f32 v70, v28, v29
v_cvt_pk_bf16_f32 v71, v30, v31
v_cvt_pk_bf16_f32 v74, v32, v33
v_cvt_pk_bf16_f32 v75, v34, v35
v_cvt_pk_bf16_f32 v78, v36, v37
v_cvt_pk_bf16_f32 v79, v38, v39
v_cvt_pk_bf16_f32 v82, v40, v41
v_cvt_pk_bf16_f32 v83, v42, v43
ds_write_b128 v3, v[64:67] offset:1024
ds_write_b128 v3, v[68:71] offset:1280
ds_write_b128 v3, v[72:75] offset:1536
ds_write_b128 v3, v[76:79] offset:1792
ds_read_b128 v[168:171], v4 offset:0
ds_read_b128 v[176:179], v4 offset:1024
ds_read_b128 v[184:187], v4 offset:2048
ds_read_b128 v[192:195], v4 offset:3072
ds_read_b128 v[200:203], v4 offset:4096
ds_read_b128 v[208:211], v4 offset:5120
ds_read_b128 v[216:219], v4 offset:6144
ds_read_b128 v[224:227], v4 offset:7168
v_pk_mov_b32 v[232:233], v[80:81], v[80:81] op_sel:[0,1]
v_pk_mov_b32 v[234:235], v[82:83], v[82:83] op_sel:[0,1]
v_max3_f32 v44, v172, v173, v174
v_min3_f32 v46, v172, v173, v174
v_max3_f32 v44, v44, v175, v180
v_min3_f32 v46, v46, v175, v180
v_max3_f32 v44, v44, v181, v182
v_min3_f32 v46, v46, v181, v182
v_max3_f32 v44, v44, v183, v188
v_min3_f32 v46, v46, v183, v188
v_max3_f32 v44, v44, v189, v190
v_min3_f32 v46, v46, v189, v190
v_max3_f32 v44, v44, v191, v196
v_min3_f32 v46, v46, v191, v196
v_max3_f32 v44, v44, v197, v198
v_min3_f32 v46, v46, v197, v198
v_max3_f32 v44, v44, v199, v204
v_min3_f32 v46, v46, v199, v204
v_max_f32 v44, v44, v205
v_min_f32 v46, v46, v205
v_mul_f32 v44, v44, v242
v_mul_f32 v46, v46, v242
v_pk_fma_f32 v[8:9], v[172:173], v[242:243], v[44:45] op_sel_hi:[1,0,0] neg_lo:[0,0,1] neg_hi:[0,0,1]
v_pk_fma_f32 v[26:27], v[172:173], v[242:243], v[46:47] op_sel_hi:[1,0,0] neg_lo:[1,0,0] neg_hi:[1,0,0]
v_pk_fma_f32 v[10:11], v[174:175], v[242:243], v[44:45] op_sel_hi:[1,0,0] neg_lo:[0,0,1] neg_hi:[0,0,1]
v_pk_fma_f32 v[28:29], v[174:175], v[242:243], v[46:47] op_sel_hi:[1,0,0] neg_lo:[1,0,0] neg_hi:[1,0,0]
v_pk_fma_f32 v[12:13], v[180:181], v[242:243], v[44:45] op_sel_hi:[1,0,0] neg_lo:[0,0,1] neg_hi:[0,0,1]
v_pk_fma_f32 v[30:31], v[180:181], v[242:243], v[46:47] op_sel_hi:[1,0,0] neg_lo:[1,0,0] neg_hi:[1,0,0]
v_pk_fma_f32 v[14:15], v[182:183], v[242:243], v[44:45] op_sel_hi:[1,0,0] neg_lo:[0,0,1] neg_hi:[0,0,1]
v_pk_fma_f32 v[32:33], v[182:183], v[242:243], v[46:47] op_sel_hi:[1,0,0] neg_lo:[1,0,0] neg_hi:[1,0,0]
v_pk_fma_f32 v[16:17], v[188:189], v[242:243], v[44:45] op_sel_hi:[1,0,0] neg_lo:[0,0,1] neg_hi:[0,0,1]
v_pk_fma_f32 v[34:35], v[188:189], v[242:243], v[46:47] op_sel_hi:[1,0,0] neg_lo:[1,0,0] neg_hi:[1,0,0]
v_pk_fma_f32 v[18:19], v[190:191], v[242:243], v[44:45] op_sel_hi:[1,0,0] neg_lo:[0,0,1] neg_hi:[0,0,1]
v_pk_fma_f32 v[36:37], v[190:191], v[242:243], v[46:47] op_sel_hi:[1,0,0] neg_lo:[1,0,0] neg_hi:[1,0,0]
v_pk_fma_f32 v[20:21], v[196:197], v[242:243], v[44:45] op_sel_hi:[1,0,0] neg_lo:[0,0,1] neg_hi:[0,0,1]
v_pk_fma_f32 v[38:39], v[196:197], v[242:243], v[46:47] op_sel_hi:[1,0,0] neg_lo:[1,0,0] neg_hi:[1,0,0]
v_pk_fma_f32 v[22:23], v[198:199], v[242:243], v[44:45] op_sel_hi:[1,0,0] neg_lo:[0,0,1] neg_hi:[0,0,1]
v_pk_fma_f32 v[40:41], v[198:199], v[242:243], v[46:47] op_sel_hi:[1,0,0] neg_lo:[1,0,0] neg_hi:[1,0,0]
v_pk_fma_f32 v[24:25], v[204:205], v[242:243], v[44:45] op_sel_hi:[1,0,0] neg_lo:[0,0,1] neg_hi:[0,0,1]
v_pk_fma_f32 v[42:43], v[204:205], v[242:243], v[46:47] op_sel_hi:[1,0,0] neg_lo:[1,0,0] neg_hi:[1,0,0]
v_exp_f32 v8, v8
v_exp_f32 v9, v9
v_exp_f32 v10, v10
v_exp_f32 v11, v11
v_exp_f32 v12, v12
v_exp_f32 v13, v13
v_exp_f32 v14, v14
v_exp_f32 v15, v15
v_exp_f32 v16, v16
v_exp_f32 v17, v17
v_exp_f32 v18, v18
v_exp_f32 v19, v19
v_exp_f32 v20, v20
v_exp_f32 v21, v21
v_exp_f32 v22, v22
v_exp_f32 v23, v23
v_exp_f32 v24, v24
v_exp_f32 v25, v25
v_exp_f32 v26, v26
v_exp_f32 v27, v27
v_exp_f32 v28, v28
v_exp_f32 v29, v29
v_exp_f32 v30, v30
v_exp_f32 v31, v31
v_exp_f32 v32, v32
v_exp_f32 v33, v33
v_exp_f32 v34, v34
v_exp_f32 v35, v35
v_exp_f32 v36, v36
v_exp_f32 v37, v37
v_exp_f32 v38, v38
v_exp_f32 v39, v39
v_exp_f32 v40, v40
v_exp_f32 v41, v41
v_exp_f32 v42, v42
v_exp_f32 v43, v43
v_pk_add_f32 v[44:45], v[8:9], v[10:11]
v_pk_add_f32 v[46:47], v[26:27], v[28:29]
v_pk_add_f32 v[44:45], v[44:45], v[12:13]
v_pk_add_f32 v[46:47], v[46:47], v[30:31]
v_pk_add_f32 v[44:45], v[44:45], v[14:15]
v_pk_add_f32 v[46:47], v[46:47], v[32:33]
v_pk_add_f32 v[44:45], v[44:45], v[16:17]
v_pk_add_f32 v[46:47], v[46:47], v[34:35]
v_pk_add_f32 v[44:45], v[44:45], v[18:19]
v_pk_add_f32 v[46:47], v[46:47], v[36:37]
v_pk_add_f32 v[44:45], v[44:45], v[20:21]
v_pk_add_f32 v[46:47], v[46:47], v[38:39]
v_pk_add_f32 v[44:45], v[44:45], v[22:23]
v_pk_add_f32 v[46:47], v[46:47], v[40:41]
v_pk_add_f32 v[44:45], v[44:45], v[24:25]
v_pk_add_f32 v[46:47], v[46:47], v[42:43]
v_add_f32 v44, v44, v45
v_add_f32 v46, v46, v47
v_rcp_f32 v44, v44
v_rcp_f32 v46, v46
s_nop 0
v_pk_mul_f32 v[8:9], v[8:9], v[44:45] op_sel_hi:[1,0]
v_pk_mul_f32 v[26:27], v[26:27], v[46:47] op_sel_hi:[1,0]
v_pk_mul_f32 v[10:11], v[10:11], v[44:45] op_sel_hi:[1,0]
v_pk_mul_f32 v[28:29], v[28:29], v[46:47] op_sel_hi:[1,0]
v_pk_mul_f32 v[12:13], v[12:13], v[44:45] op_sel_hi:[1,0]
v_pk_mul_f32 v[30:31], v[30:31], v[46:47] op_sel_hi:[1,0]
v_pk_mul_f32 v[14:15], v[14:15], v[44:45] op_sel_hi:[1,0]
v_pk_mul_f32 v[32:33], v[32:33], v[46:47] op_sel_hi:[1,0]
v_pk_mul_f32 v[16:17], v[16:17], v[44:45] op_sel_hi:[1,0]
v_pk_mul_f32 v[34:35], v[34:35], v[46:47] op_sel_hi:[1,0]
v_pk_mul_f32 v[18:19], v[18:19], v[44:45] op_sel_hi:[1,0]
v_pk_mul_f32 v[36:37], v[36:37], v[46:47] op_sel_hi:[1,0]
v_pk_mul_f32 v[20:21], v[20:21], v[44:45] op_sel_hi:[1,0]
v_pk_mul_f32 v[38:39], v[38:39], v[46:47] op_sel_hi:[1,0]
v_pk_mul_f32 v[22:23], v[22:23], v[44:45] op_sel_hi:[1,0]
v_pk_mul_f32 v[40:41], v[40:41], v[46:47] op_sel_hi:[1,0]
v_pk_mul_f32 v[24:25], v[24:25], v[44:45] op_sel_hi:[1,0]
v_pk_mul_f32 v[42:43], v[42:43], v[46:47] op_sel_hi:[1,0]
v_cvt_pk_bf16_f32 v48, v8, v9
v_cvt_pk_bf16_f32 v49, v10, v11
v_cvt_pk_bf16_f32 v52, v12, v13
v_cvt_pk_bf16_f32 v53, v14, v15
v_cvt_pk_bf16_f32 v56, v16, v17
v_cvt_pk_bf16_f32 v57, v18, v19
v_cvt_pk_bf16_f32 v60, v20, v21
v_cvt_pk_bf16_f32 v61, v22, v23
v_cvt_pk_bf16_f32 v50, v24, v25
v_cvt_pk_bf16_f32 v51, v26, v27
v_cvt_pk_bf16_f32 v54, v28, v29
v_cvt_pk_bf16_f32 v55, v30, v31
v_cvt_pk_bf16_f32 v58, v32, v33
v_cvt_pk_bf16_f32 v59, v34, v35
v_cvt_pk_bf16_f32 v62, v36, v37
v_cvt_pk_bf16_f32 v63, v38, v39
v_cvt_pk_bf16_f32 v80, v40, v41
v_cvt_pk_bf16_f32 v81, v42, v43
ds_write_b128 v3, v[48:51] offset:0
ds_write_b128 v3, v[52:55] offset:256
ds_write_b128 v3, v[56:59] offset:512
ds_write_b128 v3, v[60:63] offset:768
v_max3_f32 v44, v206, v207, v212
v_min3_f32 v46, v206, v207, v212
v_max3_f32 v44, v44, v213, v214
v_min3_f32 v46, v46, v213, v214
v_max3_f32 v44, v44, v215, v220
v_min3_f32 v46, v46, v215, v220
v_max3_f32 v44, v44, v221, v222
v_min3_f32 v46, v46, v221, v222
v_max3_f32 v44, v44, v223, v228
v_min3_f32 v46, v46, v223, v228
v_max3_f32 v44, v44, v229, v230
v_min3_f32 v46, v46, v229, v230
v_max3_f32 v44, v44, v231, v236
v_min3_f32 v46, v46, v231, v236
v_max3_f32 v44, v44, v237, v238
v_min3_f32 v46, v46, v237, v238
v_max_f32 v44, v44, v239
v_min_f32 v46, v46, v239
v_mul_f32 v44, v44, v242
v_mul_f32 v46, v46, v242
v_pk_fma_f32 v[8:9], v[206:207], v[242:243], v[44:45] op_sel_hi:[1,0,0] neg_lo:[0,0,1] neg_hi:[0,0,1]
v_pk_fma_f32 v[26:27], v[206:207], v[242:243], v[46:47] op_sel_hi:[1,0,0] neg_lo:[1,0,0] neg_hi:[1,0,0]
v_pk_fma_f32 v[10:11], v[212:213], v[242:243], v[44:45] op_sel_hi:[1,0,0] neg_lo:[0,0,1] neg_hi:[0,0,1]
v_pk_fma_f32 v[28:29], v[212:213], v[242:243], v[46:47] op_sel_hi:[1,0,0] neg_lo:[1,0,0] neg_hi:[1,0,0]
v_pk_fma_f32 v[12:13], v[214:215], v[242:243], v[44:45] op_sel_hi:[1,0,0] neg_lo:[0,0,1] neg_hi:[0,0,1]
v_pk_fma_f32 v[30:31], v[214:215], v[242:243], v[46:47] op_sel_hi:[1,0,0] neg_lo:[1,0,0] neg_hi:[1,0,0]
v_pk_fma_f32 v[14:15], v[220:221], v[242:243], v[44:45] op_sel_hi:[1,0,0] neg_lo:[0,0,1] neg_hi:[0,0,1]
v_pk_fma_f32 v[32:33], v[220:221], v[242:243], v[46:47] op_sel_hi:[1,0,0] neg_lo:[1,0,0] neg_hi:[1,0,0]
v_pk_fma_f32 v[16:17], v[222:223], v[242:243], v[44:45] op_sel_hi:[1,0,0] neg_lo:[0,0,1] neg_hi:[0,0,1]
v_pk_fma_f32 v[34:35], v[222:223], v[242:243], v[46:47] op_sel_hi:[1,0,0] neg_lo:[1,0,0] neg_hi:[1,0,0]
v_pk_fma_f32 v[18:19], v[228:229], v[242:243], v[44:45] op_sel_hi:[1,0,0] neg_lo:[0,0,1] neg_hi:[0,0,1]
v_pk_fma_f32 v[36:37], v[228:229], v[242:243], v[46:47] op_sel_hi:[1,0,0] neg_lo:[1,0,0] neg_hi:[1,0,0]
v_pk_fma_f32 v[20:21], v[230:231], v[242:243], v[44:45] op_sel_hi:[1,0,0] neg_lo:[0,0,1] neg_hi:[0,0,1]
v_pk_fma_f32 v[38:39], v[230:231], v[242:243], v[46:47] op_sel_hi:[1,0,0] neg_lo:[1,0,0] neg_hi:[1,0,0]
v_pk_fma_f32 v[22:23], v[236:237], v[242:243], v[44:45] op_sel_hi:[1,0,0] neg_lo:[0,0,1] neg_hi:[0,0,1]
v_pk_fma_f32 v[40:41], v[236:237], v[242:243], v[46:47] op_sel_hi:[1,0,0] neg_lo:[1,0,0] neg_hi:[1,0,0]
v_pk_fma_f32 v[24:25], v[238:239], v[242:243], v[44:45] op_sel_hi:[1,0,0] neg_lo:[0,0,1] neg_hi:[0,0,1]
v_pk_fma_f32 v[42:43], v[238:239], v[242:243], v[46:47] op_sel_hi:[1,0,0] neg_lo:[1,0,0] neg_hi:[1,0,0]
v_exp_f32 v8, v8
v_exp_f32 v9, v9
v_exp_f32 v10, v10
v_exp_f32 v11, v11
v_exp_f32 v12, v12
v_exp_f32 v13, v13
v_exp_f32 v14, v14
v_exp_f32 v15, v15
v_exp_f32 v16, v16
v_exp_f32 v17, v17
v_exp_f32 v18, v18
v_exp_f32 v19, v19
v_exp_f32 v20, v20
v_exp_f32 v21, v21
v_exp_f32 v22, v22
v_exp_f32 v23, v23
v_exp_f32 v24, v24
v_exp_f32 v25, v25
v_exp_f32 v26, v26
v_exp_f32 v27, v27
v_exp_f32 v28, v28
v_exp_f32 v29, v29
v_exp_f32 v30, v30
v_exp_f32 v31, v31
v_exp_f32 v32, v32
v_exp_f32 v33, v33
v_exp_f32 v34, v34
v_exp_f32 v35, v35
v_exp_f32 v36, v36
v_exp_f32 v37, v37
v_exp_f32 v38, v38
v_exp_f32 v39, v39
v_exp_f32 v40, v40
v_exp_f32 v41, v41
v_exp_f32 v42, v42
v_exp_f32 v43, v43
v_pk_add_f32 v[44:45], v[8:9], v[10:11]
v_pk_add_f32 v[46:47], v[26:27], v[28:29]
v_pk_add_f32 v[44:45], v[44:45], v[12:13]
v_pk_add_f32 v[46:47], v[46:47], v[30:31]
v_pk_add_f32 v[44:45], v[44:45], v[14:15]
v_pk_add_f32 v[46:47], v[46:47], v[32:33]
v_pk_add_f32 v[44:45], v[44:45], v[16:17]
v_pk_add_f32 v[46:47], v[46:47], v[34:35]
v_pk_add_f32 v[44:45], v[44:45], v[18:19]
v_pk_add_f32 v[46:47], v[46:47], v[36:37]
v_pk_add_f32 v[44:45], v[44:45], v[20:21]
v_pk_add_f32 v[46:47], v[46:47], v[38:39]
v_pk_add_f32 v[44:45], v[44:45], v[22:23]
v_pk_add_f32 v[46:47], v[46:47], v[40:41]
v_pk_add_f32 v[44:45], v[44:45], v[24:25]
v_pk_add_f32 v[46:47], v[46:47], v[42:43]
v_add_f32 v44, v44, v45
v_add_f32 v46, v46, v47
v_rcp_f32 v44, v44
v_rcp_f32 v46, v46
s_nop 0
v_pk_mul_f32 v[8:9], v[8:9], v[44:45] op_sel_hi:[1,0]
v_pk_mul_f32 v[26:27], v[26:27], v[46:47] op_sel_hi:[1,0]
v_pk_mul_f32 v[10:11], v[10:11], v[44:45] op_sel_hi:[1,0]
v_pk_mul_f32 v[28:29], v[28:29], v[46:47] op_sel_hi:[1,0]
v_pk_mul_f32 v[12:13], v[12:13], v[44:45] op_sel_hi:[1,0]
v_pk_mul_f32 v[30:31], v[30:31], v[46:47] op_sel_hi:[1,0]
v_pk_mul_f32 v[14:15], v[14:15], v[44:45] op_sel_hi:[1,0]
v_pk_mul_f32 v[32:33], v[32:33], v[46:47] op_sel_hi:[1,0]
v_pk_mul_f32 v[16:17], v[16:17], v[44:45] op_sel_hi:[1,0]
v_pk_mul_f32 v[34:35], v[34:35], v[46:47] op_sel_hi:[1,0]
v_pk_mul_f32 v[18:19], v[18:19], v[44:45] op_sel_hi:[1,0]
v_pk_mul_f32 v[36:37], v[36:37], v[46:47] op_sel_hi:[1,0]
v_pk_mul_f32 v[20:21], v[20:21], v[44:45] op_sel_hi:[1,0]
v_pk_mul_f32 v[38:39], v[38:39], v[46:47] op_sel_hi:[1,0]
v_pk_mul_f32 v[22:23], v[22:23], v[44:45] op_sel_hi:[1,0]
v_pk_mul_f32 v[40:41], v[40:41], v[46:47] op_sel_hi:[1,0]
v_pk_mul_f32 v[24:25], v[24:25], v[44:45] op_sel_hi:[1,0]
v_pk_mul_f32 v[42:43], v[42:43], v[46:47] op_sel_hi:[1,0]
v_cvt_pk_bf16_f32 v64, v8, v9
v_cvt_pk_bf16_f32 v65, v10, v11
v_cvt_pk_bf16_f32 v68, v12, v13
v_cvt_pk_bf16_f32 v69, v14, v15
v_cvt_pk_bf16_f32 v72, v16, v17
v_cvt_pk_bf16_f32 v73, v18, v19
v_cvt_pk_bf16_f32 v76, v20, v21
v_cvt_pk_bf16_f32 v77, v22, v23
v_cvt_pk_bf16_f32 v66, v24, v25
v_cvt_pk_bf16_f32 v67, v26, v27
v_cvt_pk_bf16_f32 v70, v28, v29
v_cvt_pk_bf16_f32 v71, v30, v31
v_cvt_pk_bf16_f32 v74, v32, v33
v_cvt_pk_bf16_f32 v75, v34, v35
v_cvt_pk_bf16_f32 v78, v36, v37
v_cvt_pk_bf16_f32 v79, v38, v39
v_cvt_pk_bf16_f32 v82, v40, v41
v_cvt_pk_bf16_f32 v83, v42, v43
ds_write_b128 v3, v[64:67] offset:1024
ds_write_b128 v3, v[68:71] offset:1280
ds_write_b128 v3, v[72:75] offset:1536
ds_write_b128 v3, v[76:79] offset:1792
ds_read_b128 v[172:175], v4 offset:0
ds_read_b128 v[180:183], v4 offset:1024
ds_read_b128 v[188:191], v4 offset:2048
ds_read_b128 v[196:199], v4 offset:3072
ds_read_b128 v[204:207], v4 offset:4096
ds_read_b128 v[212:215], v4 offset:5120
ds_read_b128 v[220:223], v4 offset:6144
ds_read_b128 v[228:231], v4 offset:7168
v_pk_mov_b32 v[236:237], v[80:81], v[80:81] op_sel:[0,1]
v_pk_mov_b32 v[238:239], v[82:83], v[82:83] op_sel:[0,1]
v_add_u32 v4, 110592, v2
v_cmp_eq_u32 vcc, 0, v6
v_cmp_eq_u32 s[40:41], 4, v6
v_lshlrev_b32 v7, 6, v7
s_mov_b32 s3, 119808
v_cndmask_b32 v5, 32, 0, vcc
v_cndmask_b32 v5, v5, 16, s[40:41]
v_add3_u32 v5, v5, v7, s3
s_lshl_b32 s56, s22, 2
s_add_u32 s56, s56, s16
s_lshl_b32 s56, s56, 1
s_add_u32 s56, s56, s23
s_sub_u32 s56, s56, 4
s_add_u32 s49, s56, 1480
s_lshl_b32 s49, s49, 7
s_mul_i32 s56, s56, 20480
s_add_u32 s57, s56, 10240
s_load_dwordx4 s[4:7], s[0:1], 56
s_load_dwordx2 s[44:45], s[0:1], 0
s_load_dwordx2 s[46:47], s[0:1], 72
s_and_b32 s17, s2, 7
s_lshr_b32 s18, s2, 3
s_lshr_b32 s28, s17, 1
s_lshl_b32 s22, s17, 1
s_add_u32 s22, s22, s18
s_and_b32 s22, s22, 3
s_and_b32 s17, s17, 1
s_lshl_b32 s17, s17, 3
s_lshr_b32 s18, s18, 2
s_add_u32 s23, s17, s18
s_add_u32 s36, s26, 20971520
s_addc_u32 s37, s27, 0
s_mov_b32 s38, 9437184
s_mov_b32 s39, 0x20000
s_lshl_b32 s17, s23, 2
s_add_u32 s17, s17, s22
s_lshl_b32 s18, s17, 4
s_lshl_b32 s30, s16, 2
s_add_u32 s30, s30, s28
s_add_u32 s30, s30, s18
s_mul_i32 s32, s30, 9216
s_add_u32 s30, s30, 1608
s_lshl_b32 s30, s30, 7
s_cmp_eq_u32 s16, s28
s_cselect_b32 s48, 2147483648, 0
s_cselect_b32 s30, 2147483648, s30
s_add_u32 s34, s32, 4096
s_add_u32 s35, s32, 8192
s_waitcnt lgkmcnt(0)
s_mov_b32 s8, s44
s_mov_b32 s9, s45
s_mov_b32 s10, 2359296
s_mov_b32 s11, 0x20000
s_mov_b32 s12, s6
s_mov_b32 s13, s7
s_mov_b32 s14, 4096
s_mov_b32 s15, 0x20000
s_mov_b32 s52, s46
s_mov_b32 s53, s47
s_mov_b32 s54, 2359296
s_mov_b32 s55, 0x20000
s_lshl_b32 s50, s23, 2
s_add_u32 s50, s50, s28
s_lshl_b32 s51, s50, 6
s_mul_i32 s50, s50, 36864
s_mul_i32 s17, s22, 288
s_add_u32 s50, s50, s17
v_mov_b32 v252, v0
v_mul_u32_u24 v253, 3641, v252
v_lshrrev_b32 v253, 16, v253
v_mul_u32_u24 v254, 18, v253
v_sub_u32 v254, v252, v254
v_mul_u32_u24 v252, 1152, v253
v_lshl_add_u32 v244, v254, 4, v252
v_mul_u32_u24 v252, 592, v253
v_lshl_add_u32 v245, v254, 5, v252
v_add_u32 v245, 110592, v245
v_lshrrev_b32 v252, 1, v254
v_mul_u32_u24 v252, 1056, v252
v_and_b32 v254, 1, v254
v_lshl_add_u32 v252, v254, 9, v252
v_xor_b32 v254, v254, v253
v_and_b32 v254, 15, v254
v_lshl_add_u32 v252, v254, 4, v252
v_lshrrev_b32 v254, 4, v253
v_lshl_add_u32 v252, v254, 3, v252
v_add_u32 v241, 36864, v252
v_add_u32 v246, 129536, v252
v_lshlrev_b32 v253, 1, v253
buffer_load_dwordx4 v[248:251], v244, s[8:11], s50 offen
buffer_load_ushort v247, v253, s[12:15], s51 offen
v_mov_b32 v252, v241
v_and_b32 v8, 15, v1
v_lshrrev_b32 v9, 4, v1
v_mul_u32_u24 v8, 592, v8
v_lshl_add_u32 v8, v9, 4, v8
v_add_u32 v254, 110592, v8
s_add_u32 s40, s26, 33554432
s_addc_u32 s41, s27, 0
s_mov_b32 s42, 2621440
s_mov_b32 s43, 0x20000
s_mov_b32 s8, 65535
s_mov_b32 s9, 0
s_mov_b32 s10, 4294901760
s_mov_b32 s11, 0
s_mov_b32 s12, 0
s_mov_b32 s13, 65535
s_mov_b32 s14, 0
s_mov_b32 s15, 4294901760
v_mov_b32 v90, 0
v_mov_b32 v91, 0
v_mov_b32 v240, 0
v_mov_b32 v241, 897988541
v_mov_b32 v242, 0
v_mov_b32 v243, 0
v_add_u32 v6, 4096, v2
v_add_u32 v7, 8192, v2
s_waitcnt lgkmcnt(0)
s_barrier
ds_read_b128 v[8:11], v4 offset:0
ds_read_b128 v[12:15], v5 offset:0
ds_read_b128 v[16:19], v4 offset:1024
ds_read_b128 v[20:23], v5 offset:256
ds_read_b128 v[40:43], v4 offset:8192
ds_read_b128 v[44:47], v5 offset:2048
ds_read_b128 v[48:51], v4 offset:20480
ds_read_b128 v[52:55], v5 offset:14336
v_cndmask_b32 v88, 0, v160, s[8:9]
v_cndmask_b32 v89, 0, v161, s[8:9]
s_waitcnt lgkmcnt(0)
v_mfma_f32_16x16x32_bf16 v[60:63], v[12:15], v[96:99], v[240:243]
s_nop 0
v_cndmask_b32 v92, 0, v162, s[8:9]
v_mfma_f32_16x16x32_bf16 v[56:59], v[8:11], v[96:99], 0
s_nop 1
v_cndmask_b32 v93, 0, v163, s[8:9]
v_mfma_f32_16x16x32_bf16 v[60:63], v[44:47], v[88:91], v[60:63]
ds_read_b128 v[24:27], v4 offset:2048
v_mfma_f32_16x16x32_bf16 v[56:59], v[40:43], v[88:91], v[56:59]
ds_read_b128 v[28:31], v5 offset:512
v_mfma_f32_16x16x32_bf16 v[68:71], v[20:23], v[104:107], v[240:243]
s_nop 0
v_cndmask_b32 v88, 0, v164, s[8:9]
v_mfma_f32_16x16x32_bf16 v[64:67], v[16:19], v[104:107], 0
s_nop 1
v_cndmask_b32 v89, 0, v165, s[8:9]
v_mfma_f32_16x16x32_bf16 v[68:71], v[44:47], v[90:93], v[68:71]
ds_read_b128 v[32:35], v4 offset:3072
v_mfma_f32_16x16x32_bf16 v[64:67], v[40:43], v[90:93], v[64:67]
ds_read_b128 v[36:39], v5 offset:768
v_mfma_f32_16x16x32_bf16 v[76:79], v[12:15], v[100:103], v[240:243]
v_rcp_f32 v62, v61
v_cndmask_b32 v92, 0, v166, s[8:9]
v_mfma_f32_16x16x32_bf16 v[72:75], v[8:11], v[100:103], 0
v_pk_mul_f32 v[56:57], v[56:57], v[62:63] op_sel_hi:[1,0]
v_pk_mul_f32 v[58:59], v[58:59], v[62:63] op_sel_hi:[1,0]
v_mfma_f32_16x16x32_bf16 v[76:79], v[44:47], v[88:91], v[76:79]
v_mul_f32 v60, v60, v62
v_cvt_pk_bf16_f32 v96, v56, v57
v_mfma_f32_16x16x32_bf16 v[72:75], v[40:43], v[88:91], v[72:75]
v_cvt_pk_bf16_f32 v97, v58, v59
v_cndmask_b32 v93, 0, v167, s[8:9]
v_mfma_f32_16x16x32_bf16 v[84:87], v[20:23], v[108:111], v[240:243]
v_rcp_f32 v70, v69
v_cndmask_b32 v88, 0, v160, s[10:11]
v_pk_mul_f32 v[64:65], v[64:65], v[70:71] op_sel_hi:[1,0]
v_mfma_f32_16x16x32_bf16 v[80:83], v[16:19], v[108:111], 0
v_pk_mul_f32 v[66:67], v[66:67], v[70:71] op_sel_hi:[1,0]
v_mul_f32 v68, v68, v70
v_cvt_pk_bf16_f32 v98, v60, v64
v_mfma_f32_16x16x32_bf16 v[84:87], v[44:47], v[90:93], v[84:87]
v_cvt_pk_bf16_f32 v99, v65, v66
v_cvt_pk_bf16_f32 v104, v67, v68
v_mfma_f32_16x16x32_bf16 v[80:83], v[40:43], v[90:93], v[80:83]
buffer_store_dwordx4 v[96:99], v2, s[40:43], s56 offen offset:0 sc1
v_cndmask_b32 v89, 0, v161, s[10:11]
s_waitcnt lgkmcnt(0)
v_mfma_f32_16x16x32_bf16 v[60:63], v[28:31], v[112:115], v[240:243]
v_rcp_f32 v78, v77
v_cndmask_b32 v92, 0, v162, s[10:11]
v_pk_mul_f32 v[72:73], v[72:73], v[78:79] op_sel_hi:[1,0]
v_mfma_f32_16x16x32_bf16 v[56:59], v[24:27], v[112:115], 0
v_pk_mul_f32 v[74:75], v[74:75], v[78:79] op_sel_hi:[1,0]
v_mul_f32 v76, v76, v78
v_cvt_pk_bf16_f32 v100, v72, v73
v_mfma_f32_16x16x32_bf16 v[60:63], v[44:47], v[88:91], v[60:63]
v_cvt_pk_bf16_f32 v101, v74, v75
v_cndmask_b32 v93, 0, v163, s[10:11]
v_mfma_f32_16x16x32_bf16 v[56:59], v[40:43], v[88:91], v[56:59]
ds_read_b128 v[8:11], v4 offset:4096
ds_read_b128 v[12:15], v5 offset:1024
v_mfma_f32_16x16x32_bf16 v[68:71], v[36:39], v[120:123], v[240:243]
v_rcp_f32 v86, v85
v_cndmask_b32 v88, 0, v164, s[10:11]
v_pk_mul_f32 v[80:81], v[80:81], v[86:87] op_sel_hi:[1,0]
v_mfma_f32_16x16x32_bf16 v[64:67], v[32:35], v[120:123], 0
v_pk_mul_f32 v[82:83], v[82:83], v[86:87] op_sel_hi:[1,0]
v_mul_f32 v84, v84, v86
v_cvt_pk_bf16_f32 v102, v76, v80
v_mfma_f32_16x16x32_bf16 v[68:71], v[44:47], v[90:93], v[68:71]
v_cvt_pk_bf16_f32 v103, v81, v82
v_cvt_pk_bf16_f32 v108, v83, v84
buffer_store_dwordx4 v[100:103], v2, s[40:43], s56 offen offset:1024 sc1
v_mfma_f32_16x16x32_bf16 v[64:67], v[40:43], v[90:93], v[64:67]
v_cndmask_b32 v89, 0, v165, s[10:11]
ds_read_b128 v[16:19], v4 offset:5120
ds_read_b128 v[20:23], v5 offset:1280
v_mfma_f32_16x16x32_bf16 v[76:79], v[28:31], v[116:119], v[240:243]
v_rcp_f32 v62, v61
v_cndmask_b32 v92, 0, v166, s[10:11]
v_mfma_f32_16x16x32_bf16 v[72:75], v[24:27], v[116:119], 0
v_pk_mul_f32 v[56:57], v[56:57], v[62:63] op_sel_hi:[1,0]
v_pk_mul_f32 v[58:59], v[58:59], v[62:63] op_sel_hi:[1,0]
v_mfma_f32_16x16x32_bf16 v[76:79], v[44:47], v[88:91], v[76:79]
v_mul_f32 v60, v60, v62
v_cvt_pk_bf16_f32 v105, v56, v57
v_mfma_f32_16x16x32_bf16 v[72:75], v[40:43], v[88:91], v[72:75]
v_cvt_pk_bf16_f32 v106, v58, v59
v_cndmask_b32 v93, 0, v167, s[10:11]
v_mfma_f32_16x16x32_bf16 v[84:87], v[36:39], v[124:127], v[240:243]
v_rcp_f32 v70, v69
v_cndmask_b32 v88, 0, v160, s[12:13]
v_pk_mul_f32 v[64:65], v[64:65], v[70:71] op_sel_hi:[1,0]
v_mfma_f32_16x16x32_bf16 v[80:83], v[32:35], v[124:127], 0
v_pk_mul_f32 v[66:67], v[66:67], v[70:71] op_sel_hi:[1,0]
v_mul_f32 v68, v68, v70
v_cvt_pk_bf16_f32 v107, v60, v64
v_mfma_f32_16x16x32_bf16 v[84:87], v[44:47], v[90:93], v[84:87]
v_cvt_pk_bf16_f32 v112, v65, v66
v_cvt_pk_bf16_f32 v113, v67, v68
v_mfma_f32_16x16x32_bf16 v[80:83], v[40:43], v[90:93], v[80:83]
buffer_store_dwordx4 v[104:107], v2, s[40:43], s56 offen offset:2048 sc1
v_cndmask_b32 v89, 0, v161, s[12:13]
s_waitcnt lgkmcnt(0)
v_mfma_f32_16x16x32_bf16 v[60:63], v[12:15], v[128:131], v[240:243]
v_rcp_f32 v78, v77
v_cndmask_b32 v92, 0, v162, s[12:13]
v_pk_mul_f32 v[72:73], v[72:73], v[78:79] op_sel_hi:[1,0]
v_mfma_f32_16x16x32_bf16 v[56:59], v[8:11], v[128:131], 0
v_pk_mul_f32 v[74:75], v[74:75], v[78:79] op_sel_hi:[1,0]
v_mul_f32 v76, v76, v78
v_cvt_pk_bf16_f32 v109, v72, v73
v_mfma_f32_16x16x32_bf16 v[60:63], v[44:47], v[88:91], v[60:63]
v_cvt_pk_bf16_f32 v110, v74, v75
v_cndmask_b32 v93, 0, v163, s[12:13]
v_mfma_f32_16x16x32_bf16 v[56:59], v[40:43], v[88:91], v[56:59]
ds_read_b128 v[24:27], v4 offset:6144
ds_read_b128 v[28:31], v5 offset:1536
v_mfma_f32_16x16x32_bf16 v[68:71], v[20:23], v[136:139], v[240:243]
v_rcp_f32 v86, v85
v_cndmask_b32 v88, 0, v164, s[12:13]
v_pk_mul_f32 v[80:81], v[80:81], v[86:87] op_sel_hi:[1,0]
v_mfma_f32_16x16x32_bf16 v[64:67], v[16:19], v[136:139], 0
v_pk_mul_f32 v[82:83], v[82:83], v[86:87] op_sel_hi:[1,0]
v_mul_f32 v84, v84, v86
v_cvt_pk_bf16_f32 v111, v76, v80
v_mfma_f32_16x16x32_bf16 v[68:71], v[44:47], v[90:93], v[68:71]
v_cvt_pk_bf16_f32 v116, v81, v82
v_cvt_pk_bf16_f32 v117, v83, v84
buffer_store_dwordx4 v[108:111], v2, s[40:43], s56 offen offset:3072 sc1
v_mfma_f32_16x16x32_bf16 v[64:67], v[40:43], v[90:93], v[64:67]
v_cndmask_b32 v89, 0, v165, s[12:13]
ds_read_b128 v[32:35], v4 offset:7168
ds_read_b128 v[36:39], v5 offset:1792
v_mfma_f32_16x16x32_bf16 v[76:79], v[12:15], v[132:135], v[240:243]
v_rcp_f32 v62, v61
v_cndmask_b32 v92, 0, v166, s[12:13]
v_mfma_f32_16x16x32_bf16 v[72:75], v[8:11], v[132:135], 0
v_pk_mul_f32 v[56:57], v[56:57], v[62:63] op_sel_hi:[1,0]
v_pk_mul_f32 v[58:59], v[58:59], v[62:63] op_sel_hi:[1,0]
v_mfma_f32_16x16x32_bf16 v[76:79], v[44:47], v[88:91], v[76:79]
v_mul_f32 v60, v60, v62
v_cvt_pk_bf16_f32 v114, v56, v57
v_mfma_f32_16x16x32_bf16 v[72:75], v[40:43], v[88:91], v[72:75]
v_cvt_pk_bf16_f32 v115, v58, v59
v_cndmask_b32 v93, 0, v167, s[12:13]
v_mfma_f32_16x16x32_bf16 v[84:87], v[20:23], v[140:143], v[240:243]
v_rcp_f32 v70, v69
v_cndmask_b32 v88, 0, v160, s[14:15]
v_pk_mul_f32 v[64:65], v[64:65], v[70:71] op_sel_hi:[1,0]
v_mfma_f32_16x16x32_bf16 v[80:83], v[16:19], v[140:143], 0
v_pk_mul_f32 v[66:67], v[66:67], v[70:71] op_sel_hi:[1,0]
v_mul_f32 v68, v68, v70
v_cvt_pk_bf16_f32 v120, v60, v64
v_mfma_f32_16x16x32_bf16 v[84:87], v[44:47], v[90:93], v[84:87]
v_cvt_pk_bf16_f32 v121, v65, v66
v_cvt_pk_bf16_f32 v122, v67, v68
v_mfma_f32_16x16x32_bf16 v[80:83], v[40:43], v[90:93], v[80:83]
buffer_store_dwordx4 v[112:115], v6, s[40:43], s56 offen offset:0 sc1
v_cndmask_b32 v89, 0, v161, s[14:15]
s_waitcnt lgkmcnt(0)
v_mfma_f32_16x16x32_bf16 v[60:63], v[28:31], v[144:147], v[240:243]
v_rcp_f32 v78, v77
v_cndmask_b32 v92, 0, v162, s[14:15]
v_pk_mul_f32 v[72:73], v[72:73], v[78:79] op_sel_hi:[1,0]
v_mfma_f32_16x16x32_bf16 v[56:59], v[24:27], v[144:147], 0
v_pk_mul_f32 v[74:75], v[74:75], v[78:79] op_sel_hi:[1,0]
v_mul_f32 v76, v76, v78
v_cvt_pk_bf16_f32 v118, v72, v73
v_mfma_f32_16x16x32_bf16 v[60:63], v[44:47], v[88:91], v[60:63]
v_cvt_pk_bf16_f32 v119, v74, v75
v_cndmask_b32 v93, 0, v163, s[14:15]
v_mfma_f32_16x16x32_bf16 v[56:59], v[40:43], v[88:91], v[56:59]
ds_read_b128 v[8:11], v4 offset:12288
ds_read_b128 v[12:15], v5 offset:12288
v_mfma_f32_16x16x32_bf16 v[68:71], v[36:39], v[152:155], v[240:243]
v_rcp_f32 v86, v85
v_cndmask_b32 v88, 0, v164, s[14:15]
v_pk_mul_f32 v[80:81], v[80:81], v[86:87] op_sel_hi:[1,0]
v_mfma_f32_16x16x32_bf16 v[64:67], v[32:35], v[152:155], 0
v_pk_mul_f32 v[82:83], v[82:83], v[86:87] op_sel_hi:[1,0]
v_mul_f32 v84, v84, v86
v_cvt_pk_bf16_f32 v124, v76, v80
v_mfma_f32_16x16x32_bf16 v[68:71], v[44:47], v[90:93], v[68:71]
v_cvt_pk_bf16_f32 v125, v81, v82
v_cvt_pk_bf16_f32 v126, v83, v84
buffer_store_dwordx4 v[116:119], v6, s[40:43], s56 offen offset:1024 sc1
v_mfma_f32_16x16x32_bf16 v[64:67], v[40:43], v[90:93], v[64:67]
v_cndmask_b32 v89, 0, v165, s[14:15]
ds_read_b128 v[16:19], v4 offset:13312
ds_read_b128 v[20:23], v5 offset:12544
v_mfma_f32_16x16x32_bf16 v[76:79], v[28:31], v[148:151], v[240:243]
v_rcp_f32 v62, v61
v_cndmask_b32 v92, 0, v166, s[14:15]
v_mfma_f32_16x16x32_bf16 v[72:75], v[24:27], v[148:151], 0
v_pk_mul_f32 v[56:57], v[56:57], v[62:63] op_sel_hi:[1,0]
v_pk_mul_f32 v[58:59], v[58:59], v[62:63] op_sel_hi:[1,0]
v_mfma_f32_16x16x32_bf16 v[76:79], v[44:47], v[88:91], v[76:79]
v_mul_f32 v60, v60, v62
v_cvt_pk_bf16_f32 v123, v56, v57
v_mfma_f32_16x16x32_bf16 v[72:75], v[40:43], v[88:91], v[72:75]
v_cvt_pk_bf16_f32 v128, v58, v59
v_cndmask_b32 v93, 0, v167, s[14:15]
v_mfma_f32_16x16x32_bf16 v[84:87], v[36:39], v[156:159], v[240:243]
v_rcp_f32 v70, v69
v_cndmask_b32 v88, 0, v232, s[8:9]
v_pk_mul_f32 v[64:65], v[64:65], v[70:71] op_sel_hi:[1,0]
v_mfma_f32_16x16x32_bf16 v[80:83], v[32:35], v[156:159], 0
v_pk_mul_f32 v[66:67], v[66:67], v[70:71] op_sel_hi:[1,0]
v_mul_f32 v68, v68, v70
v_cvt_pk_bf16_f32 v129, v60, v64
v_mfma_f32_16x16x32_bf16 v[84:87], v[44:47], v[90:93], v[84:87]
v_cvt_pk_bf16_f32 v130, v65, v66
v_cvt_pk_bf16_f32 v131, v67, v68
buffer_store_dwordx4 v[120:123], v6, s[40:43], s56 offen offset:2048 sc1
v_mfma_f32_16x16x32_bf16 v[80:83], v[40:43], v[90:93], v[80:83]
buffer_store_dwordx4 v[128:131], v7, s[40:43], s56 offen offset:0 sc1
v_cndmask_b32 v89, 0, v233, s[8:9]
s_waitcnt lgkmcnt(0)
v_mfma_f32_16x16x32_bf16 v[60:63], v[12:15], v[168:171], v[240:243]
v_rcp_f32 v78, v77
v_cndmask_b32 v92, 0, v234, s[8:9]
v_pk_mul_f32 v[72:73], v[72:73], v[78:79] op_sel_hi:[1,0]
v_mfma_f32_16x16x32_bf16 v[56:59], v[8:11], v[168:171], 0
v_pk_mul_f32 v[74:75], v[74:75], v[78:79] op_sel_hi:[1,0]
v_mul_f32 v76, v76, v78
v_cvt_pk_bf16_f32 v127, v72, v73
v_mfma_f32_16x16x32_bf16 v[60:63], v[52:55], v[88:91], v[60:63]
v_cvt_pk_bf16_f32 v132, v74, v75
v_cndmask_b32 v93, 0, v235, s[8:9]
v_mfma_f32_16x16x32_bf16 v[56:59], v[48:51], v[88:91], v[56:59]
ds_read_b128 v[24:27], v4 offset:14336
ds_read_b128 v[28:31], v5 offset:12800
v_mfma_f32_16x16x32_bf16 v[68:71], v[20:23], v[176:179], v[240:243]
v_rcp_f32 v86, v85
v_cndmask_b32 v88, 0, v236, s[8:9]
v_pk_mul_f32 v[80:81], v[80:81], v[86:87] op_sel_hi:[1,0]
v_pk_mul_f32 v[82:83], v[82:83], v[86:87] op_sel_hi:[1,0]
v_mfma_f32_16x16x32_bf16 v[64:67], v[16:19], v[176:179], 0
v_mul_f32 v84, v84, v86
v_cvt_pk_bf16_f32 v133, v76, v80
v_cvt_pk_bf16_f32 v134, v81, v82
v_mfma_f32_16x16x32_bf16 v[68:71], v[52:55], v[90:93], v[68:71]
v_cvt_pk_bf16_f32 v135, v83, v84
buffer_store_dwordx4 v[124:127], v6, s[40:43], s56 offen offset:3072 sc1
buffer_store_dwordx4 v[132:135], v7, s[40:43], s56 offen offset:1024 sc1
v_mfma_f32_16x16x32_bf16 v[64:67], v[48:51], v[90:93], v[64:67]
v_cndmask_b32 v89, 0, v237, s[8:9]
ds_read_b128 v[32:35], v4 offset:15360
ds_read_b128 v[36:39], v5 offset:13056
v_mfma_f32_16x16x32_bf16 v[76:79], v[12:15], v[172:175], v[240:243]
v_rcp_f32 v62, v61
v_cndmask_b32 v92, 0, v238, s[8:9]
v_mfma_f32_16x16x32_bf16 v[72:75], v[8:11], v[172:175], 0
v_pk_mul_f32 v[56:57], v[56:57], v[62:63] op_sel_hi:[1,0]
v_pk_mul_f32 v[58:59], v[58:59], v[62:63] op_sel_hi:[1,0]
v_mfma_f32_16x16x32_bf16 v[76:79], v[52:55], v[88:91], v[76:79]
v_mul_f32 v60, v60, v62
v_cvt_pk_bf16_f32 v168, v56, v57
v_mfma_f32_16x16x32_bf16 v[72:75], v[48:51], v[88:91], v[72:75]
v_cvt_pk_bf16_f32 v169, v58, v59
v_cndmask_b32 v93, 0, v239, s[8:9]
v_mfma_f32_16x16x32_bf16 v[84:87], v[20:23], v[180:183], v[240:243]
v_rcp_f32 v70, v69
v_cndmask_b32 v88, 0, v232, s[10:11]
v_pk_mul_f32 v[64:65], v[64:65], v[70:71] op_sel_hi:[1,0]
v_mfma_f32_16x16x32_bf16 v[80:83], v[16:19], v[180:183], 0
v_pk_mul_f32 v[66:67], v[66:67], v[70:71] op_sel_hi:[1,0]
v_mul_f32 v68, v68, v70
v_cvt_pk_bf16_f32 v170, v60, v64
v_mfma_f32_16x16x32_bf16 v[84:87], v[52:55], v[90:93], v[84:87]
v_cvt_pk_bf16_f32 v171, v65, v66
v_cvt_pk_bf16_f32 v176, v67, v68
v_mfma_f32_16x16x32_bf16 v[80:83], v[48:51], v[90:93], v[80:83]
buffer_store_dwordx4 v[168:171], v2, s[40:43], s57 offen offset:0 sc1
v_cndmask_b32 v89, 0, v233, s[10:11]
s_waitcnt lgkmcnt(0)
v_mfma_f32_16x16x32_bf16 v[60:63], v[28:31], v[184:187], v[240:243]
v_rcp_f32 v78, v77
v_cndmask_b32 v92, 0, v234, s[10:11]
v_pk_mul_f32 v[72:73], v[72:73], v[78:79] op_sel_hi:[1,0]
v_mfma_f32_16x16x32_bf16 v[56:59], v[24:27], v[184:187], 0
v_pk_mul_f32 v[74:75], v[74:75], v[78:79] op_sel_hi:[1,0]
v_mul_f32 v76, v76, v78
v_cvt_pk_bf16_f32 v172, v72, v73
v_mfma_f32_16x16x32_bf16 v[60:63], v[52:55], v[88:91], v[60:63]
v_cvt_pk_bf16_f32 v173, v74, v75
v_cndmask_b32 v93, 0, v235, s[10:11]
v_mfma_f32_16x16x32_bf16 v[56:59], v[48:51], v[88:91], v[56:59]
ds_read_b128 v[8:11], v4 offset:16384
ds_read_b128 v[12:15], v5 offset:13312
v_mfma_f32_16x16x32_bf16 v[68:71], v[36:39], v[192:195], v[240:243]
v_rcp_f32 v86, v85
v_cndmask_b32 v88, 0, v236, s[10:11]
v_pk_mul_f32 v[80:81], v[80:81], v[86:87] op_sel_hi:[1,0]
v_mfma_f32_16x16x32_bf16 v[64:67], v[32:35], v[192:195], 0
v_pk_mul_f32 v[82:83], v[82:83], v[86:87] op_sel_hi:[1,0]
v_mul_f32 v84, v84, v86
v_cvt_pk_bf16_f32 v174, v76, v80
v_mfma_f32_16x16x32_bf16 v[68:71], v[52:55], v[90:93], v[68:71]
v_cvt_pk_bf16_f32 v175, v81, v82
v_cvt_pk_bf16_f32 v180, v83, v84
buffer_store_dwordx4 v[172:175], v2, s[40:43], s57 offen offset:1024 sc1
v_mfma_f32_16x16x32_bf16 v[64:67], v[48:51], v[90:93], v[64:67]
v_cndmask_b32 v89, 0, v237, s[10:11]
ds_read_b128 v[16:19], v4 offset:17408
ds_read_b128 v[20:23], v5 offset:13568
v_mfma_f32_16x16x32_bf16 v[76:79], v[28:31], v[188:191], v[240:243]
v_rcp_f32 v62, v61
v_cndmask_b32 v92, 0, v238, s[10:11]
v_mfma_f32_16x16x32_bf16 v[72:75], v[24:27], v[188:191], 0
v_pk_mul_f32 v[56:57], v[56:57], v[62:63] op_sel_hi:[1,0]
v_pk_mul_f32 v[58:59], v[58:59], v[62:63] op_sel_hi:[1,0]
v_mfma_f32_16x16x32_bf16 v[76:79], v[52:55], v[88:91], v[76:79]
v_mul_f32 v60, v60, v62
v_cvt_pk_bf16_f32 v177, v56, v57
v_mfma_f32_16x16x32_bf16 v[72:75], v[48:51], v[88:91], v[72:75]
v_cvt_pk_bf16_f32 v178, v58, v59
v_cndmask_b32 v93, 0, v239, s[10:11]
v_mfma_f32_16x16x32_bf16 v[84:87], v[36:39], v[196:199], v[240:243]
v_rcp_f32 v70, v69
v_cndmask_b32 v88, 0, v232, s[12:13]
v_pk_mul_f32 v[64:65], v[64:65], v[70:71] op_sel_hi:[1,0]
v_mfma_f32_16x16x32_bf16 v[80:83], v[32:35], v[196:199], 0
v_pk_mul_f32 v[66:67], v[66:67], v[70:71] op_sel_hi:[1,0]
v_mul_f32 v68, v68, v70
v_cvt_pk_bf16_f32 v179, v60, v64
v_mfma_f32_16x16x32_bf16 v[84:87], v[52:55], v[90:93], v[84:87]
v_cvt_pk_bf16_f32 v184, v65, v66
v_cvt_pk_bf16_f32 v185, v67, v68
v_mfma_f32_16x16x32_bf16 v[80:83], v[48:51], v[90:93], v[80:83]
buffer_store_dwordx4 v[176:179], v2, s[40:43], s57 offen offset:2048 sc1
v_cndmask_b32 v89, 0, v233, s[12:13]
s_waitcnt lgkmcnt(0)
v_mfma_f32_16x16x32_bf16 v[60:63], v[12:15], v[200:203], v[240:243]
v_rcp_f32 v78, v77
v_cndmask_b32 v92, 0, v234, s[12:13]
v_pk_mul_f32 v[72:73], v[72:73], v[78:79] op_sel_hi:[1,0]
v_mfma_f32_16x16x32_bf16 v[56:59], v[8:11], v[200:203], 0
v_pk_mul_f32 v[74:75], v[74:75], v[78:79] op_sel_hi:[1,0]
v_mul_f32 v76, v76, v78
v_cvt_pk_bf16_f32 v181, v72, v73
v_mfma_f32_16x16x32_bf16 v[60:63], v[52:55], v[88:91], v[60:63]
v_cvt_pk_bf16_f32 v182, v74, v75
v_cndmask_b32 v93, 0, v235, s[12:13]
v_mfma_f32_16x16x32_bf16 v[56:59], v[48:51], v[88:91], v[56:59]
ds_read_b128 v[24:27], v4 offset:18432
ds_read_b128 v[28:31], v5 offset:13824
v_mfma_f32_16x16x32_bf16 v[68:71], v[20:23], v[208:211], v[240:243]
v_rcp_f32 v86, v85
v_cndmask_b32 v88, 0, v236, s[12:13]
v_pk_mul_f32 v[80:81], v[80:81], v[86:87] op_sel_hi:[1,0]
v_mfma_f32_16x16x32_bf16 v[64:67], v[16:19], v[208:211], 0
v_pk_mul_f32 v[82:83], v[82:83], v[86:87] op_sel_hi:[1,0]
v_mul_f32 v84, v84, v86
v_cvt_pk_bf16_f32 v183, v76, v80
v_mfma_f32_16x16x32_bf16 v[68:71], v[52:55], v[90:93], v[68:71]
v_cvt_pk_bf16_f32 v188, v81, v82
v_cvt_pk_bf16_f32 v189, v83, v84
buffer_store_dwordx4 v[180:183], v2, s[40:43], s57 offen offset:3072 sc1
v_mfma_f32_16x16x32_bf16 v[64:67], v[48:51], v[90:93], v[64:67]
v_cndmask_b32 v89, 0, v237, s[12:13]
ds_read_b128 v[32:35], v4 offset:19456
ds_read_b128 v[36:39], v5 offset:14080
v_mfma_f32_16x16x32_bf16 v[76:79], v[12:15], v[204:207], v[240:243]
v_rcp_f32 v62, v61
v_cndmask_b32 v92, 0, v238, s[12:13]
v_mfma_f32_16x16x32_bf16 v[72:75], v[8:11], v[204:207], 0
v_pk_mul_f32 v[56:57], v[56:57], v[62:63] op_sel_hi:[1,0]
v_pk_mul_f32 v[58:59], v[58:59], v[62:63] op_sel_hi:[1,0]
v_mfma_f32_16x16x32_bf16 v[76:79], v[52:55], v[88:91], v[76:79]
v_mul_f32 v60, v60, v62
v_cvt_pk_bf16_f32 v186, v56, v57
v_mfma_f32_16x16x32_bf16 v[72:75], v[48:51], v[88:91], v[72:75]
v_cvt_pk_bf16_f32 v187, v58, v59
v_cndmask_b32 v93, 0, v239, s[12:13]
v_mfma_f32_16x16x32_bf16 v[84:87], v[20:23], v[212:215], v[240:243]
v_rcp_f32 v70, v69
v_cndmask_b32 v88, 0, v232, s[14:15]
v_pk_mul_f32 v[64:65], v[64:65], v[70:71] op_sel_hi:[1,0]
v_mfma_f32_16x16x32_bf16 v[80:83], v[16:19], v[212:215], 0
v_pk_mul_f32 v[66:67], v[66:67], v[70:71] op_sel_hi:[1,0]
v_mul_f32 v68, v68, v70
v_cvt_pk_bf16_f32 v192, v60, v64
v_mfma_f32_16x16x32_bf16 v[84:87], v[52:55], v[90:93], v[84:87]
v_cvt_pk_bf16_f32 v193, v65, v66
v_cvt_pk_bf16_f32 v194, v67, v68
v_mfma_f32_16x16x32_bf16 v[80:83], v[48:51], v[90:93], v[80:83]
buffer_store_dwordx4 v[184:187], v6, s[40:43], s57 offen offset:0 sc1
v_cndmask_b32 v89, 0, v233, s[14:15]
s_waitcnt lgkmcnt(0)
v_mfma_f32_16x16x32_bf16 v[60:63], v[28:31], v[216:219], v[240:243]
v_rcp_f32 v78, v77
v_cndmask_b32 v92, 0, v234, s[14:15]
v_mfma_f32_16x16x32_bf16 v[56:59], v[24:27], v[216:219], 0
v_pk_mul_f32 v[72:73], v[72:73], v[78:79] op_sel_hi:[1,0]
v_pk_mul_f32 v[74:75], v[74:75], v[78:79] op_sel_hi:[1,0]
v_mfma_f32_16x16x32_bf16 v[60:63], v[52:55], v[88:91], v[60:63]
v_mul_f32 v76, v76, v78
v_cvt_pk_bf16_f32 v190, v72, v73
v_mfma_f32_16x16x32_bf16 v[56:59], v[48:51], v[88:91], v[56:59]
v_cvt_pk_bf16_f32 v191, v74, v75
v_cndmask_b32 v93, 0, v235, s[14:15]
v_mfma_f32_16x16x32_bf16 v[68:71], v[36:39], v[224:227], v[240:243]
v_rcp_f32 v86, v85
v_cndmask_b32 v88, 0, v236, s[14:15]
v_pk_mul_f32 v[80:81], v[80:81], v[86:87] op_sel_hi:[1,0]
v_mfma_f32_16x16x32_bf16 v[64:67], v[32:35], v[224:227], 0
v_pk_mul_f32 v[82:83], v[82:83], v[86:87] op_sel_hi:[1,0]
v_mul_f32 v84, v84, v86
v_cvt_pk_bf16_f32 v196, v76, v80
v_mfma_f32_16x16x32_bf16 v[68:71], v[52:55], v[90:93], v[68:71]
v_cvt_pk_bf16_f32 v197, v81, v82
v_cvt_pk_bf16_f32 v198, v83, v84
v_mfma_f32_16x16x32_bf16 v[64:67], v[48:51], v[90:93], v[64:67]
buffer_store_dwordx4 v[188:191], v6, s[40:43], s57 offen offset:1024 sc1
v_cndmask_b32 v89, 0, v237, s[14:15]
v_mfma_f32_16x16x32_bf16 v[76:79], v[28:31], v[220:223], v[240:243]
v_rcp_f32 v62, v61
v_cndmask_b32 v92, 0, v238, s[14:15]
v_mfma_f32_16x16x32_bf16 v[72:75], v[24:27], v[220:223], 0
v_pk_mul_f32 v[56:57], v[56:57], v[62:63] op_sel_hi:[1,0]
v_pk_mul_f32 v[58:59], v[58:59], v[62:63] op_sel_hi:[1,0]
v_mfma_f32_16x16x32_bf16 v[76:79], v[52:55], v[88:91], v[76:79]
v_mul_f32 v60, v60, v62
v_cvt_pk_bf16_f32 v195, v56, v57
v_mfma_f32_16x16x32_bf16 v[72:75], v[48:51], v[88:91], v[72:75]
v_cvt_pk_bf16_f32 v200, v58, v59
v_cndmask_b32 v93, 0, v239, s[14:15]
v_mfma_f32_16x16x32_bf16 v[84:87], v[36:39], v[228:231], v[240:243]
v_rcp_f32 v70, v69
s_nop 0
v_pk_mul_f32 v[64:65], v[64:65], v[70:71] op_sel_hi:[1,0]
v_mfma_f32_16x16x32_bf16 v[80:83], v[32:35], v[228:231], 0
v_pk_mul_f32 v[66:67], v[66:67], v[70:71] op_sel_hi:[1,0]
v_mul_f32 v68, v68, v70
v_cvt_pk_bf16_f32 v201, v60, v64
v_mfma_f32_16x16x32_bf16 v[84:87], v[52:55], v[90:93], v[84:87]
v_cvt_pk_bf16_f32 v202, v65, v66
v_cvt_pk_bf16_f32 v203, v67, v68
buffer_store_dwordx4 v[192:195], v6, s[40:43], s57 offen offset:2048 sc1
v_mfma_f32_16x16x32_bf16 v[80:83], v[48:51], v[90:93], v[80:83]
buffer_store_dwordx4 v[200:203], v7, s[40:43], s57 offen offset:0 sc1
s_nop 0
v_rcp_f32 v78, v77
s_nop 0
v_pk_mul_f32 v[72:73], v[72:73], v[78:79] op_sel_hi:[1,0]
v_pk_mul_f32 v[74:75], v[74:75], v[78:79] op_sel_hi:[1,0]
v_mul_f32 v76, v76, v78
v_cvt_pk_bf16_f32 v199, v72, v73
v_cvt_pk_bf16_f32 v204, v74, v75
v_rcp_f32 v86, v85
s_nop 0
v_pk_mul_f32 v[80:81], v[80:81], v[86:87] op_sel_hi:[1,0]
v_pk_mul_f32 v[82:83], v[82:83], v[86:87] op_sel_hi:[1,0]
v_mul_f32 v84, v84, v86
v_cvt_pk_bf16_f32 v205, v76, v80
v_cvt_pk_bf16_f32 v206, v81, v82
v_cvt_pk_bf16_f32 v207, v83, v84
buffer_store_dwordx4 v[196:199], v6, s[40:43], s57 offen offset:3072 sc1
buffer_store_dwordx4 v[204:207], v7, s[40:43], s57 offen offset:1024 sc1
s_nop 1
s_branch K2_cq
K1_ldF:
s_add_u32 s8, s26, 4718592
s_addc_u32 s9, s27, 0
s_mov_b32 s10, 1990656
s_mov_b32 s11, 0x20000
s_sub_u32 s17, s16, 4
s_mul_i32 s21, s23, 331776
v_and_b32 v1, 63, v0
v_lshlrev_b32 v1, 4, v1
s_mul_i32 s18, s17, 9216
v_add_u32 v2, s18, v1
v_add_u32 v3, 4096, v2
v_add_u32 v4, 8192, v2
s_mov_b32 s20, 3
s_lshl_b32 s3, s17, 2
s_add_u32 s3, s3, s23
s_add_u32 s3, s3, 4
s_lshl_b32 s19, s23, 1
s_add_u32 s19, s19, s17
s_sub_u32 s19, s19, 8
s_cmp_ge_u32 s23, 4
s_cselect_b32 s3, s19, s3
s_mul_i32 s3, s3, 36
s_add_u32 s3, s3, 256
v_and_b32 v8, 63, v0
v_min_u32 v8, 35, v8
v_add_lshl_u32 v8, v8, s3, 7
s_mov_b64 exec, 1
s_mov_b32 s63, 60000
Lp_27:
buffer_load_dwordx2 v[10:11], v8, s[96:99], 0 offen sc1
s_waitcnt vmcnt(0)
v_cmp_ne_u64 vcc, s[100:101], v[10:11]
s_sub_u32 s63, s63, 1
s_cbranch_scc1 Lx_28
s_nop 2
s_cbranch_vccz Lx_28
s_mov_b64 exec, vcc
s_sleep 6
s_branch Lp_27
Lx_28:
s_mov_b64 exec, -1
Ls_26:
s_mov_b32 s63, 60000
Lp_29:
buffer_load_dwordx2 v[10:11], v8, s[96:99], 0 offen sc1
s_waitcnt vmcnt(0)
v_cmp_ne_u64 vcc, s[100:101], v[10:11]
s_sub_u32 s63, s63, 1
s_cbranch_scc1 Lx_30
s_nop 2
s_cbranch_vccz Lx_30
s_mov_b64 exec, vcc
s_branch Lp_29
Lx_30:
s_mov_b64 exec, -1
s_add_u32 m0, s18, 0
s_nop 0
buffer_load_dwordx4 v2, s[8:11], s21 offen offset:0 sc1 lds
buffer_load_dwordx4 v2, s[8:11], s21 offen offset:1024 sc1 lds
buffer_load_dwordx4 v2, s[8:11], s21 offen offset:2048 sc1 lds
buffer_load_dwordx4 v2, s[8:11], s21 offen offset:3072 sc1 lds
s_add_u32 m0, s18, 4096
s_nop 0
buffer_load_dwordx4 v3, s[8:11], s21 offen offset:0 sc1 lds
buffer_load_dwordx4 v3, s[8:11], s21 offen offset:1024 sc1 lds
buffer_load_dwordx4 v3, s[8:11], s21 offen offset:2048 sc1 lds
buffer_load_dwordx4 v3, s[8:11], s21 offen offset:3072 sc1 lds
s_add_u32 m0, s18, 8192
s_nop 0
buffer_load_dwordx4 v4, s[8:11], s21 offen offset:0 sc1 lds
s_add_u32 s21, s21, 18432
s_add_u32 m0, s18, 36864
s_nop 0
buffer_load_dwordx4 v2, s[8:11], s21 offen offset:0 sc1 lds
buffer_load_dwordx4 v2, s[8:11], s21 offen offset:1024 sc1 lds
buffer_load_dwordx4 v2, s[8:11], s21 offen offset:2048 sc1 lds
buffer_load_dwordx4 v2, s[8:11], s21 offen offset:3072 sc1 lds
s_add_u32 m0, s18, 40960
s_nop 0
buffer_load_dwordx4 v3, s[8:11], s21 offen offset:0 sc1 lds
buffer_load_dwordx4 v3, s[8:11], s21 offen offset:1024 sc1 lds
buffer_load_dwordx4 v3, s[8:11], s21 offen offset:2048 sc1 lds
buffer_load_dwordx4 v3, s[8:11], s21 offen offset:3072 sc1 lds
s_add_u32 m0, s18, 45056
s_nop 0
buffer_load_dwordx4 v4, s[8:11], s21 offen offset:0 sc1 lds
s_add_u32 s21, s21, 18432
s_add_u32 m0, s18, 73728
s_nop 0
buffer_load_dwordx4 v2, s[8:11], s21 offen offset:0 sc1 lds
buffer_load_dwordx4 v2, s[8:11], s21 offen offset:1024 sc1 lds
buffer_load_dwordx4 v2, s[8:11], s21 offen offset:2048 sc1 lds
buffer_load_dwordx4 v2, s[8:11], s21 offen offset:3072 sc1 lds
s_add_u32 m0, s18, 77824
s_nop 0
buffer_load_dwordx4 v3, s[8:11], s21 offen offset:0 sc1 lds
buffer_load_dwordx4 v3, s[8:11], s21 offen offset:1024 sc1 lds
buffer_load_dwordx4 v3, s[8:11], s21 offen offset:2048 sc1 lds
buffer_load_dwordx4 v3, s[8:11], s21 offen offset:3072 sc1 lds
s_add_u32 m0, s18, 81920
s_nop 0
buffer_load_dwordx4 v4, s[8:11], s21 offen offset:0 sc1 lds
s_add_u32 s21, s21, 18432
Ll_25:
s_waitcnt vmcnt(18)
s_barrier
s_add_u32 m0, s18, 110592
s_nop 0
buffer_load_dwordx4 v2, s[8:11], s21 offen offset:0 sc1 lds
buffer_load_dwordx4 v2, s[8:11], s21 offen offset:1024 sc1 lds
buffer_load_dwordx4 v2, s[8:11], s21 offen offset:2048 sc1 lds
buffer_load_dwordx4 v2, s[8:11], s21 offen offset:3072 sc1 lds
s_add_u32 m0, s18, 114688
s_nop 0
buffer_load_dwordx4 v3, s[8:11], s21 offen offset:0 sc1 lds
buffer_load_dwordx4 v3, s[8:11], s21 offen offset:1024 sc1 lds
buffer_load_dwordx4 v3, s[8:11], s21 offen offset:2048 sc1 lds
buffer_load_dwordx4 v3, s[8:11], s21 offen offset:3072 sc1 lds
s_add_u32 m0, s18, 118784
s_nop 0
buffer_load_dwordx4 v4, s[8:11], s21 offen offset:0 sc1 lds
s_add_u32 s21, s21, 18432
s_waitcnt vmcnt(18)
s_barrier
s_add_u32 m0, s18, 0
s_nop 0
buffer_load_dwordx4 v2, s[8:11], s21 offen offset:0 sc1 lds
buffer_load_dwordx4 v2, s[8:11], s21 offen offset:1024 sc1 lds
buffer_load_dwordx4 v2, s[8:11], s21 offen offset:2048 sc1 lds
buffer_load_dwordx4 v2, s[8:11], s21 offen offset:3072 sc1 lds
s_add_u32 m0, s18, 4096
s_nop 0
buffer_load_dwordx4 v3, s[8:11], s21 offen offset:0 sc1 lds
buffer_load_dwordx4 v3, s[8:11], s21 offen offset:1024 sc1 lds
buffer_load_dwordx4 v3, s[8:11], s21 offen offset:2048 sc1 lds
buffer_load_dwordx4 v3, s[8:11], s21 offen offset:3072 sc1 lds
s_add_u32 m0, s18, 8192
s_nop 0
buffer_load_dwordx4 v4, s[8:11], s21 offen offset:0 sc1 lds
s_add_u32 s21, s21, 18432
Ll_25_2:
s_waitcnt vmcnt(18)
s_barrier
s_add_u32 m0, s18, 36864
s_nop 0
buffer_load_dwordx4 v2, s[8:11], s21 offen offset:0 sc1 lds
buffer_load_dwordx4 v2, s[8:11], s21 offen offset:1024 sc1 lds
buffer_load_dwordx4 v2, s[8:11], s21 offen offset:2048 sc1 lds
buffer_load_dwordx4 v2, s[8:11], s21 offen offset:3072 sc1 lds
s_add_u32 m0, s18, 40960
s_nop 0
buffer_load_dwordx4 v3, s[8:11], s21 offen offset:0 sc1 lds
buffer_load_dwordx4 v3, s[8:11], s21 offen offset:1024 sc1 lds
buffer_load_dwordx4 v3, s[8:11], s21 offen offset:2048 sc1 lds
buffer_load_dwordx4 v3, s[8:11], s21 offen offset:3072 sc1 lds
s_add_u32 m0, s18, 45056
s_nop 0
buffer_load_dwordx4 v4, s[8:11], s21 offen offset:0 sc1 lds
s_add_u32 s21, s21, 18432
Ll_25_3:
s_waitcnt vmcnt(18)
s_barrier
s_add_u32 m0, s18, 73728
s_nop 0
buffer_load_dwordx4 v2, s[8:11], s21 offen offset:0 sc1 lds
buffer_load_dwordx4 v2, s[8:11], s21 offen offset:1024 sc1 lds
buffer_load_dwordx4 v2, s[8:11], s21 offen offset:2048 sc1 lds
buffer_load_dwordx4 v2, s[8:11], s21 offen offset:3072 sc1 lds
s_add_u32 m0, s18, 77824
s_nop 0
buffer_load_dwordx4 v3, s[8:11], s21 offen offset:0 sc1 lds
buffer_load_dwordx4 v3, s[8:11], s21 offen offset:1024 sc1 lds
buffer_load_dwordx4 v3, s[8:11], s21 offen offset:2048 sc1 lds
buffer_load_dwordx4 v3, s[8:11], s21 offen offset:3072 sc1 lds
s_add_u32 m0, s18, 81920
s_nop 0
buffer_load_dwordx4 v4, s[8:11], s21 offen offset:0 sc1 lds
s_add_u32 s21, s21, 18432
s_sub_u32 s20, s20, 1
s_cmp_lg_u32 s20, 0
s_cbranch_scc1 Ll_25
Ll_25_e:
s_waitcnt vmcnt(18)
s_barrier
s_add_u32 m0, s18, 110592
s_nop 0
buffer_load_dwordx4 v2, s[8:11], s21 offen offset:0 sc1 lds
buffer_load_dwordx4 v2, s[8:11], s21 offen offset:1024 sc1 lds
buffer_load_dwordx4 v2, s[8:11], s21 offen offset:2048 sc1 lds
buffer_load_dwordx4 v2, s[8:11], s21 offen offset:3072 sc1 lds
s_add_u32 m0, s18, 114688
s_nop 0
buffer_load_dwordx4 v3, s[8:11], s21 offen offset:0 sc1 lds
buffer_load_dwordx4 v3, s[8:11], s21 offen offset:1024 sc1 lds
buffer_load_dwordx4 v3, s[8:11], s21 offen offset:2048 sc1 lds
buffer_load_dwordx4 v3, s[8:11], s21 offen offset:3072 sc1 lds
s_add_u32 m0, s18, 118784
s_nop 0
buffer_load_dwordx4 v4, s[8:11], s21 offen offset:0 sc1 lds
s_add_u32 s21, s21, 18432
s_waitcnt vmcnt(18)
s_barrier
s_add_u32 m0, s18, 0
s_nop 0
buffer_load_dwordx4 v2, s[8:11], s21 offen offset:0 sc1 lds
buffer_load_dwordx4 v2, s[8:11], s21 offen offset:1024 sc1 lds
buffer_load_dwordx4 v2, s[8:11], s21 offen offset:2048 sc1 lds
buffer_load_dwordx4 v2, s[8:11], s21 offen offset:3072 sc1 lds
s_add_u32 m0, s18, 4096
s_nop 0
buffer_load_dwordx4 v3, s[8:11], s21 offen offset:0 sc1 lds
buffer_load_dwordx4 v3, s[8:11], s21 offen offset:1024 sc1 lds
buffer_load_dwordx4 v3, s[8:11], s21 offen offset:2048 sc1 lds
buffer_load_dwordx4 v3, s[8:11], s21 offen offset:3072 sc1 lds
s_add_u32 m0, s18, 8192
s_nop 0
buffer_load_dwordx4 v4, s[8:11], s21 offen offset:0 sc1 lds
s_add_u32 s21, s21, 18432
s_waitcnt vmcnt(18)
s_barrier
s_add_u32 m0, s18, 36864
s_nop 0
buffer_load_dwordx4 v2, s[8:11], s21 offen offset:0 sc1 lds
buffer_load_dwordx4 v2, s[8:11], s21 offen offset:1024 sc1 lds
buffer_load_dwordx4 v2, s[8:11], s21 offen offset:2048 sc1 lds
buffer_load_dwordx4 v2, s[8:11], s21 offen offset:3072 sc1 lds
s_add_u32 m0, s18, 40960
s_nop 0
buffer_load_dwordx4 v3, s[8:11], s21 offen offset:0 sc1 lds
buffer_load_dwordx4 v3, s[8:11], s21 offen offset:1024 sc1 lds
buffer_load_dwordx4 v3, s[8:11], s21 offen offset:2048 sc1 lds
buffer_load_dwordx4 v3, s[8:11], s21 offen offset:3072 sc1 lds
s_add_u32 m0, s18, 45056
s_nop 0
buffer_load_dwordx4 v4, s[8:11], s21 offen offset:0 sc1 lds
s_add_u32 s21, s21, 18432
s_waitcnt vmcnt(18)
s_barrier
s_waitcnt vmcnt(9)
s_barrier
s_waitcnt vmcnt(0)
s_barrier
s_branch K1_ldtail
K1_ldX:
s_add_u32 s8, s26, 2359296
s_addc_u32 s9, s27, 0
s_mov_b32 s10, 2359296
s_mov_b32 s11, 0x20000
s_sub_u32 s17, s16, 6
s_mul_i32 s21, s22, 36864
s_lshl_b32 s18, s17, 10
s_add_u32 s21, s21, s18
s_lshl_b32 s18, s17, 12
s_mov_b32 s19, s17
v_and_b32 v1, 63, v0
v_and_b32 v2, 16, v1
v_lshrrev_b32 v2, 2, v2
v_xor_b32 v2, v2, v1
v_lshlrev_b32 v2, 4, v2
v_add_u32 v3, 8192, v2
v_add_u32 v4, 16384, v2
v_add_u32 v5, 24576, v2
s_mov_b32 s20, 3
s_lshl_b32 s3, s22, 3
s_add_u32 s3, s3, 112
v_and_b32 v8, 7, v0
v_add_lshl_u32 v8, v8, s3, 7
s_mov_b64 exec, 1
s_mov_b32 s63, 60000
Lp_33:
buffer_load_dwordx2 v[10:11], v8, s[96:99], 0 offen sc1
s_waitcnt vmcnt(0)
v_cmp_ne_u64 vcc, s[100:101], v[10:11]
s_sub_u32 s63, s63, 1
s_cbranch_scc1 Lx_34
s_nop 2
s_cbranch_vccz Lx_34
s_mov_b64 exec, vcc
s_sleep 2
s_branch Lp_33
Lx_34:
s_mov_b64 exec, -1
Ls_32:
s_mov_b32 s63, 60000
Lp_35:
buffer_load_dwordx2 v[10:11], v8, s[96:99], 0 offen sc1
s_waitcnt vmcnt(0)
v_cmp_ne_u64 vcc, s[100:101], v[10:11]
s_sub_u32 s63, s63, 1
s_cbranch_scc1 Lx_36
s_nop 2
s_cbranch_vccz Lx_36
s_mov_b64 exec, vcc
s_branch Lp_35
Lx_36:
s_mov_b64 exec, -1
s_add_u32 m0, s18, 18432
s_add_u32 s19, s19, 2
buffer_load_dwordx4 v2, s[8:11], s21 offen offset:0 sc1 lds
buffer_load_dwordx4 v3, s[8:11], s21 offen offset:1024 sc1 lds
buffer_load_dwordx4 v4, s[8:11], s21 offen offset:2048 sc1 lds
buffer_load_dwordx4 v5, s[8:11], s21 offen offset:3072 sc1 lds
s_cmp_ge_u32 s19, 9
s_cselect_b32 s3, 9, 0
s_cselect_b32 s28, 580608, 0
s_sub_u32 s19, s19, s3
s_add_u32 s21, s21, s28
s_add_u32 s21, s21, 2048
s_add_u32 m0, s18, 55296
s_add_u32 s19, s19, 2
buffer_load_dwordx4 v2, s[8:11], s21 offen offset:0 sc1 lds
buffer_load_dwordx4 v3, s[8:11], s21 offen offset:1024 sc1 lds
buffer_load_dwordx4 v4, s[8:11], s21 offen offset:2048 sc1 lds
buffer_load_dwordx4 v5, s[8:11], s21 offen offset:3072 sc1 lds
s_cmp_ge_u32 s19, 9
s_cselect_b32 s3, 9, 0
s_cselect_b32 s28, 580608, 0
s_sub_u32 s19, s19, s3
s_add_u32 s21, s21, s28
s_add_u32 s21, s21, 2048
s_add_u32 m0, s18, 92160
s_add_u32 s19, s19, 2
buffer_load_dwordx4 v2, s[8:11], s21 offen offset:0 sc1 lds
buffer_load_dwordx4 v3, s[8:11], s21 offen offset:1024 sc1 lds
buffer_load_dwordx4 v4, s[8:11], s21 offen offset:2048 sc1 lds
buffer_load_dwordx4 v5, s[8:11], s21 offen offset:3072 sc1 lds
s_cmp_ge_u32 s19, 9
s_cselect_b32 s3, 9, 0
s_cselect_b32 s28, 580608, 0
s_sub_u32 s19, s19, s3
s_add_u32 s21, s21, s28
s_add_u32 s21, s21, 2048
Ll_31:
s_waitcnt vmcnt(8)
s_barrier
s_add_u32 m0, s18, 129024
s_add_u32 s19, s19, 2
buffer_load_dwordx4 v2, s[8:11], s21 offen offset:0 sc1 lds
buffer_load_dwordx4 v3, s[8:11], s21 offen offset:1024 sc1 lds
buffer_load_dwordx4 v4, s[8:11], s21 offen offset:2048 sc1 lds
buffer_load_dwordx4 v5, s[8:11], s21 offen offset:3072 sc1 lds
s_cmp_ge_u32 s19, 9
s_cselect_b32 s3, 9, 0
s_cselect_b32 s28, 580608, 0
s_sub_u32 s19, s19, s3
s_add_u32 s21, s21, s28
s_add_u32 s21, s21, 2048
s_waitcnt vmcnt(8)
s_barrier
s_add_u32 m0, s18, 18432
s_add_u32 s19, s19, 2
buffer_load_dwordx4 v2, s[8:11], s21 offen offset:0 sc1 lds
buffer_load_dwordx4 v3, s[8:11], s21 offen offset:1024 sc1 lds
buffer_load_dwordx4 v4, s[8:11], s21 offen offset:2048 sc1 lds
buffer_load_dwordx4 v5, s[8:11], s21 offen offset:3072 sc1 lds
s_cmp_ge_u32 s19, 9
s_cselect_b32 s3, 9, 0
s_cselect_b32 s28, 580608, 0
s_sub_u32 s19, s19, s3
s_add_u32 s21, s21, s28
s_add_u32 s21, s21, 2048
Ll_31_2:
s_waitcnt vmcnt(8)
s_barrier
s_add_u32 m0, s18, 55296
s_add_u32 s19, s19, 2
buffer_load_dwordx4 v2, s[8:11], s21 offen offset:0 sc1 lds
buffer_load_dwordx4 v3, s[8:11], s21 offen offset:1024 sc1 lds
buffer_load_dwordx4 v4, s[8:11], s21 offen offset:2048 sc1 lds
buffer_load_dwordx4 v5, s[8:11], s21 offen offset:3072 sc1 lds
s_cmp_ge_u32 s19, 9
s_cselect_b32 s3, 9, 0
s_cselect_b32 s28, 580608, 0
s_sub_u32 s19, s19, s3
s_add_u32 s21, s21, s28
s_add_u32 s21, s21, 2048
Ll_31_3:
s_waitcnt vmcnt(8)
s_barrier
s_add_u32 m0, s18, 92160
s_add_u32 s19, s19, 2
buffer_load_dwordx4 v2, s[8:11], s21 offen offset:0 sc1 lds
buffer_load_dwordx4 v3, s[8:11], s21 offen offset:1024 sc1 lds
buffer_load_dwordx4 v4, s[8:11], s21 offen offset:2048 sc1 lds
buffer_load_dwordx4 v5, s[8:11], s21 offen offset:3072 sc1 lds
s_cmp_ge_u32 s19, 9
s_cselect_b32 s3, 9, 0
s_cselect_b32 s28, 580608, 0
s_sub_u32 s19, s19, s3
s_add_u32 s21, s21, s28
s_add_u32 s21, s21, 2048
s_sub_u32 s20, s20, 1
s_cmp_lg_u32 s20, 0
s_cbranch_scc1 Ll_31
Ll_31_e:
s_waitcnt vmcnt(8)
s_barrier
s_add_u32 m0, s18, 129024
s_add_u32 s19, s19, 2
buffer_load_dwordx4 v2, s[8:11], s21 offen offset:0 sc1 lds
buffer_load_dwordx4 v3, s[8:11], s21 offen offset:1024 sc1 lds
buffer_load_dwordx4 v4, s[8:11], s21 offen offset:2048 sc1 lds
buffer_load_dwordx4 v5, s[8:11], s21 offen offset:3072 sc1 lds
s_cmp_ge_u32 s19, 9
s_cselect_b32 s3, 9, 0
s_cselect_b32 s28, 580608, 0
s_sub_u32 s19, s19, s3
s_add_u32 s21, s21, s28
s_add_u32 s21, s21, 2048
s_waitcnt vmcnt(8)
s_barrier
s_add_u32 m0, s18, 18432
s_add_u32 s19, s19, 2
buffer_load_dwordx4 v2, s[8:11], s21 offen offset:0 sc1 lds
buffer_load_dwordx4 v3, s[8:11], s21 offen offset:1024 sc1 lds
buffer_load_dwordx4 v4, s[8:11], s21 offen offset:2048 sc1 lds
buffer_load_dwordx4 v5, s[8:11], s21 offen offset:3072 sc1 lds
s_cmp_ge_u32 s19, 9
s_cselect_b32 s3, 9, 0
s_cselect_b32 s28, 580608, 0
s_sub_u32 s19, s19, s3
s_add_u32 s21, s21, s28
s_add_u32 s21, s21, 2048
s_waitcnt vmcnt(8)
s_barrier
s_add_u32 m0, s18, 55296
s_add_u32 s19, s19, 2
buffer_load_dwordx4 v2, s[8:11], s21 offen offset:0 sc1 lds
buffer_load_dwordx4 v3, s[8:11], s21 offen offset:1024 sc1 lds
buffer_load_dwordx4 v4, s[8:11], s21 offen offset:2048 sc1 lds
buffer_load_dwordx4 v5, s[8:11], s21 offen offset:3072 sc1 lds
s_cmp_ge_u32 s19, 9
s_cselect_b32 s3, 9, 0
s_cselect_b32 s28, 580608, 0
s_sub_u32 s19, s19, s3
s_add_u32 s21, s21, s28
s_add_u32 s21, s21, 2048
s_waitcnt vmcnt(8)
s_barrier
s_waitcnt vmcnt(4)
s_barrier
s_waitcnt vmcnt(0)
s_barrier
K1_ldtail:
s_lshr_b32 s17, s2, 3
s_sub_u32 s17, s17, 18
s_lshl_b32 s17, s17, 2
s_add_u32 s17, s17, s16
s_sub_u32 s17, s17, 4
s_mov_b32 s49, 2147483648
s_cmp_ge_u32 s23, 4
s_cbranch_scc1 K1_ldq
s_add_u32 s32, s26, 0
s_addc_u32 s33, s27, 0
s_mov_b32 s34, 16384
s_mov_b32 s35, 0x20000
s_and_b32 s31, s16, 3
s_lshl_b32 s30, s22, 2
s_add_u32 s30, s30, s31
s_lshl_b32 s30, s30, 8
v_and_b32 v1, 63, v0
v_and_b32 v2, 15, v1
v_lshlrev_b32 v2, 2, v2
buffer_load_dword v240, v2, s[32:35], s30 offen offset:128 sc1
s_mov_b32 s52, s4
s_mov_b32 s53, s5
s_mov_b32 s54, 18874368
s_mov_b32 s55, 0x20000
s_and_b32 s46, s2, 7
s_mul_i32 s46, s46, 18
s_lshr_b32 s46, s46, 2
s_lshl_b32 s46, s46, 8
s_add_u32 s47, s17, 256
s_mul_i32 s57, s47, 64
v_add_u32 v30, s57, v1
v_mul_u32_u24 v31, 52429, v30
v_lshrrev_b32 v31, 19, v31
v_mul_u32_u24 v31, 7936, v31
v_lshl_add_u32 v30, v30, 7, v31
buffer_load_dword v255, v30, s[52:55], s46 offen
s_add_u32 s47, s47, 32
s_mul_i32 s57, s47, 64
v_add_u32 v30, s57, v1
v_mul_u32_u24 v31, 52429, v30
v_lshrrev_b32 v31, 19, v31
v_mul_u32_u24 v31, 7936, v31
v_lshl_add_u32 v30, v30, 7, v31
buffer_load_dword v255, v30, s[52:55], s46 offen
s_add_u32 s47, s47, 32
s_mov_b32 s52, s50
s_mov_b32 s53, s51
s_mov_b32 s54, 18874368
s_mov_b32 s55, 0x20000
s_bfe_u32 s57, s2, 0x20001
s_mul_i32 s57, s57, 4718592
s_and_b32 s58, s2, 1
s_lshl_b32 s58, s58, 11
s_add_u32 s57, s57, s58
s_sub_u32 s58, 287, s17
s_bitcmp1_b32 s2, 0
s_cselect_b32 s58, s58, s17
s_lshl_b32 s58, s58, 14
s_add_u32 s57, s57, s58
s_mov_b32 s58, 524288
s_bitcmp1_b32 s2, 0
s_cselect_b32 s58, -524288, s58
v_bfe_u32 v30, v0, 4, 2
v_lshlrev_b32 v30, 12, v30
v_and_b32 v31, 15, v0
v_lshl_add_u32 v30, v31, 7, v30
buffer_load_dword v255, v30, s[52:55], s57 offen
s_add_u32 s57, s57, s58
buffer_load_dword v255, v30, s[52:55], s57 offen
s_add_u32 s57, s57, s58
buffer_load_dword v255, v30, s[52:55], s57 offen
s_add_u32 s57, s57, s58
s_mul_i32 s3, s31, 9216
s_add_u32 s3, s3, 114688
v_lshl_add_u32 v2, v1, 4, s3
s_barrier
ds_read_b128 v[96:99], v2 offset:0
ds_read_b128 v[104:107], v2 offset:1024
ds_read_b128 v[112:115], v2 offset:2048
ds_read_b128 v[120:123], v2 offset:3072
ds_read_b128 v[128:131], v2 offset:4096
ds_read_b128 v[136:139], v2 offset:5120
ds_read_b128 v[144:147], v2 offset:6144
ds_read_b128 v[152:155], v2 offset:7168
ds_read_b128 v[160:163], v2 offset:8192
s_waitcnt vmcnt(5) lgkmcnt(0)
s_branch K1_kvsm
K1_ldq:
s_barrier
s_add_u32 s17, s17, 64
s_mov_b32 s52, s50
s_mov_b32 s53, s51
s_mov_b32 s54, 18874368
s_mov_b32 s55, 0x20000
s_bfe_u32 s57, s2, 0x20001
s_mul_i32 s57, s57, 4718592
s_and_b32 s58, s2, 1
s_lshl_b32 s58, s58, 11
s_add_u32 s57, s57, s58
s_sub_u32 s58, 287, s17
s_bitcmp1_b32 s2, 0
s_cselect_b32 s58, s58, s17
s_lshl_b32 s58, s58, 14
s_add_u32 s57, s57, s58
s_mov_b32 s58, 262144
s_bitcmp1_b32 s2, 0
s_cselect_b32 s58, -262144, s58
v_bfe_u32 v30, v0, 4, 2
v_lshlrev_b32 v30, 12, v30
v_and_b32 v31, 15, v0
v_lshl_add_u32 v30, v31, 7, v30
buffer_load_dword v255, v30, s[52:55], s57 offen
s_add_u32 s57, s57, s58
s_waitcnt vmcnt(0)
buffer_load_dword v255, v30, s[52:55], s57 offen
s_add_u32 s57, s57, s58
s_waitcnt vmcnt(0)
s_branch K2_ld
K1_spare:
s_load_dwordx2 s[50:51], s[0:1], 56
s_mov_b32 s8, s22
s_mov_b32 s9, s23
s_mov_b32 s10, 663552
s_mov_b32 s11, 0x20000
s_and_b32 s17, s2, 7
s_lshr_b32 s18, s2, 3
s_sub_u32 s41, s18, 30
s_lshl_b32 s41, s41, 3
s_add_u32 s41, s41, s16
s_add_u32 s43, s41, 128
s_sub_u32 s18, s18, 30
s_lshl_b32 s17, s17, 1
s_add_u32 s17, s17, s18
s_and_b32 s22, s17, 3
s_lshr_b32 s23, s17, 2
s_mul_i32 s28, s23, 165888
s_mul_i32 s29, s22, 288
s_add_u32 s28, s28, s29
s_lshl_b32 s29, s16, 10
v_add_u32 v4, 0, v0
v_mul_u32_u24 v5, 58255, v4
v_lshrrev_b32 v5, 20, v5
s_add_u32 m0, s29, 0
v_mul_u32_u24 v5, 864, v5
v_lshl_add_u32 v4, v4, 4, v5
buffer_load_dwordx4 v4, s[8:11], s28 offen lds
v_add_u32 v4, 512, v0
v_mul_u32_u24 v5, 58255, v4
v_lshrrev_b32 v5, 20, v5
s_add_u32 m0, s29, 8192
v_mul_u32_u24 v5, 864, v5
v_lshl_add_u32 v4, v4, 4, v5
buffer_load_dwordx4 v4, s[8:11], s28 offen lds
v_add_u32 v4, 1024, v0
v_mul_u32_u24 v5, 58255, v4
v_lshrrev_b32 v5, 20, v5
s_add_u32 m0, s29, 16384
v_mul_u32_u24 v5, 864, v5
v_lshl_add_u32 v4, v4, 4, v5
buffer_load_dwordx4 v4, s[8:11], s28 offen lds
v_add_u32 v4, 1536, v0
v_mul_u32_u24 v5, 58255, v4
v_lshrrev_b32 v5, 20, v5
s_add_u32 m0, s29, 24576
v_mul_u32_u24 v5, 864, v5
v_lshl_add_u32 v4, v4, 4, v5
buffer_load_dwordx4 v4, s[8:11], s28 offen lds
v_add_u32 v4, 2048, v0
v_mul_u32_u24 v5, 58255, v4
v_lshrrev_b32 v5, 20, v5
s_add_u32 m0, s29, 32768
v_mul_u32_u24 v5, 864, v5
v_lshl_add_u32 v4, v4, 4, v5
buffer_load_dwordx4 v4, s[8:11], s28 offen lds
s_cmp_lg_u32 s16, 0
s_cbranch_scc1 K1_w5
s_bfm_b64 exec, 32, 0
v_add_u32 v4, 2560, v0
v_mul_u32_u24 v5, 58255, v4
v_lshrrev_b32 v5, 20, v5
s_add_u32 m0, s29, 40960
v_mul_u32_u24 v5, 864, v5
v_lshl_add_u32 v4, v4, 4, v5
buffer_load_dwordx4 v4, s[8:11], s28 offen lds
s_mov_b64 exec, -1
K1_w5:
s_add_u32 s42, s41, 152
s_add_u32 s41, s41, 88
v_lshlrev_b32 v4, 2, v0
v_add_u32 v4, 41472, v4
v_mov_b32 v5, 0
ds_write_b32 v4, v5
s_add_u32 s12, s26, 19922944
s_addc_u32 s13, s27, 0
s_mov_b32 s14, 737280
s_mov_b32 s15, 0x20000
v_and_b32 v1, 63, v0
v_lshrrev_b32 v3, 4, v1
v_bfe_u32 v2, v1, 2, 2
s_lshl_b32 s3, s16, 3
v_and_b32 v10, 3, v1
v_lshlrev_b32 v10, 3, v10
v_add_u32 v11, 16, v3
v_cmp_gt_u32 s[30:31], 2, v3
v_mov_b32 v12, 144
v_add3_u32 v4, v2, s3, 0
v_mul_u32_u24 v5, 205, v4
v_lshrrev_b32 v5, 10, v5
v_mul_u32_u24 v6, 5, v5
v_sub_u32 v6, v4, v6
v_cmp_eq_u32 vcc, 4, v6
v_lshl_add_u32 v6, v3, 2, v6
v_mul_u32_u24 v5, 18, v5
v_cndmask_b32 v6, v6, v11, vcc
s_andn2_b64 vcc, vcc, s[30:31]
v_add_u32 v6, v6, v5
v_cndmask_b32 v6, v6, v12, vcc
v_min_u32 v6, 144, v6
v_mul_u32_u24 v6, 288, v6
v_add_u32 v8, v6, v10
v_add3_u32 v4, v2, s3, 4
v_mul_u32_u24 v5, 205, v4
v_lshrrev_b32 v5, 10, v5
v_mul_u32_u24 v6, 5, v5
v_sub_u32 v6, v4, v6
v_cmp_eq_u32 vcc, 4, v6
v_lshl_add_u32 v6, v3, 2, v6
v_mul_u32_u24 v5, 18, v5
v_cndmask_b32 v6, v6, v11, vcc
s_andn2_b64 vcc, vcc, s[30:31]
v_add_u32 v6, v6, v5
v_cndmask_b32 v6, v6, v12, vcc
v_min_u32 v6, 144, v6
v_mul_u32_u24 v6, 288, v6
v_add_u32 v9, v6, v10
s_lshl_b32 s28, s22, 2
s_add_u32 s28, s28, s23
s_mul_i32 s28, s28, 5
s_add_u32 s28, s28, s16
s_add_u32 s49, s28, 712
s_lshl_b32 s49, s49, 7
s_mul_i32 s28, s28, 9216
v_lshlrev_b32 v2, 4, v1
s_waitcnt vmcnt(0) lgkmcnt(0)
s_barrier
s_add_u32 s100, s100, 1
s_mul_i32 s101, s100, 0x9e3779b1
s_add_u32 s101, s101, 0x7f4a7c15
ds_read_b64_tr_b16 v[16:17], v8 offset:0
ds_read_b64_tr_b16 v[18:19], v9 offset:0
ds_read_b64_tr_b16 v[20:21], v8 offset:32
ds_read_b64_tr_b16 v[22:23], v9 offset:32
ds_read_b64_tr_b16 v[24:25], v8 offset:64
ds_read_b64_tr_b16 v[26:27], v9 offset:64
ds_read_b64_tr_b16 v[28:29], v8 offset:96
ds_read_b64_tr_b16 v[30:31], v9 offset:96
ds_read_b64_tr_b16 v[32:33], v8 offset:128
ds_read_b64_tr_b16 v[34:35], v9 offset:128
ds_read_b64_tr_b16 v[36:37], v8 offset:160
ds_read_b64_tr_b16 v[38:39], v9 offset:160
ds_read_b64_tr_b16 v[40:41], v8 offset:192
ds_read_b64_tr_b16 v[42:43], v9 offset:192
ds_read_b64_tr_b16 v[44:45], v8 offset:224
ds_read_b64_tr_b16 v[46:47], v9 offset:224
ds_read_b64_tr_b16 v[48:49], v8 offset:256
ds_read_b64_tr_b16 v[50:51], v9 offset:256
s_waitcnt lgkmcnt(0)
s_barrier
s_cmp_lt_u32 s16, 5
s_cbranch_scc1 K1_wot
s_lshl_b32 s49, s2, 7
s_cmp_eq_u32 s16, 5
s_cselect_b32 s49, s49, 2147483648
s_branch K1_wot1
K1_wot:
buffer_store_dwordx4 v[16:19], v2, s[12:15], s28 offen offset:0 sc1
buffer_store_dwordx4 v[20:23], v2, s[12:15], s28 offen offset:1024 sc1
buffer_store_dwordx4 v[24:27], v2, s[12:15], s28 offen offset:2048 sc1
buffer_store_dwordx4 v[28:31], v2, s[12:15], s28 offen offset:3072 sc1
s_add_u32 s28, s28, 4096
buffer_store_dwordx4 v[32:35], v2, s[12:15], s28 offen offset:0 sc1
buffer_store_dwordx4 v[36:39], v2, s[12:15], s28 offen offset:1024 sc1
buffer_store_dwordx4 v[40:43], v2, s[12:15], s28 offen offset:2048 sc1
buffer_store_dwordx4 v[44:47], v2, s[12:15], s28 offen offset:3072 sc1
s_add_u32 s28, s28, 4096
buffer_store_dwordx4 v[48:51], v2, s[12:15], s28 offen offset:0 sc1
K1_wot1:
s_waitcnt vmcnt(0)
s_barrier
v_mov_b32 v4, s100
v_mov_b32 v5, s101
v_mov_b32 v6, s49
s_mov_b64 exec, 1
buffer_store_dwordx2 v[4:5], v6, s[96:99], 0 offen sc1
s_mov_b64 exec, -1
s_sub_u32 s3, s2, 240
s_lshl_b32 s3, s3, 3
s_add_u32 s3, s3, s16
s_mul_i32 s3, s3, 15
s_add_u32 s3, s3, 792
v_add_lshl_u32 v8, v1, s3, 7
s_bfm_b64 exec, 15, 0
buffer_load_dword v255, v8, s[96:99], 0 offen sc1
s_mov_b64 exec, -1
K1_spf:
s_mul_i32 s57, s41, 64
v_add_u32 v57, s57, v1
v_mul_u32_u24 v58, 52429, v57
v_lshrrev_b32 v58, 19, v58
v_mul_u32_u24 v58, 7936, v58
v_lshl_add_u32 v57, v57, 7, v58
buffer_load_dword v255, v57, s[52:55], s46 offen
s_add_u32 s41, s41, 16
s_waitcnt vmcnt(1)
s_cmp_eq_u32 s41, s42
s_cselect_b32 s3, 56, 0
s_add_u32 s41, s41, s3
s_cmp_lt_u32 s41, 256
s_cbranch_scc1 K1_spf
s_mov_b32 s52, s50
s_mov_b32 s53, s51
s_mov_b32 s54, 18874368
s_mov_b32 s55, 0x20000
s_bfe_u32 s57, s2, 0x20001
s_mul_i32 s57, s57, 4718592
s_and_b32 s58, s2, 1
s_lshl_b32 s58, s58, 11
s_add_u32 s57, s57, s58
s_sub_u32 s58, 287, s43
s_bitcmp1_b32 s2, 0
s_cselect_b32 s58, s58, s43
s_lshl_b32 s58, s58, 14
s_add_u32 s57, s57, s58
s_mov_b32 s58, 262144
s_bitcmp1_b32 s2, 0
s_cselect_b32 s58, -262144, s58
v_bfe_u32 v30, v0, 4, 2
v_lshlrev_b32 v30, 12, v30
v_and_b32 v31, 15, v0
v_lshl_add_u32 v30, v31, 7, v30
buffer_load_dword v255, v30, s[52:55], s57 offen
s_add_u32 s57, s57, s58
s_waitcnt vmcnt(1)
buffer_load_dword v255, v30, s[52:55], s57 offen
s_add_u32 s57, s57, s58
s_waitcnt vmcnt(1)
s_mov_b32 s49, 2147483648
s_cmp_lt_u32 s16, 4
s_cbranch_scc1 K2_c
s_cmp_lg_u32 s16, 7
s_cbranch_scc1 K2_ld
s_cmp_lg_u32 s2, 255
s_cbranch_scc1 K2_ld
v_add_u32 v8, 0, v1
v_lshlrev_b32 v8, 7, v8
s_mov_b32 s63, 60000
Lp_37:
buffer_load_dwordx2 v[10:11], v8, s[96:99], 0 offen sc1
s_waitcnt vmcnt(0)
v_cmp_ne_u64 vcc, s[100:101], v[10:11]
s_sub_u32 s63, s63, 1
s_cbranch_scc1 Lx_38
s_nop 2
s_cbranch_vccz Lx_38
s_mov_b64 exec, vcc
s_sleep 8
s_branch Lp_37
Lx_38:
s_mov_b64 exec, -1
v_add_u32 v8, 64, v1
v_lshlrev_b32 v8, 7, v8
s_mov_b32 s63, 60000
Lp_39:
buffer_load_dwordx2 v[10:11], v8, s[96:99], 0 offen sc1
s_waitcnt vmcnt(0)
v_cmp_ne_u64 vcc, s[100:101], v[10:11]
s_sub_u32 s63, s63, 1
s_cbranch_scc1 Lx_40
s_nop 2
s_cbranch_vccz Lx_40
s_mov_b64 exec, vcc
s_sleep 8
s_branch Lp_39
Lx_40:
s_mov_b64 exec, -1
v_add_u32 v8, 128, v1
v_lshlrev_b32 v8, 7, v8
s_mov_b32 s63, 60000
Lp_41:
buffer_load_dwordx2 v[10:11], v8, s[96:99], 0 offen sc1
s_waitcnt vmcnt(0)
v_cmp_ne_u64 vcc, s[100:101], v[10:11]
s_sub_u32 s63, s63, 1
s_cbranch_scc1 Lx_42
s_nop 2
s_cbranch_vccz Lx_42
s_mov_b64 exec, vcc
s_sleep 8
s_branch Lp_41
Lx_42:
s_mov_b64 exec, -1
v_add_u32 v8, 192, v1
v_lshlrev_b32 v8, 7, v8
s_mov_b32 s63, 60000
Lp_43:
buffer_load_dwordx2 v[10:11], v8, s[96:99], 0 offen sc1
s_waitcnt vmcnt(0)
v_cmp_ne_u64 vcc, s[100:101], v[10:11]
s_sub_u32 s63, s63, 1
s_cbranch_scc1 Lx_44
s_nop 2
s_cbranch_vccz Lx_44
s_mov_b64 exec, vcc
s_sleep 8
s_branch Lp_43
Lx_44:
s_mov_b64 exec, -1
s_mov_b32 s49, 336896
s_branch K2_ld
K2_c:
s_load_dwordx4 s[4:7], s[0:1], 56
s_load_dwordx2 s[44:45], s[0:1], 0
s_load_dwordx2 s[46:47], s[0:1], 72
s_and_b32 s17, s2, 7
s_lshr_b32 s18, s2, 3
s_lshr_b32 s28, s17, 1
s_lshl_b32 s22, s17, 1
s_add_u32 s22, s22, s18
s_and_b32 s22, s22, 3
s_and_b32 s17, s17, 1
s_lshl_b32 s17, s17, 3
s_lshr_b32 s18, s18, 2
s_add_u32 s23, s17, s18
v_and_b32 v1, 63, v0
v_lshlrev_b32 v2, 4, v1
v_add_u32 v3, 73728, v2
v_lshrrev_b32 v8, 2, v1
v_and_b32 v9, 7, v8
s_lshl_b32 s3, s16, 1
v_xor_b32 v9, s3, v9
v_lshlrev_b32 v9, 5, v9
v_lshl_add_u32 v9, v8, 8, v9
v_and_b32 v8, 3, v1
v_lshl_add_u32 v9, v8, 3, v9
v_add_u32 v4, 18432, v9
v_xor_b32 v5, 32, v4
v_add_u32 v6, 73728, v4
v_add_u32 v7, 73728, v5
v_pk_mov_b32 v[96:97], 0, 0
v_pk_mov_b32 v[98:99], 0, 0
v_pk_mov_b32 v[100:101], 0, 0
v_pk_mov_b32 v[102:103], 0, 0
v_pk_mov_b32 v[104:105], 0, 0
v_pk_mov_b32 v[106:107], 0, 0
v_pk_mov_b32 v[108:109], 0, 0
v_pk_mov_b32 v[110:111], 0, 0
v_pk_mov_b32 v[112:113], 0, 0
v_pk_mov_b32 v[114:115], 0, 0
v_pk_mov_b32 v[116:117], 0, 0
v_pk_mov_b32 v[118:119], 0, 0
v_pk_mov_b32 v[120:121], 0, 0
v_pk_mov_b32 v[122:123], 0, 0
v_pk_mov_b32 v[124:125], 0, 0
v_pk_mov_b32 v[126:127], 0, 0
v_pk_mov_b32 v[128:129], 0, 0
v_pk_mov_b32 v[130:131], 0, 0
v_pk_mov_b32 v[132:133], 0, 0
v_pk_mov_b32 v[134:135], 0, 0
v_pk_mov_b32 v[136:137], 0, 0
v_pk_mov_b32 v[138:139], 0, 0
v_pk_mov_b32 v[140:141], 0, 0
v_pk_mov_b32 v[142:143], 0, 0
v_pk_mov_b32 v[144:145], 0, 0
v_pk_mov_b32 v[146:147], 0, 0
v_pk_mov_b32 v[148:149], 0, 0
v_pk_mov_b32 v[150:151], 0, 0
v_pk_mov_b32 v[152:153], 0, 0
v_pk_mov_b32 v[154:155], 0, 0
v_pk_mov_b32 v[156:157], 0, 0
v_pk_mov_b32 v[158:159], 0, 0
v_pk_mov_b32 v[160:161], 0, 0
v_pk_mov_b32 v[162:163], 0, 0
v_pk_mov_b32 v[164:165], 0, 0
v_pk_mov_b32 v[166:167], 0, 0
s_waitcnt vmcnt(0) lgkmcnt(0)
v_mov_b32 v8, s100
v_mov_b32 v9, s101
v_mov_b32 v10, s49
s_mov_b64 exec, 1
buffer_store_dwordx2 v[8:9], v10, s[96:99], 0 offen sc1
s_mov_b64 exec, -1
s_mov_b32 s49, 2147483648
s_barrier
s_add_u32 s36, s26, 20971520
s_addc_u32 s37, s27, 0
s_mov_b32 s38, 9437184
s_mov_b32 s39, 0x20000
s_lshl_b32 s17, s23, 2
s_add_u32 s17, s17, s22
s_lshl_b32 s18, s17, 4
s_lshl_b32 s30, s16, 2
s_add_u32 s30, s30, s28
s_add_u32 s30, s30, s18
s_mul_i32 s32, s30, 9216
s_add_u32 s30, s30, 1608
s_lshl_b32 s30, s30, 7
s_cmp_eq_u32 s16, s28
s_cselect_b32 s48, 2147483648, 0
s_cselect_b32 s30, 2147483648, s30
s_add_u32 s34, s32, 4096
s_add_u32 s35, s32, 8192
s_waitcnt lgkmcnt(0)
s_mov_b32 s8, s44
s_mov_b32 s9, s45
s_mov_b32 s10, 2359296
s_mov_b32 s11, 0x20000
s_mov_b32 s12, s6
s_mov_b32 s13, s7
s_mov_b32 s14, 4096
s_mov_b32 s15, 0x20000
s_mov_b32 s52, s46
s_mov_b32 s53, s47
s_mov_b32 s54, 2359296
s_mov_b32 s55, 0x20000
s_lshl_b32 s50, s23, 2
s_add_u32 s50, s50, s28
s_lshl_b32 s51, s50, 6
s_mul_i32 s50, s50, 36864
s_mul_i32 s17, s22, 288
s_add_u32 s50, s50, s17
v_mov_b32 v252, v0
v_mul_u32_u24 v253, 3641, v252
v_lshrrev_b32 v253, 16, v253
v_mul_u32_u24 v254, 18, v253
v_sub_u32 v254, v252, v254
v_mul_u32_u24 v252, 1152, v253
v_lshl_add_u32 v244, v254, 4, v252
v_mul_u32_u24 v252, 592, v253
v_lshl_add_u32 v245, v254, 5, v252
v_add_u32 v245, 110592, v245
v_lshrrev_b32 v252, 1, v254
v_mul_u32_u24 v252, 1056, v252
v_and_b32 v254, 1, v254
v_lshl_add_u32 v252, v254, 9, v252
v_xor_b32 v254, v254, v253
v_and_b32 v254, 15, v254
v_lshl_add_u32 v252, v254, 4, v252
v_lshrrev_b32 v254, 4, v253
v_lshl_add_u32 v252, v254, 3, v252
v_add_u32 v241, 36864, v252
v_add_u32 v246, 129536, v252
v_lshlrev_b32 v253, 1, v253
buffer_load_dwordx4 v[248:251], v244, s[8:11], s50 offen
buffer_load_ushort v247, v253, s[12:15], s51 offen
v_mov_b32 v252, v241
v_and_b32 v8, 15, v1
v_lshrrev_b32 v9, 4, v1
v_mul_u32_u24 v8, 592, v8
v_lshl_add_u32 v8, v9, 4, v8
v_add_u32 v254, 110592, v8
s_add_u32 s40, s26, 33554432
s_addc_u32 s41, s27, 0
s_mov_b32 s42, 2621440
s_mov_b32 s43, 0x20000
s_branch K2_c1
K2_cq:
v_and_b32 v1, 63, v0
v_lshlrev_b32 v2, 4, v1
v_add_u32 v3, 73728, v2
v_lshrrev_b32 v8, 2, v1
v_and_b32 v9, 7, v8
s_lshl_b32 s3, s16, 1
v_xor_b32 v9, s3, v9
v_lshlrev_b32 v9, 5, v9
v_lshl_add_u32 v9, v8, 8, v9
v_and_b32 v8, 3, v1
v_lshl_add_u32 v9, v8, 3, v9
v_add_u32 v4, 18432, v9
v_xor_b32 v5, 32, v4
v_add_u32 v6, 73728, v4
v_add_u32 v7, 73728, v5
v_pk_mov_b32 v[96:97], 0, 0
v_pk_mov_b32 v[98:99], 0, 0
v_pk_mov_b32 v[100:101], 0, 0
v_pk_mov_b32 v[102:103], 0, 0
v_pk_mov_b32 v[104:105], 0, 0
v_pk_mov_b32 v[106:107], 0, 0
v_pk_mov_b32 v[108:109], 0, 0
v_pk_mov_b32 v[110:111], 0, 0
v_pk_mov_b32 v[112:113], 0, 0
v_pk_mov_b32 v[114:115], 0, 0
v_pk_mov_b32 v[116:117], 0, 0
v_pk_mov_b32 v[118:119], 0, 0
v_pk_mov_b32 v[120:121], 0, 0
v_pk_mov_b32 v[122:123], 0, 0
v_pk_mov_b32 v[124:125], 0, 0
v_pk_mov_b32 v[126:127], 0, 0
v_pk_mov_b32 v[128:129], 0, 0
v_pk_mov_b32 v[130:131], 0, 0
v_pk_mov_b32 v[132:133], 0, 0
v_pk_mov_b32 v[134:135], 0, 0
v_pk_mov_b32 v[136:137], 0, 0
v_pk_mov_b32 v[138:139], 0, 0
v_pk_mov_b32 v[140:141], 0, 0
v_pk_mov_b32 v[142:143], 0, 0
v_pk_mov_b32 v[144:145], 0, 0
v_pk_mov_b32 v[146:147], 0, 0
v_pk_mov_b32 v[148:149], 0, 0
v_pk_mov_b32 v[150:151], 0, 0
v_pk_mov_b32 v[152:153], 0, 0
v_pk_mov_b32 v[154:155], 0, 0
v_pk_mov_b32 v[156:157], 0, 0
v_pk_mov_b32 v[158:159], 0, 0
v_pk_mov_b32 v[160:161], 0, 0
v_pk_mov_b32 v[162:163], 0, 0
v_pk_mov_b32 v[164:165], 0, 0
v_pk_mov_b32 v[166:167], 0, 0
K2_c1:
v_or_b32 v0, s48, v2
s_cmp_ge_u32 s2, 144
s_cbranch_scc1 K2_cn
ds_read_b64_tr_b16 v[80:81], v4 offset:0
ds_read_b64_tr_b16 v[82:83], v4 offset:4096
ds_read_b64_tr_b16 v[84:85], v5 offset:0
ds_read_b64_tr_b16 v[86:87], v5 offset:4096
ds_read_b128 v[8:11], v2 offset:0
ds_read_b128 v[12:15], v2 offset:1024
ds_read_b128 v[16:19], v2 offset:2048
ds_read_b128 v[20:23], v2 offset:3072
ds_read_b128 v[24:27], v2 offset:4096
ds_read_b128 v[28:31], v2 offset:5120
ds_read_b128 v[32:35], v2 offset:6144
ds_read_b128 v[36:39], v2 offset:7168
ds_read_b128 v[40:43], v2 offset:8192
s_waitcnt lgkmcnt(0)
v_mfma_f32_16x16x32_bf16 v[96:99], v[8:11], v[80:83], v[96:99]
ds_read_b64_tr_b16 v[88:89], v4 offset:8192
v_mfma_f32_16x16x32_bf16 v[100:103], v[8:11], v[84:87], v[100:103]
ds_read_b64_tr_b16 v[90:91], v4 offset:12288
v_mfma_f32_16x16x32_bf16 v[104:107], v[12:15], v[80:83], v[104:107]
ds_read_b64_tr_b16 v[92:93], v5 offset:8192
v_mfma_f32_16x16x32_bf16 v[108:111], v[12:15], v[84:87], v[108:111]
ds_read_b64_tr_b16 v[94:95], v5 offset:12288
v_mfma_f32_16x16x32_bf16 v[112:115], v[16:19], v[80:83], v[112:115]
ds_read_b128 v[44:47], v2 offset:9216
v_mfma_f32_16x16x32_bf16 v[116:119], v[16:19], v[84:87], v[116:119]
ds_read_b128 v[48:51], v2 offset:10240
v_mfma_f32_16x16x32_bf16 v[120:123], v[20:23], v[80:83], v[120:123]
ds_read_b128 v[52:55], v2 offset:11264
v_mfma_f32_16x16x32_bf16 v[124:127], v[20:23], v[84:87], v[124:127]
ds_read_b128 v[56:59], v2 offset:12288
v_mfma_f32_16x16x32_bf16 v[128:131], v[24:27], v[80:83], v[128:131]
ds_read_b128 v[60:63], v2 offset:13312
v_mfma_f32_16x16x32_bf16 v[132:135], v[24:27], v[84:87], v[132:135]
ds_read_b128 v[64:67], v2 offset:14336
v_mfma_f32_16x16x32_bf16 v[136:139], v[28:31], v[80:83], v[136:139]
ds_read_b128 v[68:71], v2 offset:15360
v_mfma_f32_16x16x32_bf16 v[140:143], v[28:31], v[84:87], v[140:143]
ds_read_b128 v[72:75], v2 offset:16384
v_mfma_f32_16x16x32_bf16 v[144:147], v[32:35], v[80:83], v[144:147]
ds_read_b128 v[76:79], v2 offset:17408
v_mfma_f32_16x16x32_bf16 v[148:151], v[32:35], v[84:87], v[148:151]
v_mfma_f32_16x16x32_bf16 v[152:155], v[36:39], v[80:83], v[152:155]
v_mfma_f32_16x16x32_bf16 v[156:159], v[36:39], v[84:87], v[156:159]
v_mfma_f32_16x16x32_bf16 v[160:163], v[40:43], v[80:83], v[160:163]
v_mfma_f32_16x16x32_bf16 v[164:167], v[40:43], v[84:87], v[164:167]
s_waitcnt lgkmcnt(0)
v_mfma_f32_16x16x32_bf16 v[96:99], v[44:47], v[88:91], v[96:99]
ds_read_b64_tr_b16 v[80:81], v4 offset:36864
v_mfma_f32_16x16x32_bf16 v[100:103], v[44:47], v[92:95], v[100:103]
ds_read_b64_tr_b16 v[82:83], v4 offset:40960
v_mfma_f32_16x16x32_bf16 v[104:107], v[48:51], v[88:91], v[104:107]
ds_read_b64_tr_b16 v[84:85], v5 offset:36864
v_mfma_f32_16x16x32_bf16 v[108:111], v[48:51], v[92:95], v[108:111]
ds_read_b64_tr_b16 v[86:87], v5 offset:40960
v_mfma_f32_16x16x32_bf16 v[112:115], v[52:55], v[88:91], v[112:115]
ds_read_b128 v[8:11], v2 offset:36864
v_mfma_f32_16x16x32_bf16 v[116:119], v[52:55], v[92:95], v[116:119]
ds_read_b128 v[12:15], v2 offset:37888
v_mfma_f32_16x16x32_bf16 v[120:123], v[56:59], v[88:91], v[120:123]
ds_read_b128 v[16:19], v2 offset:38912
v_mfma_f32_16x16x32_bf16 v[124:127], v[56:59], v[92:95], v[124:127]
ds_read_b128 v[20:23], v2 offset:39936
v_mfma_f32_16x16x32_bf16 v[128:131], v[60:63], v[88:91], v[128:131]
ds_read_b128 v[24:27], v2 offset:40960
v_mfma_f32_16x16x32_bf16 v[132:135], v[60:63], v[92:95], v[132:135]
ds_read_b128 v[28:31], v2 offset:41984
v_mfma_f32_16x16x32_bf16 v[136:139], v[64:67], v[88:91], v[136:139]
ds_read_b128 v[32:35], v2 offset:43008
v_mfma_f32_16x16x32_bf16 v[140:143], v[64:67], v[92:95], v[140:143]
ds_read_b128 v[36:39], v2 offset:44032
v_mfma_f32_16x16x32_bf16 v[144:147], v[68:71], v[88:91], v[144:147]
ds_read_b128 v[40:43], v2 offset:45056
v_mfma_f32_16x16x32_bf16 v[148:151], v[68:71], v[92:95], v[148:151]
v_mfma_f32_16x16x32_bf16 v[152:155], v[72:75], v[88:91], v[152:155]
v_mfma_f32_16x16x32_bf16 v[156:159], v[72:75], v[92:95], v[156:159]
v_mfma_f32_16x16x32_bf16 v[160:163], v[76:79], v[88:91], v[160:163]
v_mfma_f32_16x16x32_bf16 v[164:167], v[76:79], v[92:95], v[164:167]
s_waitcnt lgkmcnt(0)
v_mfma_f32_16x16x32_bf16 v[96:99], v[8:11], v[80:83], v[96:99]
ds_read_b64_tr_b16 v[88:89], v4 offset:45056
v_mfma_f32_16x16x32_bf16 v[100:103], v[8:11], v[84:87], v[100:103]
ds_read_b64_tr_b16 v[90:91], v4 offset:49152
v_mfma_f32_16x16x32_bf16 v[104:107], v[12:15], v[80:83], v[104:107]
ds_read_b64_tr_b16 v[92:93], v5 offset:45056
v_mfma_f32_16x16x32_bf16 v[108:111], v[12:15], v[84:87], v[108:111]
ds_read_b64_tr_b16 v[94:95], v5 offset:49152
v_mfma_f32_16x16x32_bf16 v[112:115], v[16:19], v[80:83], v[112:115]
ds_read_b128 v[44:47], v2 offset:46080
v_mfma_f32_16x16x32_bf16 v[116:119], v[16:19], v[84:87], v[116:119]
ds_read_b128 v[48:51], v2 offset:47104
v_mfma_f32_16x16x32_bf16 v[120:123], v[20:23], v[80:83], v[120:123]
ds_read_b128 v[52:55], v2 offset:48128
v_mfma_f32_16x16x32_bf16 v[124:127], v[20:23], v[84:87], v[124:127]
ds_read_b128 v[56:59], v2 offset:49152
v_mfma_f32_16x16x32_bf16 v[128:131], v[24:27], v[80:83], v[128:131]
ds_read_b128 v[60:63], v2 offset:50176
v_mfma_f32_16x16x32_bf16 v[132:135], v[24:27], v[84:87], v[132:135]
ds_read_b128 v[64:67], v2 offset:51200
v_mfma_f32_16x16x32_bf16 v[136:139], v[28:31], v[80:83], v[136:139]
ds_read_b128 v[68:71], v2 offset:52224
v_mfma_f32_16x16x32_bf16 v[140:143], v[28:31], v[84:87], v[140:143]
ds_read_b128 v[72:75], v2 offset:53248
v_mfma_f32_16x16x32_bf16 v[144:147], v[32:35], v[80:83], v[144:147]
ds_read_b128 v[76:79], v2 offset:54272
v_mfma_f32_16x16x32_bf16 v[148:151], v[32:35], v[84:87], v[148:151]
v_mfma_f32_16x16x32_bf16 v[152:155], v[36:39], v[80:83], v[152:155]
v_mfma_f32_16x16x32_bf16 v[156:159], v[36:39], v[84:87], v[156:159]
v_mfma_f32_16x16x32_bf16 v[160:163], v[40:43], v[80:83], v[160:163]
v_mfma_f32_16x16x32_bf16 v[164:167], v[40:43], v[84:87], v[164:167]
s_waitcnt lgkmcnt(0)
v_mfma_f32_16x16x32_bf16 v[96:99], v[44:47], v[88:91], v[96:99]
v_mfma_f32_16x16x32_bf16 v[100:103], v[44:47], v[92:95], v[100:103]
v_mfma_f32_16x16x32_bf16 v[104:107], v[48:51], v[88:91], v[104:107]
v_mfma_f32_16x16x32_bf16 v[108:111], v[48:51], v[92:95], v[108:111]
v_mfma_f32_16x16x32_bf16 v[112:115], v[52:55], v[88:91], v[112:115]
v_mfma_f32_16x16x32_bf16 v[116:119], v[52:55], v[92:95], v[116:119]
v_mfma_f32_16x16x32_bf16 v[120:123], v[56:59], v[88:91], v[120:123]
v_mfma_f32_16x16x32_bf16 v[124:127], v[56:59], v[92:95], v[124:127]
v_mfma_f32_16x16x32_bf16 v[128:131], v[60:63], v[88:91], v[128:131]
v_mfma_f32_16x16x32_bf16 v[132:135], v[60:63], v[92:95], v[132:135]
v_mfma_f32_16x16x32_bf16 v[136:139], v[64:67], v[88:91], v[136:139]
v_mfma_f32_16x16x32_bf16 v[140:143], v[64:67], v[92:95], v[140:143]
v_mfma_f32_16x16x32_bf16 v[144:147], v[68:71], v[88:91], v[144:147]
v_mfma_f32_16x16x32_bf16 v[148:151], v[68:71], v[92:95], v[148:151]
v_mfma_f32_16x16x32_bf16 v[152:155], v[72:75], v[88:91], v[152:155]
v_mfma_f32_16x16x32_bf16 v[156:159], v[72:75], v[92:95], v[156:159]
v_mfma_f32_16x16x32_bf16 v[160:163], v[76:79], v[88:91], v[160:163]
v_mfma_f32_16x16x32_bf16 v[164:167], v[76:79], v[92:95], v[164:167]
s_barrier
ds_read_b64_tr_b16 v[80:81], v6 offset:0
ds_read_b64_tr_b16 v[82:83], v6 offset:4096
ds_read_b64_tr_b16 v[84:85], v7 offset:0
ds_read_b64_tr_b16 v[86:87], v7 offset:4096
ds_read_b128 v[8:11], v3 offset:0
ds_read_b128 v[12:15], v3 offset:1024
ds_read_b128 v[16:19], v3 offset:2048
ds_read_b128 v[20:23], v3 offset:3072
ds_read_b128 v[24:27], v3 offset:4096
ds_read_b128 v[28:31], v3 offset:5120
ds_read_b128 v[32:35], v3 offset:6144
ds_read_b128 v[36:39], v3 offset:7168
ds_read_b128 v[40:43], v3 offset:8192
s_mov_b32 s20, 4
s_branch K2_c2
K2_cn:
s_barrier
ds_read_b64_tr_b16 v[80:81], v4 offset:0
ds_read_b64_tr_b16 v[82:83], v4 offset:4096
ds_read_b64_tr_b16 v[84:85], v5 offset:0
ds_read_b64_tr_b16 v[86:87], v5 offset:4096
ds_read_b128 v[8:11], v2 offset:0
ds_read_b128 v[12:15], v2 offset:1024
ds_read_b128 v[16:19], v2 offset:2048
ds_read_b128 v[20:23], v2 offset:3072
ds_read_b128 v[24:27], v2 offset:4096
ds_read_b128 v[28:31], v2 offset:5120
ds_read_b128 v[32:35], v2 offset:6144
ds_read_b128 v[36:39], v2 offset:7168
ds_read_b128 v[40:43], v2 offset:8192
s_mov_b32 s20, 4
Lc_45:
s_waitcnt lgkmcnt(0)
v_mfma_f32_16x16x32_bf16 v[96:99], v[8:11], v[80:83], v[96:99]
ds_read_b64_tr_b16 v[88:89], v4 offset:8192
v_mfma_f32_16x16x32_bf16 v[100:103], v[8:11], v[84:87], v[100:103]
ds_read_b64_tr_b16 v[90:91], v4 offset:12288
v_mfma_f32_16x16x32_bf16 v[104:107], v[12:15], v[80:83], v[104:107]
ds_read_b64_tr_b16 v[92:93], v5 offset:8192
v_mfma_f32_16x16x32_bf16 v[108:111], v[12:15], v[84:87], v[108:111]
ds_read_b64_tr_b16 v[94:95], v5 offset:12288
v_mfma_f32_16x16x32_bf16 v[112:115], v[16:19], v[80:83], v[112:115]
ds_read_b128 v[44:47], v2 offset:9216
v_mfma_f32_16x16x32_bf16 v[116:119], v[16:19], v[84:87], v[116:119]
ds_read_b128 v[48:51], v2 offset:10240
v_mfma_f32_16x16x32_bf16 v[120:123], v[20:23], v[80:83], v[120:123]
ds_read_b128 v[52:55], v2 offset:11264
v_mfma_f32_16x16x32_bf16 v[124:127], v[20:23], v[84:87], v[124:127]
ds_read_b128 v[56:59], v2 offset:12288
v_mfma_f32_16x16x32_bf16 v[128:131], v[24:27], v[80:83], v[128:131]
ds_read_b128 v[60:63], v2 offset:13312
v_mfma_f32_16x16x32_bf16 v[132:135], v[24:27], v[84:87], v[132:135]
ds_read_b128 v[64:67], v2 offset:14336
v_mfma_f32_16x16x32_bf16 v[136:139], v[28:31], v[80:83], v[136:139]
ds_read_b128 v[68:71], v2 offset:15360
v_mfma_f32_16x16x32_bf16 v[140:143], v[28:31], v[84:87], v[140:143]
ds_read_b128 v[72:75], v2 offset:16384
v_mfma_f32_16x16x32_bf16 v[144:147], v[32:35], v[80:83], v[144:147]
ds_read_b128 v[76:79], v2 offset:17408
v_mfma_f32_16x16x32_bf16 v[148:151], v[32:35], v[84:87], v[148:151]
v_mfma_f32_16x16x32_bf16 v[152:155], v[36:39], v[80:83], v[152:155]
v_mfma_f32_16x16x32_bf16 v[156:159], v[36:39], v[84:87], v[156:159]
v_mfma_f32_16x16x32_bf16 v[160:163], v[40:43], v[80:83], v[160:163]
v_mfma_f32_16x16x32_bf16 v[164:167], v[40:43], v[84:87], v[164:167]
s_waitcnt lgkmcnt(0)
s_barrier
v_mfma_f32_16x16x32_bf16 v[96:99], v[44:47], v[88:91], v[96:99]
ds_read_b64_tr_b16 v[80:81], v4 offset:36864
v_mfma_f32_16x16x32_bf16 v[100:103], v[44:47], v[92:95], v[100:103]
ds_read_b64_tr_b16 v[82:83], v4 offset:40960
v_mfma_f32_16x16x32_bf16 v[104:107], v[48:51], v[88:91], v[104:107]
ds_read_b64_tr_b16 v[84:85], v5 offset:36864
v_mfma_f32_16x16x32_bf16 v[108:111], v[48:51], v[92:95], v[108:111]
ds_read_b64_tr_b16 v[86:87], v5 offset:40960
v_mfma_f32_16x16x32_bf16 v[112:115], v[52:55], v[88:91], v[112:115]
ds_read_b128 v[8:11], v2 offset:36864
v_mfma_f32_16x16x32_bf16 v[116:119], v[52:55], v[92:95], v[116:119]
ds_read_b128 v[12:15], v2 offset:37888
v_mfma_f32_16x16x32_bf16 v[120:123], v[56:59], v[88:91], v[120:123]
ds_read_b128 v[16:19], v2 offset:38912
v_mfma_f32_16x16x32_bf16 v[124:127], v[56:59], v[92:95], v[124:127]
ds_read_b128 v[20:23], v2 offset:39936
v_mfma_f32_16x16x32_bf16 v[128:131], v[60:63], v[88:91], v[128:131]
ds_read_b128 v[24:27], v2 offset:40960
v_mfma_f32_16x16x32_bf16 v[132:135], v[60:63], v[92:95], v[132:135]
ds_read_b128 v[28:31], v2 offset:41984
v_mfma_f32_16x16x32_bf16 v[136:139], v[64:67], v[88:91], v[136:139]
ds_read_b128 v[32:35], v2 offset:43008
v_mfma_f32_16x16x32_bf16 v[140:143], v[64:67], v[92:95], v[140:143]
ds_read_b128 v[36:39], v2 offset:44032
v_mfma_f32_16x16x32_bf16 v[144:147], v[68:71], v[88:91], v[144:147]
ds_read_b128 v[40:43], v2 offset:45056
v_mfma_f32_16x16x32_bf16 v[148:151], v[68:71], v[92:95], v[148:151]
v_mfma_f32_16x16x32_bf16 v[152:155], v[72:75], v[88:91], v[152:155]
v_mfma_f32_16x16x32_bf16 v[156:159], v[72:75], v[92:95], v[156:159]
v_mfma_f32_16x16x32_bf16 v[160:163], v[76:79], v[88:91], v[160:163]
v_mfma_f32_16x16x32_bf16 v[164:167], v[76:79], v[92:95], v[164:167]
s_waitcnt lgkmcnt(0)
v_mfma_f32_16x16x32_bf16 v[96:99], v[8:11], v[80:83], v[96:99]
ds_read_b64_tr_b16 v[88:89], v4 offset:45056
v_mfma_f32_16x16x32_bf16 v[100:103], v[8:11], v[84:87], v[100:103]
ds_read_b64_tr_b16 v[90:91], v4 offset:49152
v_mfma_f32_16x16x32_bf16 v[104:107], v[12:15], v[80:83], v[104:107]
ds_read_b64_tr_b16 v[92:93], v5 offset:45056
v_mfma_f32_16x16x32_bf16 v[108:111], v[12:15], v[84:87], v[108:111]
ds_read_b64_tr_b16 v[94:95], v5 offset:49152
v_mfma_f32_16x16x32_bf16 v[112:115], v[16:19], v[80:83], v[112:115]
ds_read_b128 v[44:47], v2 offset:46080
v_mfma_f32_16x16x32_bf16 v[116:119], v[16:19], v[84:87], v[116:119]
ds_read_b128 v[48:51], v2 offset:47104
v_mfma_f32_16x16x32_bf16 v[120:123], v[20:23], v[80:83], v[120:123]
ds_read_b128 v[52:55], v2 offset:48128
v_mfma_f32_16x16x32_bf16 v[124:127], v[20:23], v[84:87], v[124:127]
ds_read_b128 v[56:59], v2 offset:49152
v_mfma_f32_16x16x32_bf16 v[128:131], v[24:27], v[80:83], v[128:131]
ds_read_b128 v[60:63], v2 offset:50176
v_mfma_f32_16x16x32_bf16 v[132:135], v[24:27], v[84:87], v[132:135]
ds_read_b128 v[64:67], v2 offset:51200
v_mfma_f32_16x16x32_bf16 v[136:139], v[28:31], v[80:83], v[136:139]
ds_read_b128 v[68:71], v2 offset:52224
v_mfma_f32_16x16x32_bf16 v[140:143], v[28:31], v[84:87], v[140:143]
ds_read_b128 v[72:75], v2 offset:53248
v_mfma_f32_16x16x32_bf16 v[144:147], v[32:35], v[80:83], v[144:147]
ds_read_b128 v[76:79], v2 offset:54272
v_mfma_f32_16x16x32_bf16 v[148:151], v[32:35], v[84:87], v[148:151]
v_mfma_f32_16x16x32_bf16 v[152:155], v[36:39], v[80:83], v[152:155]
v_mfma_f32_16x16x32_bf16 v[156:159], v[36:39], v[84:87], v[156:159]
v_mfma_f32_16x16x32_bf16 v[160:163], v[40:43], v[80:83], v[160:163]
v_mfma_f32_16x16x32_bf16 v[164:167], v[40:43], v[84:87], v[164:167]
s_waitcnt lgkmcnt(0)
s_barrier
v_mfma_f32_16x16x32_bf16 v[96:99], v[44:47], v[88:91], v[96:99]
ds_read_b64_tr_b16 v[80:81], v6 offset:0
v_mfma_f32_16x16x32_bf16 v[100:103], v[44:47], v[92:95], v[100:103]
ds_read_b64_tr_b16 v[82:83], v6 offset:4096
v_mfma_f32_16x16x32_bf16 v[104:107], v[48:51], v[88:91], v[104:107]
ds_read_b64_tr_b16 v[84:85], v7 offset:0
v_mfma_f32_16x16x32_bf16 v[108:111], v[48:51], v[92:95], v[108:111]
ds_read_b64_tr_b16 v[86:87], v7 offset:4096
v_mfma_f32_16x16x32_bf16 v[112:115], v[52:55], v[88:91], v[112:115]
ds_read_b128 v[8:11], v3 offset:0
v_mfma_f32_16x16x32_bf16 v[116:119], v[52:55], v[92:95], v[116:119]
ds_read_b128 v[12:15], v3 offset:1024
v_mfma_f32_16x16x32_bf16 v[120:123], v[56:59], v[88:91], v[120:123]
ds_read_b128 v[16:19], v3 offset:2048
v_mfma_f32_16x16x32_bf16 v[124:127], v[56:59], v[92:95], v[124:127]
ds_read_b128 v[20:23], v3 offset:3072
v_mfma_f32_16x16x32_bf16 v[128:131], v[60:63], v[88:91], v[128:131]
ds_read_b128 v[24:27], v3 offset:4096
v_mfma_f32_16x16x32_bf16 v[132:135], v[60:63], v[92:95], v[132:135]
ds_read_b128 v[28:31], v3 offset:5120
v_mfma_f32_16x16x32_bf16 v[136:139], v[64:67], v[88:91], v[136:139]
ds_read_b128 v[32:35], v3 offset:6144
v_mfma_f32_16x16x32_bf16 v[140:143], v[64:67], v[92:95], v[140:143]
ds_read_b128 v[36:39], v3 offset:7168
v_mfma_f32_16x16x32_bf16 v[144:147], v[68:71], v[88:91], v[144:147]
ds_read_b128 v[40:43], v3 offset:8192
v_mfma_f32_16x16x32_bf16 v[148:151], v[68:71], v[92:95], v[148:151]
v_mfma_f32_16x16x32_bf16 v[152:155], v[72:75], v[88:91], v[152:155]
v_mfma_f32_16x16x32_bf16 v[156:159], v[72:75], v[92:95], v[156:159]
v_mfma_f32_16x16x32_bf16 v[160:163], v[76:79], v[88:91], v[160:163]
v_mfma_f32_16x16x32_bf16 v[164:167], v[76:79], v[92:95], v[164:167]
K2_c2:
s_waitcnt lgkmcnt(0)
v_mfma_f32_16x16x32_bf16 v[96:99], v[8:11], v[80:83], v[96:99]
ds_read_b64_tr_b16 v[88:89], v6 offset:8192
v_mfma_f32_16x16x32_bf16 v[100:103], v[8:11], v[84:87], v[100:103]
ds_read_b64_tr_b16 v[90:91], v6 offset:12288
v_mfma_f32_16x16x32_bf16 v[104:107], v[12:15], v[80:83], v[104:107]
ds_read_b64_tr_b16 v[92:93], v7 offset:8192
v_mfma_f32_16x16x32_bf16 v[108:111], v[12:15], v[84:87], v[108:111]
ds_read_b64_tr_b16 v[94:95], v7 offset:12288
v_mfma_f32_16x16x32_bf16 v[112:115], v[16:19], v[80:83], v[112:115]
ds_read_b128 v[44:47], v3 offset:9216
v_mfma_f32_16x16x32_bf16 v[116:119], v[16:19], v[84:87], v[116:119]
ds_read_b128 v[48:51], v3 offset:10240
v_mfma_f32_16x16x32_bf16 v[120:123], v[20:23], v[80:83], v[120:123]
ds_read_b128 v[52:55], v3 offset:11264
v_mfma_f32_16x16x32_bf16 v[124:127], v[20:23], v[84:87], v[124:127]
ds_read_b128 v[56:59], v3 offset:12288
v_mfma_f32_16x16x32_bf16 v[128:131], v[24:27], v[80:83], v[128:131]
ds_read_b128 v[60:63], v3 offset:13312
v_mfma_f32_16x16x32_bf16 v[132:135], v[24:27], v[84:87], v[132:135]
ds_read_b128 v[64:67], v3 offset:14336
v_mfma_f32_16x16x32_bf16 v[136:139], v[28:31], v[80:83], v[136:139]
ds_read_b128 v[68:71], v3 offset:15360
v_mfma_f32_16x16x32_bf16 v[140:143], v[28:31], v[84:87], v[140:143]
ds_read_b128 v[72:75], v3 offset:16384
v_mfma_f32_16x16x32_bf16 v[144:147], v[32:35], v[80:83], v[144:147]
ds_read_b128 v[76:79], v3 offset:17408
v_mfma_f32_16x16x32_bf16 v[148:151], v[32:35], v[84:87], v[148:151]
v_mfma_f32_16x16x32_bf16 v[152:155], v[36:39], v[80:83], v[152:155]
v_mfma_f32_16x16x32_bf16 v[156:159], v[36:39], v[84:87], v[156:159]
v_mfma_f32_16x16x32_bf16 v[160:163], v[40:43], v[80:83], v[160:163]
v_mfma_f32_16x16x32_bf16 v[164:167], v[40:43], v[84:87], v[164:167]
s_waitcnt lgkmcnt(0)
s_barrier
v_mfma_f32_16x16x32_bf16 v[96:99], v[44:47], v[88:91], v[96:99]
ds_read_b64_tr_b16 v[80:81], v6 offset:36864
v_mfma_f32_16x16x32_bf16 v[100:103], v[44:47], v[92:95], v[100:103]
ds_read_b64_tr_b16 v[82:83], v6 offset:40960
v_mfma_f32_16x16x32_bf16 v[104:107], v[48:51], v[88:91], v[104:107]
ds_read_b64_tr_b16 v[84:85], v7 offset:36864
v_mfma_f32_16x16x32_bf16 v[108:111], v[48:51], v[92:95], v[108:111]
ds_read_b64_tr_b16 v[86:87], v7 offset:40960
v_mfma_f32_16x16x32_bf16 v[112:115], v[52:55], v[88:91], v[112:115]
ds_read_b128 v[8:11], v3 offset:36864
v_mfma_f32_16x16x32_bf16 v[116:119], v[52:55], v[92:95], v[116:119]
ds_read_b128 v[12:15], v3 offset:37888
v_mfma_f32_16x16x32_bf16 v[120:123], v[56:59], v[88:91], v[120:123]
ds_read_b128 v[16:19], v3 offset:38912
v_mfma_f32_16x16x32_bf16 v[124:127], v[56:59], v[92:95], v[124:127]
ds_read_b128 v[20:23], v3 offset:39936
v_mfma_f32_16x16x32_bf16 v[128:131], v[60:63], v[88:91], v[128:131]
ds_read_b128 v[24:27], v3 offset:40960
v_mfma_f32_16x16x32_bf16 v[132:135], v[60:63], v[92:95], v[132:135]
ds_read_b128 v[28:31], v3 offset:41984
v_mfma_f32_16x16x32_bf16 v[136:139], v[64:67], v[88:91], v[136:139]
ds_read_b128 v[32:35], v3 offset:43008
v_mfma_f32_16x16x32_bf16 v[140:143], v[64:67], v[92:95], v[140:143]
ds_read_b128 v[36:39], v3 offset:44032
v_mfma_f32_16x16x32_bf16 v[144:147], v[68:71], v[88:91], v[144:147]
ds_read_b128 v[40:43], v3 offset:45056
v_mfma_f32_16x16x32_bf16 v[148:151], v[68:71], v[92:95], v[148:151]
v_mfma_f32_16x16x32_bf16 v[152:155], v[72:75], v[88:91], v[152:155]
v_mfma_f32_16x16x32_bf16 v[156:159], v[72:75], v[92:95], v[156:159]
v_mfma_f32_16x16x32_bf16 v[160:163], v[76:79], v[88:91], v[160:163]
v_mfma_f32_16x16x32_bf16 v[164:167], v[76:79], v[92:95], v[164:167]
s_waitcnt lgkmcnt(0)
v_mfma_f32_16x16x32_bf16 v[96:99], v[8:11], v[80:83], v[96:99]
ds_read_b64_tr_b16 v[88:89], v6 offset:45056
v_mfma_f32_16x16x32_bf16 v[100:103], v[8:11], v[84:87], v[100:103]
ds_read_b64_tr_b16 v[90:91], v6 offset:49152
v_mfma_f32_16x16x32_bf16 v[104:107], v[12:15], v[80:83], v[104:107]
ds_read_b64_tr_b16 v[92:93], v7 offset:45056
v_mfma_f32_16x16x32_bf16 v[108:111], v[12:15], v[84:87], v[108:111]
ds_read_b64_tr_b16 v[94:95], v7 offset:49152
v_mfma_f32_16x16x32_bf16 v[112:115], v[16:19], v[80:83], v[112:115]
ds_read_b128 v[44:47], v3 offset:46080
v_mfma_f32_16x16x32_bf16 v[116:119], v[16:19], v[84:87], v[116:119]
ds_read_b128 v[48:51], v3 offset:47104
v_mfma_f32_16x16x32_bf16 v[120:123], v[20:23], v[80:83], v[120:123]
ds_read_b128 v[52:55], v3 offset:48128
v_mfma_f32_16x16x32_bf16 v[124:127], v[20:23], v[84:87], v[124:127]
ds_read_b128 v[56:59], v3 offset:49152
v_mfma_f32_16x16x32_bf16 v[128:131], v[24:27], v[80:83], v[128:131]
ds_read_b128 v[60:63], v3 offset:50176
v_mfma_f32_16x16x32_bf16 v[132:135], v[24:27], v[84:87], v[132:135]
ds_read_b128 v[64:67], v3 offset:51200
v_mfma_f32_16x16x32_bf16 v[136:139], v[28:31], v[80:83], v[136:139]
ds_read_b128 v[68:71], v3 offset:52224
v_mfma_f32_16x16x32_bf16 v[140:143], v[28:31], v[84:87], v[140:143]
ds_read_b128 v[72:75], v3 offset:53248
v_mfma_f32_16x16x32_bf16 v[144:147], v[32:35], v[80:83], v[144:147]
ds_read_b128 v[76:79], v3 offset:54272
v_mfma_f32_16x16x32_bf16 v[148:151], v[32:35], v[84:87], v[148:151]
v_mfma_f32_16x16x32_bf16 v[152:155], v[36:39], v[80:83], v[152:155]
v_mfma_f32_16x16x32_bf16 v[156:159], v[36:39], v[84:87], v[156:159]
v_mfma_f32_16x16x32_bf16 v[160:163], v[40:43], v[80:83], v[160:163]
v_mfma_f32_16x16x32_bf16 v[164:167], v[40:43], v[84:87], v[164:167]
s_waitcnt lgkmcnt(0)
s_barrier
v_mfma_f32_16x16x32_bf16 v[96:99], v[44:47], v[88:91], v[96:99]
ds_read_b64_tr_b16 v[80:81], v4 offset:0
v_mfma_f32_16x16x32_bf16 v[100:103], v[44:47], v[92:95], v[100:103]
ds_read_b64_tr_b16 v[82:83], v4 offset:4096
v_mfma_f32_16x16x32_bf16 v[104:107], v[48:51], v[88:91], v[104:107]
ds_read_b64_tr_b16 v[84:85], v5 offset:0
v_mfma_f32_16x16x32_bf16 v[108:111], v[48:51], v[92:95], v[108:111]
ds_read_b64_tr_b16 v[86:87], v5 offset:4096
v_mfma_f32_16x16x32_bf16 v[112:115], v[52:55], v[88:91], v[112:115]
ds_read_b128 v[8:11], v2 offset:0
v_mfma_f32_16x16x32_bf16 v[116:119], v[52:55], v[92:95], v[116:119]
ds_read_b128 v[12:15], v2 offset:1024
v_mfma_f32_16x16x32_bf16 v[120:123], v[56:59], v[88:91], v[120:123]
ds_read_b128 v[16:19], v2 offset:2048
v_mfma_f32_16x16x32_bf16 v[124:127], v[56:59], v[92:95], v[124:127]
ds_read_b128 v[20:23], v2 offset:3072
v_mfma_f32_16x16x32_bf16 v[128:131], v[60:63], v[88:91], v[128:131]
ds_read_b128 v[24:27], v2 offset:4096
v_mfma_f32_16x16x32_bf16 v[132:135], v[60:63], v[92:95], v[132:135]
ds_read_b128 v[28:31], v2 offset:5120
v_mfma_f32_16x16x32_bf16 v[136:139], v[64:67], v[88:91], v[136:139]
ds_read_b128 v[32:35], v2 offset:6144
v_mfma_f32_16x16x32_bf16 v[140:143], v[64:67], v[92:95], v[140:143]
ds_read_b128 v[36:39], v2 offset:7168
v_mfma_f32_16x16x32_bf16 v[144:147], v[68:71], v[88:91], v[144:147]
ds_read_b128 v[40:43], v2 offset:8192
v_mfma_f32_16x16x32_bf16 v[148:151], v[68:71], v[92:95], v[148:151]
v_mfma_f32_16x16x32_bf16 v[152:155], v[72:75], v[88:91], v[152:155]
v_mfma_f32_16x16x32_bf16 v[156:159], v[72:75], v[92:95], v[156:159]
v_mfma_f32_16x16x32_bf16 v[160:163], v[76:79], v[88:91], v[160:163]
v_mfma_f32_16x16x32_bf16 v[164:167], v[76:79], v[92:95], v[164:167]
s_cmp_eq_u32 s49, 2147483648
s_cbranch_scc1 K2_nolate
s_waitcnt vmcnt(0)
v_mov_b32 v172, s100
v_mov_b32 v173, s101
v_mov_b32 v174, s49
s_mov_b64 exec, 1
buffer_store_dwordx2 v[172:173], v174, s[96:99], 0 offen sc1
s_mov_b64 exec, -1
s_mov_b32 s49, 2147483648
K2_nolate:
s_sub_u32 s20, s20, 1
s_cmp_lg_u32 s20, 0
s_cbranch_scc1 Lc_45
s_waitcnt lgkmcnt(0)
v_mfma_f32_16x16x32_bf16 v[96:99], v[8:11], v[80:83], v[96:99]
ds_read_b64_tr_b16 v[88:89], v4 offset:8192
v_mfma_f32_16x16x32_bf16 v[100:103], v[8:11], v[84:87], v[100:103]
ds_read_b64_tr_b16 v[90:91], v4 offset:12288
v_mfma_f32_16x16x32_bf16 v[104:107], v[12:15], v[80:83], v[104:107]
ds_read_b64_tr_b16 v[92:93], v5 offset:8192
v_mfma_f32_16x16x32_bf16 v[108:111], v[12:15], v[84:87], v[108:111]
ds_read_b64_tr_b16 v[94:95], v5 offset:12288
v_mfma_f32_16x16x32_bf16 v[112:115], v[16:19], v[80:83], v[112:115]
ds_read_b128 v[44:47], v2 offset:9216
v_mfma_f32_16x16x32_bf16 v[116:119], v[16:19], v[84:87], v[116:119]
ds_read_b128 v[48:51], v2 offset:10240
v_mfma_f32_16x16x32_bf16 v[120:123], v[20:23], v[80:83], v[120:123]
ds_read_b128 v[52:55], v2 offset:11264
v_mfma_f32_16x16x32_bf16 v[124:127], v[20:23], v[84:87], v[124:127]
ds_read_b128 v[56:59], v2 offset:12288
v_mfma_f32_16x16x32_bf16 v[128:131], v[24:27], v[80:83], v[128:131]
ds_read_b128 v[60:63], v2 offset:13312
v_mfma_f32_16x16x32_bf16 v[132:135], v[24:27], v[84:87], v[132:135]
ds_read_b128 v[64:67], v2 offset:14336
v_mfma_f32_16x16x32_bf16 v[136:139], v[28:31], v[80:83], v[136:139]
ds_read_b128 v[68:71], v2 offset:15360
v_mfma_f32_16x16x32_bf16 v[140:143], v[28:31], v[84:87], v[140:143]
ds_read_b128 v[72:75], v2 offset:16384
v_mfma_f32_16x16x32_bf16 v[144:147], v[32:35], v[80:83], v[144:147]
ds_read_b128 v[76:79], v2 offset:17408
v_mfma_f32_16x16x32_bf16 v[148:151], v[32:35], v[84:87], v[148:151]
v_mfma_f32_16x16x32_bf16 v[152:155], v[36:39], v[80:83], v[152:155]
v_mfma_f32_16x16x32_bf16 v[156:159], v[36:39], v[84:87], v[156:159]
v_mfma_f32_16x16x32_bf16 v[160:163], v[40:43], v[80:83], v[160:163]
v_mfma_f32_16x16x32_bf16 v[164:167], v[40:43], v[84:87], v[164:167]
s_waitcnt lgkmcnt(0)
s_barrier
v_mfma_f32_16x16x32_bf16 v[96:99], v[44:47], v[88:91], v[96:99]
ds_read_b64_tr_b16 v[80:81], v4 offset:36864
v_mfma_f32_16x16x32_bf16 v[100:103], v[44:47], v[92:95], v[100:103]
ds_read_b64_tr_b16 v[82:83], v4 offset:40960
v_mfma_f32_16x16x32_bf16 v[104:107], v[48:51], v[88:91], v[104:107]
ds_read_b64_tr_b16 v[84:85], v5 offset:36864
v_mfma_f32_16x16x32_bf16 v[108:111], v[48:51], v[92:95], v[108:111]
ds_read_b64_tr_b16 v[86:87], v5 offset:40960
v_mfma_f32_16x16x32_bf16 v[112:115], v[52:55], v[88:91], v[112:115]
ds_read_b128 v[8:11], v2 offset:36864
v_mfma_f32_16x16x32_bf16 v[116:119], v[52:55], v[92:95], v[116:119]
ds_read_b128 v[12:15], v2 offset:37888
v_mfma_f32_16x16x32_bf16 v[120:123], v[56:59], v[88:91], v[120:123]
ds_read_b128 v[16:19], v2 offset:38912
v_mfma_f32_16x16x32_bf16 v[124:127], v[56:59], v[92:95], v[124:127]
ds_read_b128 v[20:23], v2 offset:39936
v_mfma_f32_16x16x32_bf16 v[128:131], v[60:63], v[88:91], v[128:131]
ds_read_b128 v[24:27], v2 offset:40960
v_mfma_f32_16x16x32_bf16 v[132:135], v[60:63], v[92:95], v[132:135]
ds_read_b128 v[28:31], v2 offset:41984
v_mfma_f32_16x16x32_bf16 v[136:139], v[64:67], v[88:91], v[136:139]
ds_read_b128 v[32:35], v2 offset:43008
v_mfma_f32_16x16x32_bf16 v[140:143], v[64:67], v[92:95], v[140:143]
ds_read_b128 v[36:39], v2 offset:44032
v_mfma_f32_16x16x32_bf16 v[144:147], v[68:71], v[88:91], v[144:147]
ds_read_b128 v[40:43], v2 offset:45056
v_mfma_f32_16x16x32_bf16 v[148:151], v[68:71], v[92:95], v[148:151]
v_mfma_f32_16x16x32_bf16 v[152:155], v[72:75], v[88:91], v[152:155]
v_mfma_f32_16x16x32_bf16 v[156:159], v[72:75], v[92:95], v[156:159]
v_mfma_f32_16x16x32_bf16 v[160:163], v[76:79], v[88:91], v[160:163]
v_mfma_f32_16x16x32_bf16 v[164:167], v[76:79], v[92:95], v[164:167]
s_waitcnt lgkmcnt(0)
v_mfma_f32_16x16x32_bf16 v[96:99], v[8:11], v[80:83], v[96:99]
ds_read_b64_tr_b16 v[88:89], v4 offset:45056
v_mfma_f32_16x16x32_bf16 v[100:103], v[8:11], v[84:87], v[100:103]
ds_read_b64_tr_b16 v[90:91], v4 offset:49152
v_mfma_f32_16x16x32_bf16 v[104:107], v[12:15], v[80:83], v[104:107]
ds_read_b64_tr_b16 v[92:93], v5 offset:45056
v_mfma_f32_16x16x32_bf16 v[108:111], v[12:15], v[84:87], v[108:111]
ds_read_b64_tr_b16 v[94:95], v5 offset:49152
v_mfma_f32_16x16x32_bf16 v[112:115], v[16:19], v[80:83], v[112:115]
ds_read_b128 v[44:47], v2 offset:46080
v_mfma_f32_16x16x32_bf16 v[116:119], v[16:19], v[84:87], v[116:119]
ds_read_b128 v[48:51], v2 offset:47104
v_mfma_f32_16x16x32_bf16 v[120:123], v[20:23], v[80:83], v[120:123]
ds_read_b128 v[52:55], v2 offset:48128
v_mfma_f32_16x16x32_bf16 v[124:127], v[20:23], v[84:87], v[124:127]
ds_read_b128 v[56:59], v2 offset:49152
v_mfma_f32_16x16x32_bf16 v[128:131], v[24:27], v[80:83], v[128:131]
ds_read_b128 v[60:63], v2 offset:50176
v_mfma_f32_16x16x32_bf16 v[132:135], v[24:27], v[84:87], v[132:135]
ds_read_b128 v[64:67], v2 offset:51200
v_mfma_f32_16x16x32_bf16 v[136:139], v[28:31], v[80:83], v[136:139]
ds_read_b128 v[68:71], v2 offset:52224
v_mfma_f32_16x16x32_bf16 v[140:143], v[28:31], v[84:87], v[140:143]
ds_read_b128 v[72:75], v2 offset:53248
v_mfma_f32_16x16x32_bf16 v[144:147], v[32:35], v[80:83], v[144:147]
ds_read_b128 v[76:79], v2 offset:54272
v_mfma_f32_16x16x32_bf16 v[148:151], v[32:35], v[84:87], v[148:151]
v_mfma_f32_16x16x32_bf16 v[152:155], v[36:39], v[80:83], v[152:155]
v_mfma_f32_16x16x32_bf16 v[156:159], v[36:39], v[84:87], v[156:159]
v_mfma_f32_16x16x32_bf16 v[160:163], v[40:43], v[80:83], v[160:163]
v_mfma_f32_16x16x32_bf16 v[164:167], v[40:43], v[84:87], v[164:167]
s_waitcnt lgkmcnt(0)
v_mfma_f32_16x16x32_bf16 v[96:99], v[44:47], v[88:91], v[96:99]
v_mfma_f32_16x16x32_bf16 v[100:103], v[44:47], v[92:95], v[100:103]
v_mfma_f32_16x16x32_bf16 v[104:107], v[48:51], v[88:91], v[104:107]
v_mfma_f32_16x16x32_bf16 v[108:111], v[48:51], v[92:95], v[108:111]
v_mfma_f32_16x16x32_bf16 v[112:115], v[52:55], v[88:91], v[112:115]
v_mfma_f32_16x16x32_bf16 v[116:119], v[52:55], v[92:95], v[116:119]
v_mfma_f32_16x16x32_bf16 v[120:123], v[56:59], v[88:91], v[120:123]
v_mfma_f32_16x16x32_bf16 v[124:127], v[56:59], v[92:95], v[124:127]
v_mfma_f32_16x16x32_bf16 v[128:131], v[60:63], v[88:91], v[128:131]
v_mfma_f32_16x16x32_bf16 v[132:135], v[60:63], v[92:95], v[132:135]
v_cvt_pk_bf16_f32 v168, v96, v97
v_cvt_pk_bf16_f32 v169, v98, v99
v_cvt_pk_bf16_f32 v170, v100, v101
v_mfma_f32_16x16x32_bf16 v[136:139], v[64:67], v[88:91], v[136:139]
v_cvt_pk_bf16_f32 v171, v102, v103
buffer_store_dwordx4 v[168:171], v0, s[36:39], s32 offen offset:0 sc1
v_mfma_f32_16x16x32_bf16 v[140:143], v[64:67], v[92:95], v[140:143]
v_cvt_pk_bf16_f32 v172, v104, v105
v_cvt_pk_bf16_f32 v173, v106, v107
v_cvt_pk_bf16_f32 v174, v108, v109
v_mfma_f32_16x16x32_bf16 v[144:147], v[68:71], v[88:91], v[144:147]
v_cvt_pk_bf16_f32 v175, v110, v111
buffer_store_dwordx4 v[172:175], v0, s[36:39], s32 offen offset:1024 sc1
v_mfma_f32_16x16x32_bf16 v[148:151], v[68:71], v[92:95], v[148:151]
v_cvt_pk_bf16_f32 v176, v112, v113
v_cvt_pk_bf16_f32 v177, v114, v115
v_cvt_pk_bf16_f32 v178, v116, v117
v_mfma_f32_16x16x32_bf16 v[152:155], v[72:75], v[88:91], v[152:155]
v_cvt_pk_bf16_f32 v179, v118, v119
buffer_store_dwordx4 v[176:179], v0, s[36:39], s32 offen offset:2048 sc1
v_mfma_f32_16x16x32_bf16 v[156:159], v[72:75], v[92:95], v[156:159]
v_cvt_pk_bf16_f32 v180, v120, v121
v_cvt_pk_bf16_f32 v181, v122, v123
v_cvt_pk_bf16_f32 v182, v124, v125
v_mfma_f32_16x16x32_bf16 v[160:163], v[76:79], v[88:91], v[160:163]
v_cvt_pk_bf16_f32 v183, v126, v127
buffer_store_dwordx4 v[180:183], v0, s[36:39], s32 offen offset:3072 sc1
v_mfma_f32_16x16x32_bf16 v[164:167], v[76:79], v[92:95], v[164:167]
v_cvt_pk_bf16_f32 v184, v128, v129
v_cvt_pk_bf16_f32 v185, v130, v131
v_cvt_pk_bf16_f32 v186, v132, v133
v_cvt_pk_bf16_f32 v187, v134, v135
buffer_store_dwordx4 v[184:187], v0, s[36:39], s34 offen offset:0 sc1
v_cvt_pk_bf16_f32 v188, v136, v137
v_cvt_pk_bf16_f32 v189, v138, v139
v_cvt_pk_bf16_f32 v190, v140, v141
v_cvt_pk_bf16_f32 v191, v142, v143
buffer_store_dwordx4 v[188:191], v0, s[36:39], s34 offen offset:1024 sc1
v_cvt_pk_bf16_f32 v192, v144, v145
v_cvt_pk_bf16_f32 v193, v146, v147
v_cvt_pk_bf16_f32 v194, v148, v149
v_cvt_pk_bf16_f32 v195, v150, v151
buffer_store_dwordx4 v[192:195], v0, s[36:39], s34 offen offset:2048 sc1
v_cvt_pk_bf16_f32 v196, v152, v153
v_cvt_pk_bf16_f32 v197, v154, v155
v_cvt_pk_bf16_f32 v198, v156, v157
v_cvt_pk_bf16_f32 v199, v158, v159
buffer_store_dwordx4 v[196:199], v0, s[36:39], s34 offen offset:3072 sc1
v_cvt_pk_bf16_f32 v200, v160, v161
v_cvt_pk_bf16_f32 v201, v162, v163
v_cvt_pk_bf16_f32 v202, v164, v165
v_cvt_pk_bf16_f32 v203, v166, v167
buffer_store_dwordx4 v[200:203], v0, s[36:39], s35 offen offset:0 sc1
s_lshl_b32 s3, s16, 10
v_add_u32 v4, s3, v2
v_add_u32 v5, 110592, v4
v_add_u32 v3, 110592, v2
s_and_b32 s17, s16, 1
s_lshl_b32 s3, s17, 10
s_add_u32 s3, s3, 73728
v_add_u32 v6, s3, v2
v_xor_b32 v7, 1024, v6
s_cmp_eq_u32 s17, 0
s_cselect_b32 s3, 81920, 0
s_cselect_b32 s18, 0, 81920
s_cselect_b32 s19, 0, 159744
s_cselect_b32 s21, 159744, 0
s_add_u32 s3, s3, s19
s_add_u32 s18, s18, s21
s_cmp_eq_u32 s17, 0
s_cselect_b32 s19, 9, 1
s_cselect_b32 s21, 1, 9
s_lshl_b32 s19, s19, 10
s_lshl_b32 s21, s21, 10
v_add_u32 v224, s3, v2
v_add_u32 v225, s18, v2
s_add_u32 s3, s3, s19
s_add_u32 s18, s18, s21
v_add_u32 v226, s3, v2
v_add_u32 v227, s18, v2
s_add_u32 s3, s3, s19
s_add_u32 s18, s18, s21
v_add_u32 v228, s3, v2
v_add_u32 v229, s18, v2
s_add_u32 s3, s3, s19
s_add_u32 s18, s18, s21
v_add_u32 v230, s3, v2
v_add_u32 v231, s18, v2
s_add_u32 s3, s3, s19
s_add_u32 s18, s18, s21
v_add_u32 v232, 65536, v4
v_add_u32 v233, 65536, v2
v_add_u32 v234, 147456, v2
s_barrier
ds_read_b128 v[8:11], v6 offset:0
ds_read_b128 v[12:15], v7 offset:0
ds_read_b128 v[16:19], v5 offset:0
ds_read_b128 v[20:23], v5 offset:4096
ds_read_b128 v[24:27], v3 offset:8192
ds_read_b128 v[28:31], v6 offset:9216
ds_read_b128 v[32:35], v7 offset:9216
ds_read_b128 v[36:39], v5 offset:9216
ds_read_b128 v[40:43], v5 offset:13312
ds_read_b128 v[44:47], v3 offset:17408
ds_read_b128 v[48:51], v6 offset:18432
ds_read_b128 v[52:55], v7 offset:18432
ds_read_b128 v[56:59], v5 offset:18432
ds_read_b128 v[60:63], v5 offset:22528
ds_read_b128 v[64:67], v3 offset:26624
ds_read_b128 v[68:71], v6 offset:27648
ds_read_b128 v[72:75], v7 offset:27648
ds_read_b128 v[76:79], v5 offset:27648
ds_read_b128 v[80:83], v5 offset:31744
ds_read_b128 v[84:87], v3 offset:35840
s_waitcnt vmcnt(0)
v_mov_b32 v236, s100
v_mov_b32 v237, s101
v_mov_b32 v238, s30
s_mov_b64 exec, 1
buffer_store_dwordx2 v[236:237], v238, s[96:99], 0 offen sc1
s_mov_b64 exec, -1
s_waitcnt lgkmcnt(0)
s_barrier
v_mfma_f32_16x16x32_bf16 v[204:207], v[16:19], v[8:11], 0
ds_read_b128 v[88:91], v6 offset:2048
v_mfma_f32_16x16x32_bf16 v[208:211], v[16:19], v[12:15], 0
ds_read_b128 v[92:95], v7 offset:2048
v_mfma_f32_16x16x32_bf16 v[212:215], v[20:23], v[8:11], 0
ds_read_b128 v[96:99], v4 offset:0
v_mfma_f32_16x16x32_bf16 v[216:219], v[20:23], v[12:15], 0
ds_read_b128 v[100:103], v4 offset:4096
v_mfma_f32_16x16x32_bf16 v[220:223], v[24:27], v[8:11], 0
ds_read_b128 v[104:107], v2 offset:8192
v_mfma_f32_16x16x32_bf16 v[204:207], v[36:39], v[28:31], v[204:207]
ds_read_b128 v[108:111], v6 offset:11264
v_mfma_f32_16x16x32_bf16 v[208:211], v[36:39], v[32:35], v[208:211]
ds_read_b128 v[112:115], v7 offset:11264
v_mfma_f32_16x16x32_bf16 v[212:215], v[40:43], v[28:31], v[212:215]
ds_read_b128 v[116:119], v4 offset:9216
v_mfma_f32_16x16x32_bf16 v[216:219], v[40:43], v[32:35], v[216:219]
ds_read_b128 v[120:123], v4 offset:13312
v_mfma_f32_16x16x32_bf16 v[220:223], v[44:47], v[28:31], v[220:223]
ds_read_b128 v[124:127], v2 offset:17408
v_mfma_f32_16x16x32_bf16 v[204:207], v[56:59], v[48:51], v[204:207]
ds_read_b128 v[128:131], v6 offset:20480
v_mfma_f32_16x16x32_bf16 v[208:211], v[56:59], v[52:55], v[208:211]
ds_read_b128 v[132:135], v7 offset:20480
v_mfma_f32_16x16x32_bf16 v[212:215], v[60:63], v[48:51], v[212:215]
ds_read_b128 v[136:139], v4 offset:18432
v_mfma_f32_16x16x32_bf16 v[216:219], v[60:63], v[52:55], v[216:219]
ds_read_b128 v[140:143], v4 offset:22528
v_mfma_f32_16x16x32_bf16 v[220:223], v[64:67], v[48:51], v[220:223]
ds_read_b128 v[144:147], v2 offset:26624
v_mfma_f32_16x16x32_bf16 v[204:207], v[76:79], v[68:71], v[204:207]
ds_read_b128 v[148:151], v6 offset:29696
v_mfma_f32_16x16x32_bf16 v[208:211], v[76:79], v[72:75], v[208:211]
ds_read_b128 v[152:155], v7 offset:29696
v_mfma_f32_16x16x32_bf16 v[212:215], v[80:83], v[68:71], v[212:215]
ds_read_b128 v[156:159], v4 offset:27648
v_mfma_f32_16x16x32_bf16 v[216:219], v[80:83], v[72:75], v[216:219]
ds_read_b128 v[160:163], v4 offset:31744
v_mfma_f32_16x16x32_bf16 v[220:223], v[84:87], v[68:71], v[220:223]
ds_read_b128 v[164:167], v2 offset:35840
s_waitcnt lgkmcnt(0)
s_barrier
v_mfma_f32_16x16x32_bf16 v[204:207], v[96:99], v[88:91], v[204:207]
ds_read_b128 v[8:11], v234 offset:0
v_mfma_f32_16x16x32_bf16 v[208:211], v[96:99], v[92:95], v[208:211]
ds_read_b128 v[12:15], v6 offset:4096
v_mfma_f32_16x16x32_bf16 v[212:215], v[100:103], v[88:91], v[212:215]
ds_read_b128 v[16:19], v234 offset:1024
v_mfma_f32_16x16x32_bf16 v[216:219], v[100:103], v[92:95], v[216:219]
ds_read_b128 v[20:23], v6 offset:13312
v_mfma_f32_16x16x32_bf16 v[220:223], v[104:107], v[88:91], v[220:223]
ds_read_b128 v[24:27], v234 offset:2048
v_mfma_f32_16x16x32_bf16 v[204:207], v[116:119], v[108:111], v[204:207]
ds_read_b128 v[28:31], v6 offset:22528
v_mfma_f32_16x16x32_bf16 v[208:211], v[116:119], v[112:115], v[208:211]
ds_read_b128 v[32:35], v234 offset:3072
v_mfma_f32_16x16x32_bf16 v[212:215], v[120:123], v[108:111], v[212:215]
ds_read_b128 v[36:39], v6 offset:31744
v_mfma_f32_16x16x32_bf16 v[216:219], v[120:123], v[112:115], v[216:219]
ds_read_b128 v[40:43], v234 offset:4096
v_mfma_f32_16x16x32_bf16 v[220:223], v[124:127], v[108:111], v[220:223]
ds_read_b128 v[44:47], v6 offset:6144
v_mfma_f32_16x16x32_bf16 v[204:207], v[136:139], v[128:131], v[204:207]
ds_read_b128 v[48:51], v234 offset:5120
v_mfma_f32_16x16x32_bf16 v[208:211], v[136:139], v[132:135], v[208:211]
ds_read_b128 v[52:55], v6 offset:15360
v_mfma_f32_16x16x32_bf16 v[212:215], v[140:143], v[128:131], v[212:215]
ds_read_b128 v[56:59], v234 offset:6144
v_mfma_f32_16x16x32_bf16 v[216:219], v[140:143], v[132:135], v[216:219]
ds_read_b128 v[60:63], v6 offset:24576
v_mfma_f32_16x16x32_bf16 v[220:223], v[144:147], v[128:131], v[220:223]
ds_read_b128 v[64:67], v234 offset:7168
v_mfma_f32_16x16x32_bf16 v[204:207], v[156:159], v[148:151], v[204:207]
ds_read_b128 v[68:71], v6 offset:33792
v_mfma_f32_16x16x32_bf16 v[208:211], v[156:159], v[152:155], v[208:211]
v_mfma_f32_16x16x32_bf16 v[212:215], v[160:163], v[148:151], v[212:215]
v_mfma_f32_16x16x32_bf16 v[216:219], v[160:163], v[152:155], v[216:219]
v_mfma_f32_16x16x32_bf16 v[220:223], v[164:167], v[148:151], v[220:223]
s_waitcnt lgkmcnt(0)
v_mfma_f32_16x16x32_bf16 v[220:223], v[8:11], v[12:15], v[220:223]
ds_read_b128 v[88:91], v234 offset:8192
v_mfma_f32_16x16x32_bf16 v[220:223], v[16:19], v[20:23], v[220:223]
ds_read_b128 v[92:95], v224
v_mfma_f32_16x16x32_bf16 v[220:223], v[24:27], v[28:31], v[220:223]
ds_read_b128 v[96:99], v234 offset:9216
v_mfma_f32_16x16x32_bf16 v[220:223], v[32:35], v[36:39], v[220:223]
ds_read_b128 v[100:103], v226
v_mfma_f32_16x16x32_bf16 v[220:223], v[40:43], v[44:47], v[220:223]
ds_read_b128 v[104:107], v234 offset:10240
v_mfma_f32_16x16x32_bf16 v[220:223], v[48:51], v[52:55], v[220:223]
ds_read_b128 v[108:111], v228
v_mfma_f32_16x16x32_bf16 v[220:223], v[56:59], v[60:63], v[220:223]
ds_read_b128 v[112:115], v234 offset:11264
v_mfma_f32_16x16x32_bf16 v[220:223], v[64:67], v[68:71], v[220:223]
ds_read_b128 v[116:119], v230
s_mul_i32 s3, s17, 9472
v_add_u32 v6, s3, v254
s_lshl_b32 s18, s16, 6
v_add_u32 v4, s18, v6
s_xor_b32 s17, s17, 1
s_mul_i32 s3, s17, 9472
s_add_u32 s3, s3, s18
v_add_u32 v5, s3, v254
s_cmp_lg_u32 s16, s28
s_cbranch_scc1 K2_nown
v_lshrrev_b32 v7, 5, v1
v_xor_b32 v7, v7, v1
v_lshlrev_b32 v7, 4, v7
v_add_u32 v7, 129536, v7
s_waitcnt lgkmcnt(0)
v_mfma_f32_16x16x32_bf16 v[220:223], v[88:91], v[92:95], v[220:223]
v_mfma_f32_16x16x32_bf16 v[220:223], v[96:99], v[100:103], v[220:223]
v_mfma_f32_16x16x32_bf16 v[220:223], v[104:107], v[108:111], v[220:223]
v_mfma_f32_16x16x32_bf16 v[220:223], v[112:115], v[116:119], v[220:223]
ds_write_b128 v7, v[168:171] offset:0
ds_write_b128 v7, v[172:175] offset:1056
ds_write_b128 v7, v[176:179] offset:2112
ds_write_b128 v7, v[180:183] offset:3168
ds_write_b128 v7, v[184:187] offset:4224
ds_write_b128 v7, v[188:191] offset:5280
ds_write_b128 v7, v[192:195] offset:6336
ds_write_b128 v7, v[196:199] offset:7392
ds_write_b128 v7, v[200:203] offset:8448
s_branch K2_nown1
K2_nown:
s_waitcnt lgkmcnt(0)
v_mfma_f32_16x16x32_bf16 v[220:223], v[88:91], v[92:95], v[220:223]
v_mfma_f32_16x16x32_bf16 v[220:223], v[96:99], v[100:103], v[220:223]
v_mfma_f32_16x16x32_bf16 v[220:223], v[104:107], v[108:111], v[220:223]
v_mfma_f32_16x16x32_bf16 v[220:223], v[112:115], v[116:119], v[220:223]
K2_nown1:
s_nop 3
ds_write_b128 v4, v[204:207] offset:0
ds_write_b128 v5, v[208:211] offset:0
ds_write_b128 v4, v[212:215] offset:256
ds_write_b128 v5, v[216:219] offset:256
ds_write_b128 v6, v[220:223] offset:512
K2_fin:
s_cmp_eq_u32 s16, 7
s_cbranch_scc1 K2_fin2
v_lshlrev_b32 v40, 16, v248
v_and_b32 v41, 0xffff0000, v248
v_lshlrev_b32 v42, 16, v249
v_and_b32 v43, 0xffff0000, v249
v_lshlrev_b32 v44, 16, v250
v_and_b32 v45, 0xffff0000, v250
v_lshlrev_b32 v46, 16, v251
v_and_b32 v47, 0xffff0000, v251
v_lshlrev_b32 v48, 16, v247
v_pk_add_f32 v[40:41], v[40:41], v[48:49] op_sel_hi:[1,0]
v_pk_add_f32 v[42:43], v[42:43], v[48:49] op_sel_hi:[1,0]
v_pk_add_f32 v[44:45], v[44:45], v[48:49] op_sel_hi:[1,0]
v_pk_add_f32 v[46:47], v[46:47], v[48:49] op_sel_hi:[1,0]
s_waitcnt lgkmcnt(0)
s_barrier
ds_read_b128 v[16:19], v245
ds_read_b128 v[20:23], v245 offset:16
ds_read_b64 v[24:25], v246
ds_read_b64 v[26:27], v246 offset:256
v_subrev_u32 v50, 110592, v245
ds_read_b128 v[60:63], v50
ds_read_b128 v[64:67], v50 offset:16
s_waitcnt lgkmcnt(4)
v_pk_add_f32 v[40:41], v[40:41], v[16:17]
v_pk_add_f32 v[42:43], v[42:43], v[18:19]
v_pk_add_f32 v[44:45], v[44:45], v[20:21]
v_pk_add_f32 v[46:47], v[46:47], v[22:23]
s_waitcnt lgkmcnt(2)
v_lshlrev_b32 v8, 16, v24
v_and_b32 v9, 0xffff0000, v24
v_lshlrev_b32 v10, 16, v25
v_and_b32 v11, 0xffff0000, v25
v_lshlrev_b32 v12, 16, v26
v_and_b32 v13, 0xffff0000, v26
v_lshlrev_b32 v14, 16, v27
v_and_b32 v15, 0xffff0000, v27
v_pk_add_f32 v[40:41], v[40:41], v[8:9]
v_pk_add_f32 v[42:43], v[42:43], v[10:11]
v_pk_add_f32 v[44:45], v[44:45], v[12:13]
v_pk_add_f32 v[46:47], v[46:47], v[14:15]
s_waitcnt lgkmcnt(0)
v_pk_add_f32 v[40:41], v[40:41], v[60:61]
v_pk_add_f32 v[42:43], v[42:43], v[62:63]
v_pk_add_f32 v[44:45], v[44:45], v[64:65]
v_pk_add_f32 v[46:47], v[46:47], v[66:67]
s_waitcnt vmcnt(0)
s_barrier
ds_read_b64 v[60:61], v252 offset:0
ds_read_b64 v[62:63], v252 offset:256
ds_read_b64 v[64:65], v252 offset:9504
ds_read_b64 v[66:67], v252 offset:9760
ds_read_b64 v[68:69], v252 offset:19008
ds_read_b64 v[70:71], v252 offset:19264
s_waitcnt lgkmcnt(4)
v_lshlrev_b32 v8, 16, v60
v_and_b32 v9, 0xffff0000, v60
v_lshlrev_b32 v10, 16, v61
v_and_b32 v11, 0xffff0000, v61
v_lshlrev_b32 v12, 16, v62
v_and_b32 v13, 0xffff0000, v62
v_lshlrev_b32 v14, 16, v63
v_and_b32 v15, 0xffff0000, v63
v_pk_add_f32 v[40:41], v[40:41], v[8:9]
v_pk_add_f32 v[42:43], v[42:43], v[10:11]
v_pk_add_f32 v[44:45], v[44:45], v[12:13]
v_pk_add_f32 v[46:47], v[46:47], v[14:15]
s_waitcnt lgkmcnt(2)
v_lshlrev_b32 v8, 16, v64
v_and_b32 v9, 0xffff0000, v64
v_lshlrev_b32 v10, 16, v65
v_and_b32 v11, 0xffff0000, v65
v_lshlrev_b32 v12, 16, v66
v_and_b32 v13, 0xffff0000, v66
v_lshlrev_b32 v14, 16, v67
v_and_b32 v15, 0xffff0000, v67
v_pk_add_f32 v[40:41], v[40:41], v[8:9]
v_pk_add_f32 v[42:43], v[42:43], v[10:11]
v_pk_add_f32 v[44:45], v[44:45], v[12:13]
v_pk_add_f32 v[46:47], v[46:47], v[14:15]
s_waitcnt lgkmcnt(0)
v_lshlrev_b32 v8, 16, v68
v_and_b32 v9, 0xffff0000, v68
v_lshlrev_b32 v10, 16, v69
v_and_b32 v11, 0xffff0000, v69
v_lshlrev_b32 v12, 16, v70
v_and_b32 v13, 0xffff0000, v70
v_lshlrev_b32 v14, 16, v71
v_and_b32 v15, 0xffff0000, v71
v_pk_add_f32 v[40:41], v[40:41], v[8:9]
v_pk_add_f32 v[42:43], v[42:43], v[10:11]
v_pk_add_f32 v[44:45], v[44:45], v[12:13]
v_pk_add_f32 v[46:47], v[46:47], v[14:15]
v_cvt_pk_bf16_f32 v52, v40, v41
v_cvt_pk_bf16_f32 v53, v42, v43
v_cvt_pk_bf16_f32 v54, v44, v45
v_cvt_pk_bf16_f32 v55, v46, v47
buffer_store_dwordx4 v[52:55], v244, s[52:55], s50 offen sc1
s_branch K2_done
K2_fin2:
v_lshlrev_b32 v40, 16, v248
v_and_b32 v41, 0xffff0000, v248
v_lshlrev_b32 v42, 16, v249
v_and_b32 v43, 0xffff0000, v249
v_lshlrev_b32 v44, 16, v250
v_and_b32 v45, 0xffff0000, v250
v_lshlrev_b32 v46, 16, v251
v_and_b32 v47, 0xffff0000, v251
v_lshlrev_b32 v48, 16, v247
v_pk_add_f32 v[40:41], v[40:41], v[48:49] op_sel_hi:[1,0]
v_pk_add_f32 v[42:43], v[42:43], v[48:49] op_sel_hi:[1,0]
v_pk_add_f32 v[44:45], v[44:45], v[48:49] op_sel_hi:[1,0]
v_pk_add_f32 v[46:47], v[46:47], v[48:49] op_sel_hi:[1,0]
v_lshlrev_b32 v96, 16, v236
v_and_b32 v97, 0xffff0000, v236
v_lshlrev_b32 v98, 16, v237
v_and_b32 v99, 0xffff0000, v237
v_lshlrev_b32 v100, 16, v238
v_and_b32 v101, 0xffff0000, v238
v_lshlrev_b32 v102, 16, v239
v_and_b32 v103, 0xffff0000, v239
v_lshlrev_b32 v48, 16, v235
v_pk_add_f32 v[96:97], v[96:97], v[48:49] op_sel_hi:[1,0]
v_pk_add_f32 v[98:99], v[98:99], v[48:49] op_sel_hi:[1,0]
v_pk_add_f32 v[100:101], v[100:101], v[48:49] op_sel_hi:[1,0]
v_pk_add_f32 v[102:103], v[102:103], v[48:49] op_sel_hi:[1,0]
s_waitcnt lgkmcnt(0)
s_barrier
ds_read_b128 v[16:19], v245
ds_read_b128 v[20:23], v245 offset:16
ds_read_b64 v[24:25], v246
ds_read_b64 v[26:27], v246 offset:256
ds_read_b128 v[28:31], v233
ds_read_b128 v[32:35], v233 offset:16
ds_read_b64 v[36:37], v234
ds_read_b64 v[38:39], v234 offset:256
v_subrev_u32 v50, 110592, v245
ds_read_b128 v[60:63], v50
ds_read_b128 v[64:67], v50 offset:16
v_subrev_u32 v50, 110592, v233
ds_read_b128 v[68:71], v50
ds_read_b128 v[72:75], v50 offset:16
s_waitcnt lgkmcnt(10)
v_pk_add_f32 v[40:41], v[40:41], v[16:17]
v_pk_add_f32 v[42:43], v[42:43], v[18:19]
v_pk_add_f32 v[44:45], v[44:45], v[20:21]
v_pk_add_f32 v[46:47], v[46:47], v[22:23]
s_waitcnt lgkmcnt(8)
v_lshlrev_b32 v8, 16, v24
v_and_b32 v9, 0xffff0000, v24
v_lshlrev_b32 v10, 16, v25
v_and_b32 v11, 0xffff0000, v25
v_lshlrev_b32 v12, 16, v26
v_and_b32 v13, 0xffff0000, v26
v_lshlrev_b32 v14, 16, v27
v_and_b32 v15, 0xffff0000, v27
v_pk_add_f32 v[40:41], v[40:41], v[8:9]
v_pk_add_f32 v[42:43], v[42:43], v[10:11]
v_pk_add_f32 v[44:45], v[44:45], v[12:13]
v_pk_add_f32 v[46:47], v[46:47], v[14:15]
s_waitcnt lgkmcnt(6)
v_pk_add_f32 v[96:97], v[96:97], v[28:29]
v_pk_add_f32 v[98:99], v[98:99], v[30:31]
v_pk_add_f32 v[100:101], v[100:101], v[32:33]
v_pk_add_f32 v[102:103], v[102:103], v[34:35]
s_waitcnt lgkmcnt(4)
v_lshlrev_b32 v8, 16, v36
v_and_b32 v9, 0xffff0000, v36
v_lshlrev_b32 v10, 16, v37
v_and_b32 v11, 0xffff0000, v37
v_lshlrev_b32 v12, 16, v38
v_and_b32 v13, 0xffff0000, v38
v_lshlrev_b32 v14, 16, v39
v_and_b32 v15, 0xffff0000, v39
v_pk_add_f32 v[96:97], v[96:97], v[8:9]
v_pk_add_f32 v[98:99], v[98:99], v[10:11]
v_pk_add_f32 v[100:101], v[100:101], v[12:13]
v_pk_add_f32 v[102:103], v[102:103], v[14:15]
s_waitcnt lgkmcnt(2)
v_pk_add_f32 v[40:41], v[40:41], v[60:61]
v_pk_add_f32 v[42:43], v[42:43], v[62:63]
v_pk_add_f32 v[44:45], v[44:45], v[64:65]
v_pk_add_f32 v[46:47], v[46:47], v[66:67]
s_waitcnt lgkmcnt(0)
v_pk_add_f32 v[96:97], v[96:97], v[68:69]
v_pk_add_f32 v[98:99], v[98:99], v[70:71]
v_pk_add_f32 v[100:101], v[100:101], v[72:73]
v_pk_add_f32 v[102:103], v[102:103], v[74:75]
s_waitcnt vmcnt(0)
s_barrier
ds_read_b64 v[60:61], v252 offset:0
ds_read_b64 v[62:63], v252 offset:256
ds_read_b64 v[64:65], v252 offset:9504
ds_read_b64 v[66:67], v252 offset:9760
ds_read_b64 v[68:69], v252 offset:19008
ds_read_b64 v[70:71], v252 offset:19264
ds_read_b64 v[72:73], v240 offset:0
ds_read_b64 v[74:75], v240 offset:256
ds_read_b64 v[76:77], v240 offset:9504
ds_read_b64 v[78:79], v240 offset:9760
ds_read_b64 v[80:81], v240 offset:19008
ds_read_b64 v[82:83], v240 offset:19264
s_waitcnt lgkmcnt(10)
v_lshlrev_b32 v8, 16, v60
v_and_b32 v9, 0xffff0000, v60
v_lshlrev_b32 v10, 16, v61
v_and_b32 v11, 0xffff0000, v61
v_lshlrev_b32 v12, 16, v62
v_and_b32 v13, 0xffff0000, v62
v_lshlrev_b32 v14, 16, v63
v_and_b32 v15, 0xffff0000, v63
v_pk_add_f32 v[40:41], v[40:41], v[8:9]
v_pk_add_f32 v[42:43], v[42:43], v[10:11]
v_pk_add_f32 v[44:45], v[44:45], v[12:13]
v_pk_add_f32 v[46:47], v[46:47], v[14:15]
s_waitcnt lgkmcnt(8)
v_lshlrev_b32 v8, 16, v64
v_and_b32 v9, 0xffff0000, v64
v_lshlrev_b32 v10, 16, v65
v_and_b32 v11, 0xffff0000, v65
v_lshlrev_b32 v12, 16, v66
v_and_b32 v13, 0xffff0000, v66
v_lshlrev_b32 v14, 16, v67
v_and_b32 v15, 0xffff0000, v67
v_pk_add_f32 v[40:41], v[40:41], v[8:9]
v_pk_add_f32 v[42:43], v[42:43], v[10:11]
v_pk_add_f32 v[44:45], v[44:45], v[12:13]
v_pk_add_f32 v[46:47], v[46:47], v[14:15]
s_waitcnt lgkmcnt(6)
v_lshlrev_b32 v8, 16, v68
v_and_b32 v9, 0xffff0000, v68
v_lshlrev_b32 v10, 16, v69
v_and_b32 v11, 0xffff0000, v69
v_lshlrev_b32 v12, 16, v70
v_and_b32 v13, 0xffff0000, v70
v_lshlrev_b32 v14, 16, v71
v_and_b32 v15, 0xffff0000, v71
v_pk_add_f32 v[40:41], v[40:41], v[8:9]
v_pk_add_f32 v[42:43], v[42:43], v[10:11]
v_pk_add_f32 v[44:45], v[44:45], v[12:13]
v_pk_add_f32 v[46:47], v[46:47], v[14:15]
v_cvt_pk_bf16_f32 v52, v40, v41
v_cvt_pk_bf16_f32 v53, v42, v43
v_cvt_pk_bf16_f32 v54, v44, v45
v_cvt_pk_bf16_f32 v55, v46, v47
buffer_store_dwordx4 v[52:55], v244, s[52:55], s50 offen sc1
s_waitcnt lgkmcnt(4)
v_lshlrev_b32 v8, 16, v72
v_and_b32 v9, 0xffff0000, v72
v_lshlrev_b32 v10, 16, v73
v_and_b32 v11, 0xffff0000, v73
v_lshlrev_b32 v12, 16, v74
v_and_b32 v13, 0xffff0000, v74
v_lshlrev_b32 v14, 16, v75
v_and_b32 v15, 0xffff0000, v75
v_pk_add_f32 v[96:97], v[96:97], v[8:9]
v_pk_add_f32 v[98:99], v[98:99], v[10:11]
v_pk_add_f32 v[100:101], v[100:101], v[12:13]
v_pk_add_f32 v[102:103], v[102:103], v[14:15]
s_waitcnt lgkmcnt(2)
v_lshlrev_b32 v8, 16, v76
v_and_b32 v9, 0xffff0000, v76
v_lshlrev_b32 v10, 16, v77
v_and_b32 v11, 0xffff0000, v77
v_lshlrev_b32 v12, 16, v78
v_and_b32 v13, 0xffff0000, v78
v_lshlrev_b32 v14, 16, v79
v_and_b32 v15, 0xffff0000, v79
v_pk_add_f32 v[96:97], v[96:97], v[8:9]
v_pk_add_f32 v[98:99], v[98:99], v[10:11]
v_pk_add_f32 v[100:101], v[100:101], v[12:13]
v_pk_add_f32 v[102:103], v[102:103], v[14:15]
s_waitcnt lgkmcnt(0)
v_lshlrev_b32 v8, 16, v80
v_and_b32 v9, 0xffff0000, v80
v_lshlrev_b32 v10, 16, v81
v_and_b32 v11, 0xffff0000, v81
v_lshlrev_b32 v12, 16, v82
v_and_b32 v13, 0xffff0000, v82
v_lshlrev_b32 v14, 16, v83
v_and_b32 v15, 0xffff0000, v83
v_pk_add_f32 v[96:97], v[96:97], v[8:9]
v_pk_add_f32 v[98:99], v[98:99], v[10:11]
v_pk_add_f32 v[100:101], v[100:101], v[12:13]
v_pk_add_f32 v[102:103], v[102:103], v[14:15]
v_cvt_pk_bf16_f32 v56, v96, v97
v_cvt_pk_bf16_f32 v57, v98, v99
v_cvt_pk_bf16_f32 v58, v100, v101
v_cvt_pk_bf16_f32 v59, v102, v103
buffer_store_dwordx4 v[56:59], v232, s[52:55], s50 offen sc1
K2_done:
s_endpgm
K2_ld:
s_load_dwordx4 s[4:7], s[0:1], 56
s_load_dwordx2 s[44:45], s[0:1], 0
s_load_dwordx2 s[46:47], s[0:1], 72
s_and_b32 s17, s2, 7
s_lshr_b32 s18, s2, 3
s_lshr_b32 s28, s17, 1
s_lshl_b32 s22, s17, 1
s_add_u32 s22, s22, s18
s_and_b32 s22, s22, 3
s_and_b32 s17, s17, 1
s_lshl_b32 s17, s17, 3
s_lshr_b32 s18, s18, 2
s_add_u32 s23, s17, s18
s_cmp_eq_u32 s49, 2147483648
s_cbranch_scc1 K2_ld1
s_waitcnt vmcnt(0)
v_mov_b32 v8, s100
v_mov_b32 v9, s101
v_mov_b32 v10, s49
s_mov_b64 exec, 1
buffer_store_dwordx2 v[8:9], v10, s[96:99], 0 offen sc1
s_mov_b64 exec, -1
K2_ld1:
s_lshr_b32 s56, s2, 3
s_lshl_b32 s3, s2, 1
s_add_u32 s56, s56, s3
s_and_b32 s56, s56, 3
s_mul_i32 s56, s56, 20
s_add_u32 s3, s56, 712
v_and_b32 v36, 63, v0
v_lshlrev_b32 v37, 4, v36
v_min_u32 v36, 19, v36
v_add_lshl_u32 v36, v36, s3, 7
s_sub_u32 s3, s16, 4
s_mul_i32 s55, s3, 46080
s_add_u32 s55, s55, 8192
v_add_u32 v33, s55, v37
s_lshl_b32 s3, s3, 10
v_add_u32 v37, s3, v37
v_add_u32 v23, 4096, v37
s_cmp_lt_u32 s2, 144
s_cbranch_scc1 Lw_46
s_mov_b32 s63, 60000
Lp_47:
buffer_load_dwordx2 v[38:39], v36, s[96:99], 0 offen sc1
s_waitcnt vmcnt(0)
v_cmp_ne_u64 vcc, s[100:101], v[38:39]
s_sub_u32 s63, s63, 1
s_cbranch_scc1 Lx_48
s_nop 2
s_cbranch_vccz Lx_48
s_mov_b64 exec, vcc
s_sleep 2
s_branch Lp_47
Lx_48:
s_mov_b64 exec, -1
Lw_46:
s_add_u32 s92, s26, 19922944
s_addc_u32 s93, s27, 0
s_mov_b32 s94, 737280
s_mov_b32 s95, 0x20000
s_add_u32 s56, s56, 2
s_mul_i32 s56, s56, 9216
s_cmp_lt_u32 s2, 144
s_cselect_b32 s3, 9216, 0
s_add_u32 s56, s56, s3
s_mul_i32 s57, s28, 9
s_sub_u32 s57, s24, s57
s_lshl_b32 s57, s57, 1
s_sub_u32 s58, 16, s57
s_bitcmp1_b32 s2, 0
s_cselect_b32 s57, s58, s57
s_cmp_lt_u32 s2, 144
s_cselect_b32 s57, s57, 64
s_cselect_b32 s58, 4, 6
s_lshl_b32 s59, s22, 1
s_add_u32 s59, s59, s23
s_and_b32 s59, s59, 7
s_mul_i32 s59, s59, s58
s_lshr_b32 s59, s59, 3
s_sub_u32 s29, s16, 4
s_mul_i32 s34, s29, 9216
s_lshl_b32 s32, s22, 2
s_add_u32 s32, s32, s29
s_mul_i32 s32, s32, 46080
s_add_u32 s32, s32, 19922944
v_and_b32 v24, 63, v0
v_lshlrev_b32 v20, 4, v24
v_add_u32 v21, 4096, v20
v_add_u32 v22, 8192, v20
s_mov_b32 s36, s26
s_mov_b32 s37, s27
s_mov_b32 s38, 36175872
s_mov_b32 s39, 0x20000
s_waitcnt lgkmcnt(0)
s_mov_b32 s8, s44
s_mov_b32 s9, s45
s_mov_b32 s10, 2359296
s_mov_b32 s11, 0x20000
s_mov_b32 s12, s6
s_mov_b32 s13, s7
s_mov_b32 s14, 4096
s_mov_b32 s15, 0x20000
s_mov_b32 s52, s46
s_mov_b32 s53, s47
s_mov_b32 s54, 2359296
s_mov_b32 s55, 0x20000
s_lshl_b32 s50, s23, 2
s_add_u32 s50, s50, s28
s_lshl_b32 s51, s50, 6
s_mul_i32 s50, s50, 36864
s_mul_i32 s17, s22, 288
s_add_u32 s50, s50, s17
v_mov_b32 v252, v0
v_mul_u32_u24 v253, 3641, v252
v_lshrrev_b32 v253, 16, v253
v_mul_u32_u24 v254, 18, v253
v_sub_u32 v254, v252, v254
v_mul_u32_u24 v252, 1152, v253
v_lshl_add_u32 v244, v254, 4, v252
v_mul_u32_u24 v252, 592, v253
v_lshl_add_u32 v245, v254, 5, v252
v_add_u32 v245, 110592, v245
v_lshrrev_b32 v252, 1, v254
v_mul_u32_u24 v252, 1056, v252
v_and_b32 v254, 1, v254
v_lshl_add_u32 v252, v254, 9, v252
v_xor_b32 v254, v254, v253
v_and_b32 v254, 15, v254
v_lshl_add_u32 v252, v254, 4, v252
v_lshrrev_b32 v254, 4, v253
v_lshl_add_u32 v252, v254, 3, v252
v_add_u32 v241, 36864, v252
v_add_u32 v246, 129536, v252
v_lshlrev_b32 v242, 1, v253
v_mov_b32 v243, 2147483648
s_mov_b32 s46, 2359296
s_mov_b32 s47, 0x20000
v_mov_b32 v232, 2147483648
s_cmp_lg_u32 s16, 7
s_cbranch_scc1 K2_fp1
v_and_b32 v252, 63, v0
v_add_u32 v252, 512, v252
v_mul_u32_u24 v253, 3641, v252
v_lshrrev_b32 v253, 16, v253
v_mul_u32_u24 v254, 18, v253
v_sub_u32 v254, v252, v254
v_mul_u32_u24 v252, 1152, v253
v_lshl_add_u32 v232, v254, 4, v252
v_mul_u32_u24 v252, 592, v253
v_lshl_add_u32 v233, v254, 5, v252
v_add_u32 v233, 110592, v233
v_lshrrev_b32 v252, 1, v254
v_mul_u32_u24 v252, 1056, v252
v_and_b32 v254, 1, v254
v_lshl_add_u32 v252, v254, 9, v252
v_xor_b32 v254, v254, v253
v_and_b32 v254, 15, v254
v_lshl_add_u32 v252, v254, 4, v252
v_lshrrev_b32 v254, 4, v253
v_lshl_add_u32 v252, v254, 3, v252
v_add_u32 v240, 36864, v252
v_add_u32 v234, 129536, v252
v_lshlrev_b32 v243, 1, v253
K2_fp1:
v_mov_b32 v252, v241
s_lshl_b32 s30, s23, 2
s_add_u32 s30, s30, s22
s_lshl_b32 s30, s30, 2
s_add_u32 s30, s30, s28
s_lshl_b32 s30, s30, 2
s_add_u32 s30, s30, s29
s_add_u32 s3, s30, 1608
s_lshl_b32 s3, s3, 7
v_mov_b32 v32, s3
s_mul_i32 s30, s30, 9216
s_cmp_gt_u32 s29, s28
s_cselect_b32 s3, 1, 0
s_sub_u32 s31, s29, s3
s_mul_i32 s31, s31, 9504
s_lshl_b32 s40, s22, 2
s_add_u32 s40, s40, s29
s_mul_i32 s40, s40, 5
s_add_u32 s40, s40, 712
v_add_u32 v28, s40, v24
v_cmp_gt_u32 vcc, 5, v24
s_lshl_b32 s33, s23, 2
s_add_u32 s33, s33, s28
s_lshl_b32 s33, s33, 2
s_add_u32 s33, s33, s29
s_lshr_b32 s40, s33, 1
s_add_u32 s40, s40, 1480
v_mov_b32 v29, s40
v_cndmask_b32 v28, v29, v28, vcc
v_lshlrev_b32 v28, 7, v28
s_mul_i32 s33, s33, 10240
s_add_u32 s33, s33, 33554432
s_lshl_b32 s48, s40, 7
s_cmp_ge_u32 s16, 6
s_cbranch_scc1 K2_ldW
s_add_u32 s8, s26, 6815744
s_addc_u32 s9, s27, 0
s_mov_b32 s10, 5308416
s_mov_b32 s11, 0x20000
s_sub_u32 s17, s16, 4
s_lshl_b32 s21, s22, 2
s_add_u32 s21, s21, s28
s_mul_i32 s40, s21, 36
s_mul_i32 s21, s21, 331776
s_add_u32 s40, s40, s17
s_add_u32 s40, s40, 792
v_min_u32 v8, 17, v24
v_lshl_add_u32 v8, v8, 1, s40
v_lshlrev_b32 v8, 7, v8
s_mov_b32 s35, s21
s_sub_u32 s60, s58, s59
s_mov_b32 s61, s58
s_mov_b32 s19, 18432
s_bitcmp1_b32 s2, 0
s_cselect_b32 s62, 313344, 0
s_cselect_b32 s19, -18432, s19
s_add_u32 s35, s35, s62
s_cmp_ge_u32 s59, s57
s_cselect_b32 s62, 2, 0
s_add_u32 s62, s62, s59
s_mul_i32 s62, s62, s19
s_add_u32 s21, s35, s62
v_and_b32 v1, 63, v0
v_lshlrev_b32 v1, 4, v1
s_mul_i32 s18, s17, 9216
v_add_u32 v2, s18, v1
v_add_u32 v3, 4096, v2
v_add_u32 v4, 8192, v2
s_mov_b32 s20, 3
s_cmp_ge_u32 s2, 144
s_cbranch_scc1 K2_pn
s_barrier
s_mov_b32 s40, s6
s_mov_b32 s41, s7
s_mov_b32 s42, 4096
s_mov_b32 s43, 0x20000
buffer_load_dwordx4 v[248:251], v244, s[44:47], s50 offen
buffer_load_ushort v247, v242, s[40:43], s51 offen
s_cmp_lg_u32 s16, 7
s_cbranch_scc1 Lxl_50
buffer_load_dwordx4 v[236:239], v232, s[44:47], s50 offen
buffer_load_ushort v235, v243, s[40:43], s51 offen
Lxl_50:
s_sub_u32 s3, s16, 4
s_lshl_b32 s3, s3, 10
s_add_u32 m0, s3, 151552
s_mov_b32 s3, s56
buffer_load_dwordx4 v33, s[92:95], s56 offen sc1 lds
buffer_load_dwordx4 v[72:75], v37, s[92:95], s3 offen sc1
buffer_load_dwordx4 v[76:79], v23, s[92:95], s3 offen sc1
s_add_u32 s3, s3, 46080
buffer_load_dwordx4 v[80:83], v37, s[92:95], s3 offen sc1
buffer_load_dwordx4 v[84:87], v23, s[92:95], s3 offen sc1
s_add_u32 s3, s3, 46080
buffer_load_dwordx4 v[88:91], v37, s[92:95], s3 offen sc1
buffer_load_dwordx4 v[92:95], v23, s[92:95], s3 offen sc1
s_add_u32 s3, s3, 46080
buffer_load_dwordx4 v[96:99], v37, s[92:95], s3 offen sc1
buffer_load_dwordx4 v[100:103], v23, s[92:95], s3 offen sc1
s_add_u32 s56, s56, 9216
s_mov_b64 exec, 1
s_mov_b32 s63, 60000
Lp_52:
buffer_load_dwordx2 v[10:11], v8, s[96:99], 0 offen sc1
s_waitcnt vmcnt(0)
v_cmp_ne_u64 vcc, s[100:101], v[10:11]
s_sub_u32 s63, s63, 1
s_cbranch_scc1 Lx_53
s_nop 2
s_cbranch_vccz Lx_53
s_mov_b64 exec, vcc
s_sleep 8
s_branch Lp_52
Lx_53:
s_mov_b64 exec, -1
Ls_51:
s_mov_b32 s63, 60000
Lp_54:
buffer_load_dwordx2 v[10:11], v8, s[96:99], 0 offen sc1
s_waitcnt vmcnt(0)
v_cmp_ne_u64 vcc, s[100:101], v[10:11]
s_sub_u32 s63, s63, 1
s_cbranch_scc1 Lx_55
s_nop 2
s_cbranch_vccz Lx_55
s_mov_b64 exec, vcc
s_sleep 1
s_branch Lp_54
Lx_55:
s_mov_b64 exec, -1
s_add_u32 m0, s18, 73728
s_nop 0
buffer_load_dwordx4 v2, s[8:11], s21 offen offset:0 sc1 lds
buffer_load_dwordx4 v2, s[8:11], s21 offen offset:1024 sc1 lds
buffer_load_dwordx4 v2, s[8:11], s21 offen offset:2048 sc1 lds
buffer_load_dwordx4 v2, s[8:11], s21 offen offset:3072 sc1 lds
s_add_u32 m0, s18, 77824
s_nop 0
buffer_load_dwordx4 v3, s[8:11], s21 offen offset:0 sc1 lds
buffer_load_dwordx4 v3, s[8:11], s21 offen offset:1024 sc1 lds
buffer_load_dwordx4 v3, s[8:11], s21 offen offset:2048 sc1 lds
buffer_load_dwordx4 v3, s[8:11], s21 offen offset:3072 sc1 lds
s_add_u32 m0, s18, 81920
s_nop 0
buffer_load_dwordx4 v4, s[8:11], s21 offen offset:0 sc1 lds
s_add_u32 s59, s59, 1
s_sub_u32 s60, s60, 1
s_cmp_eq_u32 s60, 0
s_cselect_b32 s62, s58, 0
s_cselect_b32 s60, s58, s60
s_sub_u32 s59, s59, s62
s_sub_u32 s61, s61, 1
s_cmp_eq_u32 s61, 0
s_cselect_b32 s62, s58, 0
s_cselect_b32 s61, s58, s61
s_add_u32 s59, s59, s62
s_cmp_ge_u32 s59, s57
s_cselect_b32 s62, 2, 0
s_add_u32 s62, s62, s59
s_mul_i32 s62, s62, s19
s_add_u32 s21, s35, s62
s_add_u32 m0, s18, 110592
s_nop 0
buffer_load_dwordx4 v2, s[8:11], s21 offen offset:0 sc1 lds
buffer_load_dwordx4 v2, s[8:11], s21 offen offset:1024 sc1 lds
buffer_load_dwordx4 v2, s[8:11], s21 offen offset:2048 sc1 lds
buffer_load_dwordx4 v2, s[8:11], s21 offen offset:3072 sc1 lds
s_add_u32 m0, s18, 114688
s_nop 0
buffer_load_dwordx4 v3, s[8:11], s21 offen offset:0 sc1 lds
buffer_load_dwordx4 v3, s[8:11], s21 offen offset:1024 sc1 lds
buffer_load_dwordx4 v3, s[8:11], s21 offen offset:2048 sc1 lds
buffer_load_dwordx4 v3, s[8:11], s21 offen offset:3072 sc1 lds
s_add_u32 m0, s18, 118784
s_nop 0
buffer_load_dwordx4 v4, s[8:11], s21 offen offset:0 sc1 lds
s_add_u32 s59, s59, 1
s_sub_u32 s60, s60, 1
s_cmp_eq_u32 s60, 0
s_cselect_b32 s62, s58, 0
s_cselect_b32 s60, s58, s60
s_sub_u32 s59, s59, s62
s_sub_u32 s61, s61, 1
s_cmp_eq_u32 s61, 0
s_cselect_b32 s62, s58, 0
s_cselect_b32 s61, s58, s61
s_add_u32 s59, s59, s62
s_cmp_ge_u32 s59, s57
s_cselect_b32 s62, 2, 0
s_add_u32 s62, s62, s59
s_mul_i32 s62, s62, s19
s_add_u32 s21, s35, s62
s_waitcnt vmcnt(9)
s_barrier
s_add_u32 m0, s18, 0
s_nop 0
buffer_load_dwordx4 v2, s[8:11], s21 offen offset:0 sc1 lds
buffer_load_dwordx4 v2, s[8:11], s21 offen offset:1024 sc1 lds
buffer_load_dwordx4 v2, s[8:11], s21 offen offset:2048 sc1 lds
buffer_load_dwordx4 v2, s[8:11], s21 offen offset:3072 sc1 lds
s_add_u32 m0, s18, 4096
s_nop 0
buffer_load_dwordx4 v3, s[8:11], s21 offen offset:0 sc1 lds
buffer_load_dwordx4 v3, s[8:11], s21 offen offset:1024 sc1 lds
buffer_load_dwordx4 v3, s[8:11], s21 offen offset:2048 sc1 lds
buffer_load_dwordx4 v3, s[8:11], s21 offen offset:3072 sc1 lds
s_add_u32 m0, s18, 8192
s_nop 0
buffer_load_dwordx4 v4, s[8:11], s21 offen offset:0 sc1 lds
s_add_u32 s59, s59, 1
s_sub_u32 s60, s60, 1
s_cmp_eq_u32 s60, 0
s_cselect_b32 s62, s58, 0
s_cselect_b32 s60, s58, s60
s_sub_u32 s59, s59, s62
s_sub_u32 s61, s61, 1
s_cmp_eq_u32 s61, 0
s_cselect_b32 s62, s58, 0
s_cselect_b32 s61, s58, s61
s_add_u32 s59, s59, s62
s_cmp_ge_u32 s59, s57
s_cselect_b32 s62, 2, 0
s_add_u32 s62, s62, s59
s_mul_i32 s62, s62, s19
s_add_u32 s21, s35, s62
s_add_u32 m0, s18, 36864
s_nop 0
buffer_load_dwordx4 v2, s[8:11], s21 offen offset:0 sc1 lds
buffer_load_dwordx4 v2, s[8:11], s21 offen offset:1024 sc1 lds
buffer_load_dwordx4 v2, s[8:11], s21 offen offset:2048 sc1 lds
buffer_load_dwordx4 v2, s[8:11], s21 offen offset:3072 sc1 lds
s_add_u32 m0, s18, 40960
s_nop 0
buffer_load_dwordx4 v3, s[8:11], s21 offen offset:0 sc1 lds
buffer_load_dwordx4 v3, s[8:11], s21 offen offset:1024 sc1 lds
buffer_load_dwordx4 v3, s[8:11], s21 offen offset:2048 sc1 lds
buffer_load_dwordx4 v3, s[8:11], s21 offen offset:3072 sc1 lds
s_add_u32 m0, s18, 45056
s_nop 0
buffer_load_dwordx4 v4, s[8:11], s21 offen offset:0 sc1 lds
s_add_u32 s59, s59, 1
s_sub_u32 s60, s60, 1
s_cmp_eq_u32 s60, 0
s_cselect_b32 s62, s58, 0
s_cselect_b32 s60, s58, s60
s_sub_u32 s59, s59, s62
s_sub_u32 s61, s61, 1
s_cmp_eq_u32 s61, 0
s_cselect_b32 s62, s58, 0
s_cselect_b32 s61, s58, s61
s_add_u32 s59, s59, s62
s_cmp_ge_u32 s59, s57
s_cselect_b32 s62, 2, 0
s_add_u32 s62, s62, s59
s_mul_i32 s62, s62, s19
s_add_u32 s21, s35, s62
s_branch Ll_49_3
K2_pn:
s_mov_b32 s40, s6
s_mov_b32 s41, s7
s_mov_b32 s42, 4096
s_mov_b32 s43, 0x20000
buffer_load_dwordx4 v[248:251], v244, s[44:47], s50 offen
buffer_load_ushort v247, v242, s[40:43], s51 offen
s_cmp_lg_u32 s16, 7
s_cbranch_scc1 Lxl_56
buffer_load_dwordx4 v[236:239], v232, s[44:47], s50 offen
buffer_load_ushort v235, v243, s[40:43], s51 offen
Lxl_56:
s_sub_u32 s3, s2, 208
s_cmp_ge_u32 s3, 32
s_cbranch_scc1 Lg_57
s_sub_u32 s3, s16, 4
s_lshl_b32 s3, s3, 10
s_add_u32 m0, s3, 147456
s_mov_b32 s3, s56
buffer_load_dwordx4 v33, s[92:95], s56 offen sc1 lds
buffer_load_dwordx4 v[40:43], v37, s[92:95], s3 offen sc1
buffer_load_dwordx4 v[44:47], v23, s[92:95], s3 offen sc1
s_add_u32 s3, s3, 46080
buffer_load_dwordx4 v[48:51], v37, s[92:95], s3 offen sc1
buffer_load_dwordx4 v[52:55], v23, s[92:95], s3 offen sc1
s_add_u32 s3, s3, 46080
buffer_load_dwordx4 v[56:59], v37, s[92:95], s3 offen sc1
buffer_load_dwordx4 v[60:63], v23, s[92:95], s3 offen sc1
s_add_u32 s3, s3, 46080
buffer_load_dwordx4 v[64:67], v37, s[92:95], s3 offen sc1
buffer_load_dwordx4 v[68:71], v23, s[92:95], s3 offen sc1
s_add_u32 s56, s56, 9216
s_sub_u32 s3, s16, 4
s_lshl_b32 s3, s3, 10
s_add_u32 m0, s3, 151552
s_mov_b32 s3, s56
buffer_load_dwordx4 v33, s[92:95], s56 offen sc1 lds
buffer_load_dwordx4 v[72:75], v37, s[92:95], s3 offen sc1
buffer_load_dwordx4 v[76:79], v23, s[92:95], s3 offen sc1
s_add_u32 s3, s3, 46080
buffer_load_dwordx4 v[80:83], v37, s[92:95], s3 offen sc1
buffer_load_dwordx4 v[84:87], v23, s[92:95], s3 offen sc1
s_add_u32 s3, s3, 46080
buffer_load_dwordx4 v[88:91], v37, s[92:95], s3 offen sc1
buffer_load_dwordx4 v[92:95], v23, s[92:95], s3 offen sc1
s_add_u32 s3, s3, 46080
buffer_load_dwordx4 v[96:99], v37, s[92:95], s3 offen sc1
buffer_load_dwordx4 v[100:103], v23, s[92:95], s3 offen sc1
s_add_u32 s56, s56, 9216
s_sub_u32 s3, s16, 4
s_lshl_b32 s3, s3, 10
s_add_u32 m0, s3, 155648
s_mov_b32 s3, s56
buffer_load_dwordx4 v33, s[92:95], s56 offen sc1 lds
buffer_load_dwordx4 v[104:107], v37, s[92:95], s3 offen sc1
buffer_load_dwordx4 v[108:111], v23, s[92:95], s3 offen sc1
s_add_u32 s3, s3, 46080
buffer_load_dwordx4 v[112:115], v37, s[92:95], s3 offen sc1
buffer_load_dwordx4 v[116:119], v23, s[92:95], s3 offen sc1
s_add_u32 s3, s3, 46080
buffer_load_dwordx4 v[120:123], v37, s[92:95], s3 offen sc1
buffer_load_dwordx4 v[124:127], v23, s[92:95], s3 offen sc1
s_add_u32 s3, s3, 46080
buffer_load_dwordx4 v[128:131], v37, s[92:95], s3 offen sc1
buffer_load_dwordx4 v[132:135], v23, s[92:95], s3 offen sc1
s_add_u32 s56, s56, 9216
s_and_b32 s3, s2, 1
s_lshl_b32 s3, s3, 2
s_add_u32 s3, s3, s29
s_mul_i32 s3, s3, 6
s_lshl_b32 s41, s3, 10
s_add_u32 s41, s41, 19660800
s_add_u32 s3, s3, 1368
v_min_u32 v14, 5, v24
v_add_lshl_u32 v14, v14, s3, 7
s_mul_i32 s43, s29, 6144
s_add_u32 m0, s43, 110592
s_mov_b32 s63, 60000
Lp_58:
buffer_load_dwordx2 v[16:17], v14, s[96:99], 0 offen sc1
s_waitcnt vmcnt(0)
v_cmp_ne_u64 vcc, s[100:101], v[16:17]
s_sub_u32 s63, s63, 1
s_cbranch_scc1 Lx_59
s_nop 2
s_cbranch_vccz Lx_59
s_mov_b64 exec, vcc
s_sleep 4
s_branch Lp_58
Lx_59:
s_mov_b64 exec, -1
buffer_load_dwordx4 v20, s[36:39], s41 offen offset:0 sc1 lds
buffer_load_dwordx4 v20, s[36:39], s41 offen offset:1024 sc1 lds
buffer_load_dwordx4 v20, s[36:39], s41 offen offset:2048 sc1 lds
buffer_load_dwordx4 v20, s[36:39], s41 offen offset:3072 sc1 lds
s_add_u32 m0, s43, 114688
s_nop 0
buffer_load_dwordx4 v21, s[36:39], s41 offen offset:0 sc1 lds
s_bitcmp1_b32 s29, 0
s_cselect_b64 exec, 0xffff, -1
buffer_load_dwordx4 v21, s[36:39], s41 offen offset:1024 sc1 lds
s_mov_b64 exec, -1
s_waitcnt vmcnt(0)
Lg_57:
s_barrier
s_cmp_lt_u32 s2, 144
s_cbranch_scc1 Lg_60
s_sub_u32 s3, s2, 208
s_cmp_lt_u32 s3, 32
s_cbranch_scc1 Lg_60
s_sub_u32 s3, s16, 4
s_lshl_b32 s3, s3, 10
s_add_u32 m0, s3, 147456
s_mov_b32 s3, s56
buffer_load_dwordx4 v33, s[92:95], s56 offen sc1 lds
buffer_load_dwordx4 v[40:43], v37, s[92:95], s3 offen sc1
buffer_load_dwordx4 v[44:47], v23, s[92:95], s3 offen sc1
s_add_u32 s3, s3, 46080
buffer_load_dwordx4 v[48:51], v37, s[92:95], s3 offen sc1
buffer_load_dwordx4 v[52:55], v23, s[92:95], s3 offen sc1
s_add_u32 s3, s3, 46080
buffer_load_dwordx4 v[56:59], v37, s[92:95], s3 offen sc1
buffer_load_dwordx4 v[60:63], v23, s[92:95], s3 offen sc1
s_add_u32 s3, s3, 46080
buffer_load_dwordx4 v[64:67], v37, s[92:95], s3 offen sc1
buffer_load_dwordx4 v[68:71], v23, s[92:95], s3 offen sc1
s_add_u32 s56, s56, 9216
s_sub_u32 s3, s16, 4
s_lshl_b32 s3, s3, 10
s_add_u32 m0, s3, 151552
s_mov_b32 s3, s56
buffer_load_dwordx4 v33, s[92:95], s56 offen sc1 lds
buffer_load_dwordx4 v[72:75], v37, s[92:95], s3 offen sc1
buffer_load_dwordx4 v[76:79], v23, s[92:95], s3 offen sc1
s_add_u32 s3, s3, 46080
buffer_load_dwordx4 v[80:83], v37, s[92:95], s3 offen sc1
buffer_load_dwordx4 v[84:87], v23, s[92:95], s3 offen sc1
s_add_u32 s3, s3, 46080
buffer_load_dwordx4 v[88:91], v37, s[92:95], s3 offen sc1
buffer_load_dwordx4 v[92:95], v23, s[92:95], s3 offen sc1
s_add_u32 s3, s3, 46080
buffer_load_dwordx4 v[96:99], v37, s[92:95], s3 offen sc1
buffer_load_dwordx4 v[100:103], v23, s[92:95], s3 offen sc1
s_add_u32 s56, s56, 9216
s_sub_u32 s3, s16, 4
s_lshl_b32 s3, s3, 10
s_add_u32 m0, s3, 155648
s_mov_b32 s3, s56
buffer_load_dwordx4 v33, s[92:95], s56 offen sc1 lds
buffer_load_dwordx4 v[104:107], v37, s[92:95], s3 offen sc1
buffer_load_dwordx4 v[108:111], v23, s[92:95], s3 offen sc1
s_add_u32 s3, s3, 46080
buffer_load_dwordx4 v[112:115], v37, s[92:95], s3 offen sc1
buffer_load_dwordx4 v[116:119], v23, s[92:95], s3 offen sc1
s_add_u32 s3, s3, 46080
buffer_load_dwordx4 v[120:123], v37, s[92:95], s3 offen sc1
buffer_load_dwordx4 v[124:127], v23, s[92:95], s3 offen sc1
s_add_u32 s3, s3, 46080
buffer_load_dwordx4 v[128:131], v37, s[92:95], s3 offen sc1
buffer_load_dwordx4 v[132:135], v23, s[92:95], s3 offen sc1
s_add_u32 s56, s56, 9216
s_waitcnt vmcnt(0)
Lg_60:
s_mov_b64 exec, 1
s_mov_b32 s63, 60000
Lp_62:
buffer_load_dwordx2 v[10:11], v8, s[96:99], 0 offen sc1
s_waitcnt vmcnt(0)
v_cmp_ne_u64 vcc, s[100:101], v[10:11]
s_sub_u32 s63, s63, 1
s_cbranch_scc1 Lx_63
s_nop 2
s_cbranch_vccz Lx_63
s_mov_b64 exec, vcc
s_sleep 8
s_branch Lp_62
Lx_63:
s_mov_b64 exec, -1
Ls_61:
s_mov_b32 s63, 60000
Lp_64:
buffer_load_dwordx2 v[10:11], v8, s[96:99], 0 offen sc1
s_waitcnt vmcnt(0)
v_cmp_ne_u64 vcc, s[100:101], v[10:11]
s_sub_u32 s63, s63, 1
s_cbranch_scc1 Lx_65
s_nop 2
s_cbranch_vccz Lx_65
s_mov_b64 exec, vcc
s_sleep 1
s_branch Lp_64
Lx_65:
s_mov_b64 exec, -1
s_add_u32 m0, s18, 0
s_nop 0
buffer_load_dwordx4 v2, s[8:11], s21 offen offset:0 sc1 lds
buffer_load_dwordx4 v2, s[8:11], s21 offen offset:1024 sc1 lds
buffer_load_dwordx4 v2, s[8:11], s21 offen offset:2048 sc1 lds
buffer_load_dwordx4 v2, s[8:11], s21 offen offset:3072 sc1 lds
s_add_u32 m0, s18, 4096
s_nop 0
buffer_load_dwordx4 v3, s[8:11], s21 offen offset:0 sc1 lds
buffer_load_dwordx4 v3, s[8:11], s21 offen offset:1024 sc1 lds
buffer_load_dwordx4 v3, s[8:11], s21 offen offset:2048 sc1 lds
buffer_load_dwordx4 v3, s[8:11], s21 offen offset:3072 sc1 lds
s_add_u32 m0, s18, 8192
s_nop 0
buffer_load_dwordx4 v4, s[8:11], s21 offen offset:0 sc1 lds
s_add_u32 s59, s59, 1
s_sub_u32 s60, s60, 1
s_cmp_eq_u32 s60, 0
s_cselect_b32 s62, s58, 0
s_cselect_b32 s60, s58, s60
s_sub_u32 s59, s59, s62
s_sub_u32 s61, s61, 1
s_cmp_eq_u32 s61, 0
s_cselect_b32 s62, s58, 0
s_cselect_b32 s61, s58, s61
s_add_u32 s59, s59, s62
s_cmp_ge_u32 s59, s57
s_cselect_b32 s62, 2, 0
s_add_u32 s62, s62, s59
s_mul_i32 s62, s62, s19
s_add_u32 s21, s35, s62
s_add_u32 m0, s18, 36864
s_nop 0
buffer_load_dwordx4 v2, s[8:11], s21 offen offset:0 sc1 lds
buffer_load_dwordx4 v2, s[8:11], s21 offen offset:1024 sc1 lds
buffer_load_dwordx4 v2, s[8:11], s21 offen offset:2048 sc1 lds
buffer_load_dwordx4 v2, s[8:11], s21 offen offset:3072 sc1 lds
s_add_u32 m0, s18, 40960
s_nop 0
buffer_load_dwordx4 v3, s[8:11], s21 offen offset:0 sc1 lds
buffer_load_dwordx4 v3, s[8:11], s21 offen offset:1024 sc1 lds
buffer_load_dwordx4 v3, s[8:11], s21 offen offset:2048 sc1 lds
buffer_load_dwordx4 v3, s[8:11], s21 offen offset:3072 sc1 lds
s_add_u32 m0, s18, 45056
s_nop 0
buffer_load_dwordx4 v4, s[8:11], s21 offen offset:0 sc1 lds
s_add_u32 s59, s59, 1
s_sub_u32 s60, s60, 1
s_cmp_eq_u32 s60, 0
s_cselect_b32 s62, s58, 0
s_cselect_b32 s60, s58, s60
s_sub_u32 s59, s59, s62
s_sub_u32 s61, s61, 1
s_cmp_eq_u32 s61, 0
s_cselect_b32 s62, s58, 0
s_cselect_b32 s61, s58, s61
s_add_u32 s59, s59, s62
s_cmp_ge_u32 s59, s57
s_cselect_b32 s62, 2, 0
s_add_u32 s62, s62, s59
s_mul_i32 s62, s62, s19
s_add_u32 s21, s35, s62
s_add_u32 m0, s18, 73728
s_nop 0
buffer_load_dwordx4 v2, s[8:11], s21 offen offset:0 sc1 lds
buffer_load_dwordx4 v2, s[8:11], s21 offen offset:1024 sc1 lds
buffer_load_dwordx4 v2, s[8:11], s21 offen offset:2048 sc1 lds
buffer_load_dwordx4 v2, s[8:11], s21 offen offset:3072 sc1 lds
s_add_u32 m0, s18, 77824
s_nop 0
buffer_load_dwordx4 v3, s[8:11], s21 offen offset:0 sc1 lds
buffer_load_dwordx4 v3, s[8:11], s21 offen offset:1024 sc1 lds
buffer_load_dwordx4 v3, s[8:11], s21 offen offset:2048 sc1 lds
buffer_load_dwordx4 v3, s[8:11], s21 offen offset:3072 sc1 lds
s_add_u32 m0, s18, 81920
s_nop 0
buffer_load_dwordx4 v4, s[8:11], s21 offen offset:0 sc1 lds
s_add_u32 s59, s59, 1
s_sub_u32 s60, s60, 1
s_cmp_eq_u32 s60, 0
s_cselect_b32 s62, s58, 0
s_cselect_b32 s60, s58, s60
s_sub_u32 s59, s59, s62
s_sub_u32 s61, s61, 1
s_cmp_eq_u32 s61, 0
s_cselect_b32 s62, s58, 0
s_cselect_b32 s61, s58, s61
s_add_u32 s59, s59, s62
s_cmp_ge_u32 s59, s57
s_cselect_b32 s62, 2, 0
s_add_u32 s62, s62, s59
s_mul_i32 s62, s62, s19
s_add_u32 s21, s35, s62
Ll_49:
s_waitcnt vmcnt(18)
s_barrier
s_add_u32 m0, s18, 110592
s_nop 0
buffer_load_dwordx4 v2, s[8:11], s21 offen offset:0 sc1 lds
buffer_load_dwordx4 v2, s[8:11], s21 offen offset:1024 sc1 lds
buffer_load_dwordx4 v2, s[8:11], s21 offen offset:2048 sc1 lds
buffer_load_dwordx4 v2, s[8:11], s21 offen offset:3072 sc1 lds
s_add_u32 m0, s18, 114688
s_nop 0
buffer_load_dwordx4 v3, s[8:11], s21 offen offset:0 sc1 lds
buffer_load_dwordx4 v3, s[8:11], s21 offen offset:1024 sc1 lds
buffer_load_dwordx4 v3, s[8:11], s21 offen offset:2048 sc1 lds
buffer_load_dwordx4 v3, s[8:11], s21 offen offset:3072 sc1 lds
s_add_u32 m0, s18, 118784
s_nop 0
buffer_load_dwordx4 v4, s[8:11], s21 offen offset:0 sc1 lds
s_add_u32 s59, s59, 1
s_sub_u32 s60, s60, 1
s_cmp_eq_u32 s60, 0
s_cselect_b32 s62, s58, 0
s_cselect_b32 s60, s58, s60
s_sub_u32 s59, s59, s62
s_sub_u32 s61, s61, 1
s_cmp_eq_u32 s61, 0
s_cselect_b32 s62, s58, 0
s_cselect_b32 s61, s58, s61
s_add_u32 s59, s59, s62
s_cmp_ge_u32 s59, s57
s_cselect_b32 s62, 2, 0
s_add_u32 s62, s62, s59
s_mul_i32 s62, s62, s19
s_add_u32 s21, s35, s62
s_waitcnt vmcnt(18)
s_barrier
s_add_u32 m0, s18, 0
s_nop 0
buffer_load_dwordx4 v2, s[8:11], s21 offen offset:0 sc1 lds
buffer_load_dwordx4 v2, s[8:11], s21 offen offset:1024 sc1 lds
buffer_load_dwordx4 v2, s[8:11], s21 offen offset:2048 sc1 lds
buffer_load_dwordx4 v2, s[8:11], s21 offen offset:3072 sc1 lds
s_add_u32 m0, s18, 4096
s_nop 0
buffer_load_dwordx4 v3, s[8:11], s21 offen offset:0 sc1 lds
buffer_load_dwordx4 v3, s[8:11], s21 offen offset:1024 sc1 lds
buffer_load_dwordx4 v3, s[8:11], s21 offen offset:2048 sc1 lds
buffer_load_dwordx4 v3, s[8:11], s21 offen offset:3072 sc1 lds
s_add_u32 m0, s18, 8192
s_nop 0
buffer_load_dwordx4 v4, s[8:11], s21 offen offset:0 sc1 lds
s_add_u32 s59, s59, 1
s_sub_u32 s60, s60, 1
s_cmp_eq_u32 s60, 0
s_cselect_b32 s62, s58, 0
s_cselect_b32 s60, s58, s60
s_sub_u32 s59, s59, s62
s_sub_u32 s61, s61, 1
s_cmp_eq_u32 s61, 0
s_cselect_b32 s62, s58, 0
s_cselect_b32 s61, s58, s61
s_add_u32 s59, s59, s62
s_cmp_ge_u32 s59, s57
s_cselect_b32 s62, 2, 0
s_add_u32 s62, s62, s59
s_mul_i32 s62, s62, s19
s_add_u32 s21, s35, s62
Ll_49_2:
s_waitcnt vmcnt(18)
s_barrier
s_add_u32 m0, s18, 36864
s_nop 0
buffer_load_dwordx4 v2, s[8:11], s21 offen offset:0 sc1 lds
buffer_load_dwordx4 v2, s[8:11], s21 offen offset:1024 sc1 lds
buffer_load_dwordx4 v2, s[8:11], s21 offen offset:2048 sc1 lds
buffer_load_dwordx4 v2, s[8:11], s21 offen offset:3072 sc1 lds
s_add_u32 m0, s18, 40960
s_nop 0
buffer_load_dwordx4 v3, s[8:11], s21 offen offset:0 sc1 lds
buffer_load_dwordx4 v3, s[8:11], s21 offen offset:1024 sc1 lds
buffer_load_dwordx4 v3, s[8:11], s21 offen offset:2048 sc1 lds
buffer_load_dwordx4 v3, s[8:11], s21 offen offset:3072 sc1 lds
s_add_u32 m0, s18, 45056
s_nop 0
buffer_load_dwordx4 v4, s[8:11], s21 offen offset:0 sc1 lds
s_add_u32 s59, s59, 1
s_sub_u32 s60, s60, 1
s_cmp_eq_u32 s60, 0
s_cselect_b32 s62, s58, 0
s_cselect_b32 s60, s58, s60
s_sub_u32 s59, s59, s62
s_sub_u32 s61, s61, 1
s_cmp_eq_u32 s61, 0
s_cselect_b32 s62, s58, 0
s_cselect_b32 s61, s58, s61
s_add_u32 s59, s59, s62
s_cmp_ge_u32 s59, s57
s_cselect_b32 s62, 2, 0
s_add_u32 s62, s62, s59
s_mul_i32 s62, s62, s19
s_add_u32 s21, s35, s62
Ll_49_3:
s_waitcnt vmcnt(18)
s_barrier
s_add_u32 m0, s18, 73728
s_nop 0
buffer_load_dwordx4 v2, s[8:11], s21 offen offset:0 sc1 lds
buffer_load_dwordx4 v2, s[8:11], s21 offen offset:1024 sc1 lds
buffer_load_dwordx4 v2, s[8:11], s21 offen offset:2048 sc1 lds
buffer_load_dwordx4 v2, s[8:11], s21 offen offset:3072 sc1 lds
s_add_u32 m0, s18, 77824
s_nop 0
buffer_load_dwordx4 v3, s[8:11], s21 offen offset:0 sc1 lds
buffer_load_dwordx4 v3, s[8:11], s21 offen offset:1024 sc1 lds
buffer_load_dwordx4 v3, s[8:11], s21 offen offset:2048 sc1 lds
buffer_load_dwordx4 v3, s[8:11], s21 offen offset:3072 sc1 lds
s_add_u32 m0, s18, 81920
s_nop 0
buffer_load_dwordx4 v4, s[8:11], s21 offen offset:0 sc1 lds
s_add_u32 s59, s59, 1
s_sub_u32 s60, s60, 1
s_cmp_eq_u32 s60, 0
s_cselect_b32 s62, s58, 0
s_cselect_b32 s60, s58, s60
s_sub_u32 s59, s59, s62
s_sub_u32 s61, s61, 1
s_cmp_eq_u32 s61, 0
s_cselect_b32 s62, s58, 0
s_cselect_b32 s61, s58, s61
s_add_u32 s59, s59, s62
s_cmp_ge_u32 s59, s57
s_cselect_b32 s62, 2, 0
s_add_u32 s62, s62, s59
s_mul_i32 s62, s62, s19
s_add_u32 s21, s35, s62
s_cmp_ge_u32 s2, 144
s_cbranch_scc1 Lu_66
s_cmp_lg_u32 s20, 3
s_cbranch_scc1 Lu_67
s_sub_u32 s3, s16, 4
s_lshl_b32 s3, s3, 10
s_add_u32 m0, s3, 155648
s_mov_b32 s3, s56
buffer_load_dwordx4 v33, s[92:95], s56 offen sc1 lds
buffer_load_dwordx4 v[104:107], v37, s[92:95], s3 offen sc1
buffer_load_dwordx4 v[108:111], v23, s[92:95], s3 offen sc1
s_add_u32 s3, s3, 46080
buffer_load_dwordx4 v[112:115], v37, s[92:95], s3 offen sc1
buffer_load_dwordx4 v[116:119], v23, s[92:95], s3 offen sc1
s_add_u32 s3, s3, 46080
buffer_load_dwordx4 v[120:123], v37, s[92:95], s3 offen sc1
buffer_load_dwordx4 v[124:127], v23, s[92:95], s3 offen sc1
s_add_u32 s3, s3, 46080
buffer_load_dwordx4 v[128:131], v37, s[92:95], s3 offen sc1
buffer_load_dwordx4 v[132:135], v23, s[92:95], s3 offen sc1
s_add_u32 s56, s56, 9216
Lu_67:
Lu_66:
s_sub_u32 s20, s20, 1
s_cmp_lg_u32 s20, 0
s_cbranch_scc1 Ll_49
Ll_49_e:
s_waitcnt vmcnt(18)
s_barrier
s_add_u32 m0, s18, 110592
s_nop 0
buffer_load_dwordx4 v2, s[8:11], s21 offen offset:0 sc1 lds
buffer_load_dwordx4 v2, s[8:11], s21 offen offset:1024 sc1 lds
buffer_load_dwordx4 v2, s[8:11], s21 offen offset:2048 sc1 lds
buffer_load_dwordx4 v2, s[8:11], s21 offen offset:3072 sc1 lds
s_add_u32 m0, s18, 114688
s_nop 0
buffer_load_dwordx4 v3, s[8:11], s21 offen offset:0 sc1 lds
buffer_load_dwordx4 v3, s[8:11], s21 offen offset:1024 sc1 lds
buffer_load_dwordx4 v3, s[8:11], s21 offen offset:2048 sc1 lds
buffer_load_dwordx4 v3, s[8:11], s21 offen offset:3072 sc1 lds
s_add_u32 m0, s18, 118784
s_nop 0
buffer_load_dwordx4 v4, s[8:11], s21 offen offset:0 sc1 lds
s_add_u32 s59, s59, 1
s_sub_u32 s60, s60, 1
s_cmp_eq_u32 s60, 0
s_cselect_b32 s62, s58, 0
s_cselect_b32 s60, s58, s60
s_sub_u32 s59, s59, s62
s_sub_u32 s61, s61, 1
s_cmp_eq_u32 s61, 0
s_cselect_b32 s62, s58, 0
s_cselect_b32 s61, s58, s61
s_add_u32 s59, s59, s62
s_cmp_ge_u32 s59, s57
s_cselect_b32 s62, 2, 0
s_add_u32 s62, s62, s59
s_mul_i32 s62, s62, s19
s_add_u32 s21, s35, s62
s_waitcnt vmcnt(18)
s_barrier
s_add_u32 m0, s18, 0
s_nop 0
buffer_load_dwordx4 v2, s[8:11], s21 offen offset:0 sc1 lds
buffer_load_dwordx4 v2, s[8:11], s21 offen offset:1024 sc1 lds
buffer_load_dwordx4 v2, s[8:11], s21 offen offset:2048 sc1 lds
buffer_load_dwordx4 v2, s[8:11], s21 offen offset:3072 sc1 lds
s_add_u32 m0, s18, 4096
s_nop 0
buffer_load_dwordx4 v3, s[8:11], s21 offen offset:0 sc1 lds
buffer_load_dwordx4 v3, s[8:11], s21 offen offset:1024 sc1 lds
buffer_load_dwordx4 v3, s[8:11], s21 offen offset:2048 sc1 lds
buffer_load_dwordx4 v3, s[8:11], s21 offen offset:3072 sc1 lds
s_add_u32 m0, s18, 8192
s_nop 0
buffer_load_dwordx4 v4, s[8:11], s21 offen offset:0 sc1 lds
s_add_u32 s59, s59, 1
s_sub_u32 s60, s60, 1
s_cmp_eq_u32 s60, 0
s_cselect_b32 s62, s58, 0
s_cselect_b32 s60, s58, s60
s_sub_u32 s59, s59, s62
s_sub_u32 s61, s61, 1
s_cmp_eq_u32 s61, 0
s_cselect_b32 s62, s58, 0
s_cselect_b32 s61, s58, s61
s_add_u32 s59, s59, s62
s_cmp_ge_u32 s59, s57
s_cselect_b32 s62, 2, 0
s_add_u32 s62, s62, s59
s_mul_i32 s62, s62, s19
s_add_u32 s21, s35, s62
s_load_dwordx2 s[42:43], s[96:97], s48
s_waitcnt vmcnt(18)
s_barrier
s_add_u32 m0, s18, 36864
s_nop 0
buffer_load_dwordx4 v2, s[8:11], s21 offen offset:0 sc1 lds
buffer_load_dwordx4 v2, s[8:11], s21 offen offset:1024 sc1 lds
buffer_load_dwordx4 v2, s[8:11], s21 offen offset:2048 sc1 lds
buffer_load_dwordx4 v2, s[8:11], s21 offen offset:3072 sc1 lds
s_add_u32 m0, s18, 40960
s_nop 0
buffer_load_dwordx4 v3, s[8:11], s21 offen offset:0 sc1 lds
buffer_load_dwordx4 v3, s[8:11], s21 offen offset:1024 sc1 lds
buffer_load_dwordx4 v3, s[8:11], s21 offen offset:2048 sc1 lds
buffer_load_dwordx4 v3, s[8:11], s21 offen offset:3072 sc1 lds
s_add_u32 m0, s18, 45056
s_nop 0
buffer_load_dwordx4 v4, s[8:11], s21 offen offset:0 sc1 lds
s_add_u32 s59, s59, 1
s_sub_u32 s60, s60, 1
s_cmp_eq_u32 s60, 0
s_cselect_b32 s62, s58, 0
s_cselect_b32 s60, s58, s60
s_sub_u32 s59, s59, s62
s_sub_u32 s61, s61, 1
s_cmp_eq_u32 s61, 0
s_cselect_b32 s62, s58, 0
s_cselect_b32 s61, s58, s61
s_add_u32 s59, s59, s62
s_cmp_ge_u32 s59, s57
s_cselect_b32 s62, 2, 0
s_add_u32 s62, s62, s59
s_mul_i32 s62, s62, s19
s_add_u32 s21, s35, s62
s_waitcnt vmcnt(18)
s_barrier
s_waitcnt lgkmcnt(0)
s_cmp_eq_u64 s[42:43], s[100:101]
s_cbranch_scc1 Lt_69
s_mov_b32 s63, 60000
Lp_70:
buffer_load_dwordx2 v[30:31], v28, s[96:99], 0 offen sc1
s_waitcnt vmcnt(0)
v_cmp_ne_u64 vcc, s[100:101], v[30:31]
s_sub_u32 s63, s63, 1
s_cbranch_scc1 Lx_71
s_nop 2
s_cbranch_vccz Lx_71
s_mov_b64 exec, vcc
s_branch Lp_70
Lx_71:
s_mov_b64 exec, -1
Lt_69:
s_add_u32 m0, s34, 73728
s_nop 0
buffer_load_dwordx4 v20, s[36:39], s33 offen offset:0 sc1 lds
buffer_load_dwordx4 v20, s[36:39], s33 offen offset:1024 sc1 lds
buffer_load_dwordx4 v20, s[36:39], s33 offen offset:2048 sc1 lds
buffer_load_dwordx4 v20, s[36:39], s33 offen offset:3072 sc1 lds
s_add_u32 m0, s34, 77824
s_nop 0
buffer_load_dwordx4 v21, s[36:39], s33 offen offset:0 sc1 lds
buffer_load_dwordx4 v21, s[36:39], s33 offen offset:1024 sc1 lds
buffer_load_dwordx4 v21, s[36:39], s33 offen offset:2048 sc1 lds
buffer_load_dwordx4 v21, s[36:39], s33 offen offset:3072 sc1 lds
s_add_u32 m0, s34, 81920
s_nop 0
buffer_load_dwordx4 v22, s[36:39], s33 offen offset:0 sc1 lds
s_lshl_b32 s3, s29, 10
s_add_u32 m0, s3, 158720
s_nop 0
buffer_load_dwordx4 v22, s[36:39], s33 offen offset:1024 sc1 lds
s_waitcnt vmcnt(19)
s_barrier
s_add_u32 m0, s34, 110592
s_nop 0
buffer_load_dwordx4 v20, s[36:39], s32 offen offset:0 sc1 lds
buffer_load_dwordx4 v20, s[36:39], s32 offen offset:1024 sc1 lds
buffer_load_dwordx4 v20, s[36:39], s32 offen offset:2048 sc1 lds
buffer_load_dwordx4 v20, s[36:39], s32 offen offset:3072 sc1 lds
s_add_u32 m0, s34, 114688
s_nop 0
buffer_load_dwordx4 v21, s[36:39], s32 offen offset:0 sc1 lds
buffer_load_dwordx4 v21, s[36:39], s32 offen offset:1024 sc1 lds
buffer_load_dwordx4 v21, s[36:39], s32 offen offset:2048 sc1 lds
buffer_load_dwordx4 v21, s[36:39], s32 offen offset:3072 sc1 lds
s_add_u32 m0, s34, 118784
s_nop 0
buffer_load_dwordx4 v22, s[36:39], s32 offen offset:0 sc1 lds
s_add_u32 s32, s32, 9216
s_waitcnt vmcnt(19)
s_barrier
s_add_u32 m0, s34, 0
s_nop 0
buffer_load_dwordx4 v20, s[36:39], s32 offen offset:0 sc1 lds
buffer_load_dwordx4 v20, s[36:39], s32 offen offset:1024 sc1 lds
buffer_load_dwordx4 v20, s[36:39], s32 offen offset:2048 sc1 lds
buffer_load_dwordx4 v20, s[36:39], s32 offen offset:3072 sc1 lds
s_add_u32 m0, s34, 4096
s_nop 0
buffer_load_dwordx4 v21, s[36:39], s32 offen offset:0 sc1 lds
buffer_load_dwordx4 v21, s[36:39], s32 offen offset:1024 sc1 lds
buffer_load_dwordx4 v21, s[36:39], s32 offen offset:2048 sc1 lds
buffer_load_dwordx4 v21, s[36:39], s32 offen offset:3072 sc1 lds
s_add_u32 m0, s34, 8192
s_nop 0
buffer_load_dwordx4 v22, s[36:39], s32 offen offset:0 sc1 lds
s_add_u32 s32, s32, 9216
Lz_68:
s_branch K2_rx
K2_ldW:
s_mov_b32 s12, s4
s_mov_b32 s13, s5
s_mov_b32 s14, 18874368
s_mov_b32 s15, 0x20000
s_sub_u32 s17, s16, 6
s_mul_i32 s21, s28, 4718592
s_lshl_b32 s18, s23, 8
s_add_u32 s21, s21, s18
s_cmp_lt_u32 s2, 144
s_cbranch_scc1 K2_nob
s_sub_u32 s3, s2, 208
s_cmp_lt_u32 s3, 32
s_cbranch_scc1 K2_nob
s_barrier
K2_nob:
s_mov_b32 s35, s21
s_sub_u32 s60, s58, s59
s_mov_b32 s61, s58
s_mov_b32 s19, 262144
s_bitcmp1_b32 s2, 0
s_cselect_b32 s62, 4456448, 0
s_cselect_b32 s19, -262144, s19
s_add_u32 s35, s35, s62
s_cmp_ge_u32 s59, s57
s_cselect_b32 s62, 2, 0
s_add_u32 s62, s62, s59
s_mul_i32 s62, s62, s19
s_add_u32 s21, s35, s62
v_and_b32 v1, 63, v0
v_lshrrev_b32 v10, 4, v1
v_and_b32 v11, 15, v1
s_lshl_b32 s18, s17, 5
v_add_u32 v12, s18, v10
s_mov_b32 s3, 4096
v_mul_lo_u32 v12, v12, s3
v_or_b32 v13, 0, v10
v_lshlrev_b32 v13, 1, v13
v_xor_b32 v13, v13, v11
v_lshl_add_u32 v13, v13, 4, v12
v_add_u32 v2, 0, v13
v_add_u32 v4, 30720, v13
v_add_u32 v6, 65536, v13
v_add_u32 v8, 96256, v13
v_or_b32 v13, 4, v10
v_lshlrev_b32 v13, 1, v13
v_xor_b32 v13, v13, v11
v_lshl_add_u32 v13, v13, 4, v12
v_add_u32 v3, 15360, v13
v_add_u32 v5, 46080, v13
v_add_u32 v7, 80896, v13
v_add_u32 v9, 111616, v13
s_lshl_b32 s18, s17, 13
s_mov_b32 s20, 3
s_cmp_ge_u32 s2, 144
s_cbranch_scc1 K2_wn
s_mov_b32 s25, s21
s_mul_i32 s21, s24, 524288
s_lshl_b32 s3, s23, 8
s_add_u32 s21, s21, s3
s_mov_b32 s21, s25
s_waitcnt vmcnt(0)
s_barrier
s_mov_b32 s40, s6
s_mov_b32 s41, s7
s_mov_b32 s42, 4096
s_mov_b32 s43, 0x20000
buffer_load_dwordx4 v[248:251], v244, s[44:47], s50 offen
buffer_load_ushort v247, v242, s[40:43], s51 offen
s_cmp_lg_u32 s16, 7
s_cbranch_scc1 Lxl_73
buffer_load_dwordx4 v[236:239], v232, s[44:47], s50 offen
buffer_load_ushort v235, v243, s[40:43], s51 offen
Lxl_73:
s_add_u32 m0, s18, 92160
s_nop 0
buffer_load_dwordx4 v2, s[12:15], s21 offen offset:0  lds
buffer_load_dwordx4 v3, s[12:15], s21 offen offset:1024  lds
buffer_load_dwordx4 v4, s[12:15], s21 offen offset:2048  lds
buffer_load_dwordx4 v5, s[12:15], s21 offen offset:3072  lds
s_add_u32 m0, s18, 96256
s_nop 0
buffer_load_dwordx4 v6, s[12:15], s21 offen offset:0  lds
buffer_load_dwordx4 v7, s[12:15], s21 offen offset:1024  lds
buffer_load_dwordx4 v8, s[12:15], s21 offen offset:2048  lds
buffer_load_dwordx4 v9, s[12:15], s21 offen offset:3072  lds
s_add_u32 s59, s59, 1
s_sub_u32 s60, s60, 1
s_cmp_eq_u32 s60, 0
s_cselect_b32 s62, s58, 0
s_cselect_b32 s60, s58, s60
s_sub_u32 s59, s59, s62
s_sub_u32 s61, s61, 1
s_cmp_eq_u32 s61, 0
s_cselect_b32 s62, s58, 0
s_cselect_b32 s61, s58, s61
s_add_u32 s59, s59, s62
s_cmp_ge_u32 s59, s57
s_cselect_b32 s62, 2, 0
s_add_u32 s62, s62, s59
s_mul_i32 s62, s62, s19
s_add_u32 s21, s35, s62
s_add_u32 m0, s18, 129024
s_nop 0
buffer_load_dwordx4 v2, s[12:15], s21 offen offset:0  lds
buffer_load_dwordx4 v3, s[12:15], s21 offen offset:1024  lds
buffer_load_dwordx4 v4, s[12:15], s21 offen offset:2048  lds
buffer_load_dwordx4 v5, s[12:15], s21 offen offset:3072  lds
s_add_u32 m0, s18, 133120
s_nop 0
buffer_load_dwordx4 v6, s[12:15], s21 offen offset:0  lds
buffer_load_dwordx4 v7, s[12:15], s21 offen offset:1024  lds
buffer_load_dwordx4 v8, s[12:15], s21 offen offset:2048  lds
buffer_load_dwordx4 v9, s[12:15], s21 offen offset:3072  lds
s_add_u32 s59, s59, 1
s_sub_u32 s60, s60, 1
s_cmp_eq_u32 s60, 0
s_cselect_b32 s62, s58, 0
s_cselect_b32 s60, s58, s60
s_sub_u32 s59, s59, s62
s_sub_u32 s61, s61, 1
s_cmp_eq_u32 s61, 0
s_cselect_b32 s62, s58, 0
s_cselect_b32 s61, s58, s61
s_add_u32 s59, s59, s62
s_cmp_ge_u32 s59, s57
s_cselect_b32 s62, 2, 0
s_add_u32 s62, s62, s59
s_mul_i32 s62, s62, s19
s_add_u32 s21, s35, s62
s_sub_u32 s3, s16, 4
s_lshl_b32 s3, s3, 10
s_add_u32 m0, s3, 151552
s_mov_b32 s3, s56
buffer_load_dwordx4 v33, s[92:95], s56 offen sc1 lds
buffer_load_dwordx4 v[72:75], v37, s[92:95], s3 offen sc1
buffer_load_dwordx4 v[76:79], v23, s[92:95], s3 offen sc1
s_add_u32 s3, s3, 46080
buffer_load_dwordx4 v[80:83], v37, s[92:95], s3 offen sc1
buffer_load_dwordx4 v[84:87], v23, s[92:95], s3 offen sc1
s_add_u32 s3, s3, 46080
buffer_load_dwordx4 v[88:91], v37, s[92:95], s3 offen sc1
buffer_load_dwordx4 v[92:95], v23, s[92:95], s3 offen sc1
s_add_u32 s3, s3, 46080
buffer_load_dwordx4 v[96:99], v37, s[92:95], s3 offen sc1
buffer_load_dwordx4 v[100:103], v23, s[92:95], s3 offen sc1
s_add_u32 s56, s56, 9216
s_waitcnt vmcnt(17)
s_barrier
s_add_u32 m0, s18, 18432
s_nop 0
buffer_load_dwordx4 v2, s[12:15], s21 offen offset:0  lds
buffer_load_dwordx4 v3, s[12:15], s21 offen offset:1024  lds
buffer_load_dwordx4 v4, s[12:15], s21 offen offset:2048  lds
buffer_load_dwordx4 v5, s[12:15], s21 offen offset:3072  lds
s_add_u32 m0, s18, 22528
s_nop 0
buffer_load_dwordx4 v6, s[12:15], s21 offen offset:0  lds
buffer_load_dwordx4 v7, s[12:15], s21 offen offset:1024  lds
buffer_load_dwordx4 v8, s[12:15], s21 offen offset:2048  lds
buffer_load_dwordx4 v9, s[12:15], s21 offen offset:3072  lds
s_add_u32 s59, s59, 1
s_sub_u32 s60, s60, 1
s_cmp_eq_u32 s60, 0
s_cselect_b32 s62, s58, 0
s_cselect_b32 s60, s58, s60
s_sub_u32 s59, s59, s62
s_sub_u32 s61, s61, 1
s_cmp_eq_u32 s61, 0
s_cselect_b32 s62, s58, 0
s_cselect_b32 s61, s58, s61
s_add_u32 s59, s59, s62
s_cmp_ge_u32 s59, s57
s_cselect_b32 s62, 2, 0
s_add_u32 s62, s62, s59
s_mul_i32 s62, s62, s19
s_add_u32 s21, s35, s62
s_add_u32 m0, s18, 55296
s_nop 0
buffer_load_dwordx4 v2, s[12:15], s21 offen offset:0  lds
buffer_load_dwordx4 v3, s[12:15], s21 offen offset:1024  lds
buffer_load_dwordx4 v4, s[12:15], s21 offen offset:2048  lds
buffer_load_dwordx4 v5, s[12:15], s21 offen offset:3072  lds
s_add_u32 m0, s18, 59392
s_nop 0
buffer_load_dwordx4 v6, s[12:15], s21 offen offset:0  lds
buffer_load_dwordx4 v7, s[12:15], s21 offen offset:1024  lds
buffer_load_dwordx4 v8, s[12:15], s21 offen offset:2048  lds
buffer_load_dwordx4 v9, s[12:15], s21 offen offset:3072  lds
s_add_u32 s59, s59, 1
s_sub_u32 s60, s60, 1
s_cmp_eq_u32 s60, 0
s_cselect_b32 s62, s58, 0
s_cselect_b32 s60, s58, s60
s_sub_u32 s59, s59, s62
s_sub_u32 s61, s61, 1
s_cmp_eq_u32 s61, 0
s_cselect_b32 s62, s58, 0
s_cselect_b32 s61, s58, s61
s_add_u32 s59, s59, s62
s_cmp_ge_u32 s59, s57
s_cselect_b32 s62, 2, 0
s_add_u32 s62, s62, s59
s_mul_i32 s62, s62, s19
s_add_u32 s21, s35, s62
s_branch Ll_72_3
K2_wn:
s_mov_b32 s40, s6
s_mov_b32 s41, s7
s_mov_b32 s42, 4096
s_mov_b32 s43, 0x20000
buffer_load_dwordx4 v[248:251], v244, s[44:47], s50 offen
buffer_load_ushort v247, v242, s[40:43], s51 offen
s_cmp_lg_u32 s16, 7
s_cbranch_scc1 Lxl_74
buffer_load_dwordx4 v[236:239], v232, s[44:47], s50 offen
buffer_load_ushort v235, v243, s[40:43], s51 offen
Lxl_74:
s_add_u32 m0, s18, 18432
s_nop 0
buffer_load_dwordx4 v2, s[12:15], s21 offen offset:0  lds
buffer_load_dwordx4 v3, s[12:15], s21 offen offset:1024  lds
buffer_load_dwordx4 v4, s[12:15], s21 offen offset:2048  lds
buffer_load_dwordx4 v5, s[12:15], s21 offen offset:3072  lds
s_add_u32 m0, s18, 22528
s_nop 0
buffer_load_dwordx4 v6, s[12:15], s21 offen offset:0  lds
buffer_load_dwordx4 v7, s[12:15], s21 offen offset:1024  lds
buffer_load_dwordx4 v8, s[12:15], s21 offen offset:2048  lds
buffer_load_dwordx4 v9, s[12:15], s21 offen offset:3072  lds
s_add_u32 s59, s59, 1
s_sub_u32 s60, s60, 1
s_cmp_eq_u32 s60, 0
s_cselect_b32 s62, s58, 0
s_cselect_b32 s60, s58, s60
s_sub_u32 s59, s59, s62
s_sub_u32 s61, s61, 1
s_cmp_eq_u32 s61, 0
s_cselect_b32 s62, s58, 0
s_cselect_b32 s61, s58, s61
s_add_u32 s59, s59, s62
s_cmp_ge_u32 s59, s57
s_cselect_b32 s62, 2, 0
s_add_u32 s62, s62, s59
s_mul_i32 s62, s62, s19
s_add_u32 s21, s35, s62
s_add_u32 m0, s18, 55296
s_nop 0
buffer_load_dwordx4 v2, s[12:15], s21 offen offset:0  lds
buffer_load_dwordx4 v3, s[12:15], s21 offen offset:1024  lds
buffer_load_dwordx4 v4, s[12:15], s21 offen offset:2048  lds
buffer_load_dwordx4 v5, s[12:15], s21 offen offset:3072  lds
s_add_u32 m0, s18, 59392
s_nop 0
buffer_load_dwordx4 v6, s[12:15], s21 offen offset:0  lds
buffer_load_dwordx4 v7, s[12:15], s21 offen offset:1024  lds
buffer_load_dwordx4 v8, s[12:15], s21 offen offset:2048  lds
buffer_load_dwordx4 v9, s[12:15], s21 offen offset:3072  lds
s_add_u32 s59, s59, 1
s_sub_u32 s60, s60, 1
s_cmp_eq_u32 s60, 0
s_cselect_b32 s62, s58, 0
s_cselect_b32 s60, s58, s60
s_sub_u32 s59, s59, s62
s_sub_u32 s61, s61, 1
s_cmp_eq_u32 s61, 0
s_cselect_b32 s62, s58, 0
s_cselect_b32 s61, s58, s61
s_add_u32 s59, s59, s62
s_cmp_ge_u32 s59, s57
s_cselect_b32 s62, 2, 0
s_add_u32 s62, s62, s59
s_mul_i32 s62, s62, s19
s_add_u32 s21, s35, s62
s_add_u32 m0, s18, 92160
s_nop 0
buffer_load_dwordx4 v2, s[12:15], s21 offen offset:0  lds
buffer_load_dwordx4 v3, s[12:15], s21 offen offset:1024  lds
buffer_load_dwordx4 v4, s[12:15], s21 offen offset:2048  lds
buffer_load_dwordx4 v5, s[12:15], s21 offen offset:3072  lds
s_add_u32 m0, s18, 96256
s_nop 0
buffer_load_dwordx4 v6, s[12:15], s21 offen offset:0  lds
buffer_load_dwordx4 v7, s[12:15], s21 offen offset:1024  lds
buffer_load_dwordx4 v8, s[12:15], s21 offen offset:2048  lds
buffer_load_dwordx4 v9, s[12:15], s21 offen offset:3072  lds
s_add_u32 s59, s59, 1
s_sub_u32 s60, s60, 1
s_cmp_eq_u32 s60, 0
s_cselect_b32 s62, s58, 0
s_cselect_b32 s60, s58, s60
s_sub_u32 s59, s59, s62
s_sub_u32 s61, s61, 1
s_cmp_eq_u32 s61, 0
s_cselect_b32 s62, s58, 0
s_cselect_b32 s61, s58, s61
s_add_u32 s59, s59, s62
s_cmp_ge_u32 s59, s57
s_cselect_b32 s62, 2, 0
s_add_u32 s62, s62, s59
s_mul_i32 s62, s62, s19
s_add_u32 s21, s35, s62
s_sub_u32 s3, s2, 208
s_cmp_ge_u32 s3, 32
s_cbranch_scc1 Lg_75
s_sub_u32 s3, s16, 4
s_lshl_b32 s3, s3, 10
s_add_u32 m0, s3, 147456
s_mov_b32 s3, s56
buffer_load_dwordx4 v33, s[92:95], s56 offen sc1 lds
buffer_load_dwordx4 v[40:43], v37, s[92:95], s3 offen sc1
buffer_load_dwordx4 v[44:47], v23, s[92:95], s3 offen sc1
s_add_u32 s3, s3, 46080
buffer_load_dwordx4 v[48:51], v37, s[92:95], s3 offen sc1
buffer_load_dwordx4 v[52:55], v23, s[92:95], s3 offen sc1
s_add_u32 s3, s3, 46080
buffer_load_dwordx4 v[56:59], v37, s[92:95], s3 offen sc1
buffer_load_dwordx4 v[60:63], v23, s[92:95], s3 offen sc1
s_add_u32 s3, s3, 46080
buffer_load_dwordx4 v[64:67], v37, s[92:95], s3 offen sc1
buffer_load_dwordx4 v[68:71], v23, s[92:95], s3 offen sc1
s_add_u32 s56, s56, 9216
s_sub_u32 s3, s16, 4
s_lshl_b32 s3, s3, 10
s_add_u32 m0, s3, 151552
s_mov_b32 s3, s56
buffer_load_dwordx4 v33, s[92:95], s56 offen sc1 lds
buffer_load_dwordx4 v[72:75], v37, s[92:95], s3 offen sc1
buffer_load_dwordx4 v[76:79], v23, s[92:95], s3 offen sc1
s_add_u32 s3, s3, 46080
buffer_load_dwordx4 v[80:83], v37, s[92:95], s3 offen sc1
buffer_load_dwordx4 v[84:87], v23, s[92:95], s3 offen sc1
s_add_u32 s3, s3, 46080
buffer_load_dwordx4 v[88:91], v37, s[92:95], s3 offen sc1
buffer_load_dwordx4 v[92:95], v23, s[92:95], s3 offen sc1
s_add_u32 s3, s3, 46080
buffer_load_dwordx4 v[96:99], v37, s[92:95], s3 offen sc1
buffer_load_dwordx4 v[100:103], v23, s[92:95], s3 offen sc1
s_add_u32 s56, s56, 9216
s_sub_u32 s3, s16, 4
s_lshl_b32 s3, s3, 10
s_add_u32 m0, s3, 155648
s_mov_b32 s3, s56
buffer_load_dwordx4 v33, s[92:95], s56 offen sc1 lds
buffer_load_dwordx4 v[104:107], v37, s[92:95], s3 offen sc1
buffer_load_dwordx4 v[108:111], v23, s[92:95], s3 offen sc1
s_add_u32 s3, s3, 46080
buffer_load_dwordx4 v[112:115], v37, s[92:95], s3 offen sc1
buffer_load_dwordx4 v[116:119], v23, s[92:95], s3 offen sc1
s_add_u32 s3, s3, 46080
buffer_load_dwordx4 v[120:123], v37, s[92:95], s3 offen sc1
buffer_load_dwordx4 v[124:127], v23, s[92:95], s3 offen sc1
s_add_u32 s3, s3, 46080
buffer_load_dwordx4 v[128:131], v37, s[92:95], s3 offen sc1
buffer_load_dwordx4 v[132:135], v23, s[92:95], s3 offen sc1
s_add_u32 s56, s56, 9216
s_and_b32 s3, s2, 1
s_lshl_b32 s3, s3, 2
s_add_u32 s3, s3, s29
s_mul_i32 s3, s3, 6
s_lshl_b32 s41, s3, 10
s_add_u32 s41, s41, 19660800
s_add_u32 s3, s3, 1368
v_min_u32 v14, 5, v24
v_add_lshl_u32 v14, v14, s3, 7
s_mul_i32 s43, s29, 6144
s_add_u32 m0, s43, 110592
s_mov_b32 s63, 60000
Lp_76:
buffer_load_dwordx2 v[16:17], v14, s[96:99], 0 offen sc1
s_waitcnt vmcnt(0)
v_cmp_ne_u64 vcc, s[100:101], v[16:17]
s_sub_u32 s63, s63, 1
s_cbranch_scc1 Lx_77
s_nop 2
s_cbranch_vccz Lx_77
s_mov_b64 exec, vcc
s_sleep 4
s_branch Lp_76
Lx_77:
s_mov_b64 exec, -1
buffer_load_dwordx4 v20, s[36:39], s41 offen offset:0 sc1 lds
buffer_load_dwordx4 v20, s[36:39], s41 offen offset:1024 sc1 lds
buffer_load_dwordx4 v20, s[36:39], s41 offen offset:2048 sc1 lds
buffer_load_dwordx4 v20, s[36:39], s41 offen offset:3072 sc1 lds
s_add_u32 m0, s43, 114688
s_nop 0
buffer_load_dwordx4 v21, s[36:39], s41 offen offset:0 sc1 lds
s_bitcmp1_b32 s29, 0
s_cselect_b64 exec, 0xffff, -1
buffer_load_dwordx4 v21, s[36:39], s41 offen offset:1024 sc1 lds
s_mov_b64 exec, -1
s_waitcnt vmcnt(0)
s_barrier
Lg_75:
s_cmp_lt_u32 s2, 144
s_cbranch_scc1 Lg_78
s_sub_u32 s3, s2, 208
s_cmp_lt_u32 s3, 32
s_cbranch_scc1 Lg_78
s_sub_u32 s3, s16, 4
s_lshl_b32 s3, s3, 10
s_add_u32 m0, s3, 147456
s_mov_b32 s3, s56
buffer_load_dwordx4 v33, s[92:95], s56 offen sc1 lds
buffer_load_dwordx4 v[40:43], v37, s[92:95], s3 offen sc1
buffer_load_dwordx4 v[44:47], v23, s[92:95], s3 offen sc1
s_add_u32 s3, s3, 46080
buffer_load_dwordx4 v[48:51], v37, s[92:95], s3 offen sc1
buffer_load_dwordx4 v[52:55], v23, s[92:95], s3 offen sc1
s_add_u32 s3, s3, 46080
buffer_load_dwordx4 v[56:59], v37, s[92:95], s3 offen sc1
buffer_load_dwordx4 v[60:63], v23, s[92:95], s3 offen sc1
s_add_u32 s3, s3, 46080
buffer_load_dwordx4 v[64:67], v37, s[92:95], s3 offen sc1
buffer_load_dwordx4 v[68:71], v23, s[92:95], s3 offen sc1
s_add_u32 s56, s56, 9216
s_sub_u32 s3, s16, 4
s_lshl_b32 s3, s3, 10
s_add_u32 m0, s3, 151552
s_mov_b32 s3, s56
buffer_load_dwordx4 v33, s[92:95], s56 offen sc1 lds
buffer_load_dwordx4 v[72:75], v37, s[92:95], s3 offen sc1
buffer_load_dwordx4 v[76:79], v23, s[92:95], s3 offen sc1
s_add_u32 s3, s3, 46080
buffer_load_dwordx4 v[80:83], v37, s[92:95], s3 offen sc1
buffer_load_dwordx4 v[84:87], v23, s[92:95], s3 offen sc1
s_add_u32 s3, s3, 46080
buffer_load_dwordx4 v[88:91], v37, s[92:95], s3 offen sc1
buffer_load_dwordx4 v[92:95], v23, s[92:95], s3 offen sc1
s_add_u32 s3, s3, 46080
buffer_load_dwordx4 v[96:99], v37, s[92:95], s3 offen sc1
buffer_load_dwordx4 v[100:103], v23, s[92:95], s3 offen sc1
s_add_u32 s56, s56, 9216
s_sub_u32 s3, s16, 4
s_lshl_b32 s3, s3, 10
s_add_u32 m0, s3, 155648
s_mov_b32 s3, s56
buffer_load_dwordx4 v33, s[92:95], s56 offen sc1 lds
buffer_load_dwordx4 v[104:107], v37, s[92:95], s3 offen sc1
buffer_load_dwordx4 v[108:111], v23, s[92:95], s3 offen sc1
s_add_u32 s3, s3, 46080
buffer_load_dwordx4 v[112:115], v37, s[92:95], s3 offen sc1
buffer_load_dwordx4 v[116:119], v23, s[92:95], s3 offen sc1
s_add_u32 s3, s3, 46080
buffer_load_dwordx4 v[120:123], v37, s[92:95], s3 offen sc1
buffer_load_dwordx4 v[124:127], v23, s[92:95], s3 offen sc1
s_add_u32 s3, s3, 46080
buffer_load_dwordx4 v[128:131], v37, s[92:95], s3 offen sc1
buffer_load_dwordx4 v[132:135], v23, s[92:95], s3 offen sc1
s_add_u32 s56, s56, 9216
s_waitcnt vmcnt(0)
Lg_78:
Ll_72:
s_waitcnt vmcnt(16)
s_barrier
s_add_u32 m0, s18, 129024
s_nop 0
buffer_load_dwordx4 v2, s[12:15], s21 offen offset:0  lds
buffer_load_dwordx4 v3, s[12:15], s21 offen offset:1024  lds
buffer_load_dwordx4 v4, s[12:15], s21 offen offset:2048  lds
buffer_load_dwordx4 v5, s[12:15], s21 offen offset:3072  lds
s_add_u32 m0, s18, 133120
s_nop 0
buffer_load_dwordx4 v6, s[12:15], s21 offen offset:0  lds
buffer_load_dwordx4 v7, s[12:15], s21 offen offset:1024  lds
buffer_load_dwordx4 v8, s[12:15], s21 offen offset:2048  lds
buffer_load_dwordx4 v9, s[12:15], s21 offen offset:3072  lds
s_add_u32 s59, s59, 1
s_sub_u32 s60, s60, 1
s_cmp_eq_u32 s60, 0
s_cselect_b32 s62, s58, 0
s_cselect_b32 s60, s58, s60
s_sub_u32 s59, s59, s62
s_sub_u32 s61, s61, 1
s_cmp_eq_u32 s61, 0
s_cselect_b32 s62, s58, 0
s_cselect_b32 s61, s58, s61
s_add_u32 s59, s59, s62
s_cmp_ge_u32 s59, s57
s_cselect_b32 s62, 2, 0
s_add_u32 s62, s62, s59
s_mul_i32 s62, s62, s19
s_add_u32 s21, s35, s62
s_waitcnt vmcnt(16)
s_barrier
s_add_u32 m0, s18, 18432
s_nop 0
buffer_load_dwordx4 v2, s[12:15], s21 offen offset:0  lds
buffer_load_dwordx4 v3, s[12:15], s21 offen offset:1024  lds
buffer_load_dwordx4 v4, s[12:15], s21 offen offset:2048  lds
buffer_load_dwordx4 v5, s[12:15], s21 offen offset:3072  lds
s_add_u32 m0, s18, 22528
s_nop 0
buffer_load_dwordx4 v6, s[12:15], s21 offen offset:0  lds
buffer_load_dwordx4 v7, s[12:15], s21 offen offset:1024  lds
buffer_load_dwordx4 v8, s[12:15], s21 offen offset:2048  lds
buffer_load_dwordx4 v9, s[12:15], s21 offen offset:3072  lds
s_add_u32 s59, s59, 1
s_sub_u32 s60, s60, 1
s_cmp_eq_u32 s60, 0
s_cselect_b32 s62, s58, 0
s_cselect_b32 s60, s58, s60
s_sub_u32 s59, s59, s62
s_sub_u32 s61, s61, 1
s_cmp_eq_u32 s61, 0
s_cselect_b32 s62, s58, 0
s_cselect_b32 s61, s58, s61
s_add_u32 s59, s59, s62
s_cmp_ge_u32 s59, s57
s_cselect_b32 s62, 2, 0
s_add_u32 s62, s62, s59
s_mul_i32 s62, s62, s19
s_add_u32 s21, s35, s62
Ll_72_2:
s_waitcnt vmcnt(16)
s_barrier
s_add_u32 m0, s18, 55296
s_nop 0
buffer_load_dwordx4 v2, s[12:15], s21 offen offset:0  lds
buffer_load_dwordx4 v3, s[12:15], s21 offen offset:1024  lds
buffer_load_dwordx4 v4, s[12:15], s21 offen offset:2048  lds
buffer_load_dwordx4 v5, s[12:15], s21 offen offset:3072  lds
s_add_u32 m0, s18, 59392
s_nop 0
buffer_load_dwordx4 v6, s[12:15], s21 offen offset:0  lds
buffer_load_dwordx4 v7, s[12:15], s21 offen offset:1024  lds
buffer_load_dwordx4 v8, s[12:15], s21 offen offset:2048  lds
buffer_load_dwordx4 v9, s[12:15], s21 offen offset:3072  lds
s_add_u32 s59, s59, 1
s_sub_u32 s60, s60, 1
s_cmp_eq_u32 s60, 0
s_cselect_b32 s62, s58, 0
s_cselect_b32 s60, s58, s60
s_sub_u32 s59, s59, s62
s_sub_u32 s61, s61, 1
s_cmp_eq_u32 s61, 0
s_cselect_b32 s62, s58, 0
s_cselect_b32 s61, s58, s61
s_add_u32 s59, s59, s62
s_cmp_ge_u32 s59, s57
s_cselect_b32 s62, 2, 0
s_add_u32 s62, s62, s59
s_mul_i32 s62, s62, s19
s_add_u32 s21, s35, s62
Ll_72_3:
s_waitcnt vmcnt(16)
s_barrier
s_add_u32 m0, s18, 92160
s_nop 0
buffer_load_dwordx4 v2, s[12:15], s21 offen offset:0  lds
buffer_load_dwordx4 v3, s[12:15], s21 offen offset:1024  lds
buffer_load_dwordx4 v4, s[12:15], s21 offen offset:2048  lds
buffer_load_dwordx4 v5, s[12:15], s21 offen offset:3072  lds
s_add_u32 m0, s18, 96256
s_nop 0
buffer_load_dwordx4 v6, s[12:15], s21 offen offset:0  lds
buffer_load_dwordx4 v7, s[12:15], s21 offen offset:1024  lds
buffer_load_dwordx4 v8, s[12:15], s21 offen offset:2048  lds
buffer_load_dwordx4 v9, s[12:15], s21 offen offset:3072  lds
s_add_u32 s59, s59, 1
s_sub_u32 s60, s60, 1
s_cmp_eq_u32 s60, 0
s_cselect_b32 s62, s58, 0
s_cselect_b32 s60, s58, s60
s_sub_u32 s59, s59, s62
s_sub_u32 s61, s61, 1
s_cmp_eq_u32 s61, 0
s_cselect_b32 s62, s58, 0
s_cselect_b32 s61, s58, s61
s_add_u32 s59, s59, s62
s_cmp_ge_u32 s59, s57
s_cselect_b32 s62, 2, 0
s_add_u32 s62, s62, s59
s_mul_i32 s62, s62, s19
s_add_u32 s21, s35, s62
s_cmp_ge_u32 s2, 144
s_cbranch_scc1 Lu_79
s_cmp_lg_u32 s20, 3
s_cbranch_scc1 Lu_80
s_sub_u32 s3, s16, 4
s_lshl_b32 s3, s3, 10
s_add_u32 m0, s3, 155648
s_mov_b32 s3, s56
buffer_load_dwordx4 v33, s[92:95], s56 offen sc1 lds
buffer_load_dwordx4 v[104:107], v37, s[92:95], s3 offen sc1
buffer_load_dwordx4 v[108:111], v23, s[92:95], s3 offen sc1
s_add_u32 s3, s3, 46080
buffer_load_dwordx4 v[112:115], v37, s[92:95], s3 offen sc1
buffer_load_dwordx4 v[116:119], v23, s[92:95], s3 offen sc1
s_add_u32 s3, s3, 46080
buffer_load_dwordx4 v[120:123], v37, s[92:95], s3 offen sc1
buffer_load_dwordx4 v[124:127], v23, s[92:95], s3 offen sc1
s_add_u32 s3, s3, 46080
buffer_load_dwordx4 v[128:131], v37, s[92:95], s3 offen sc1
buffer_load_dwordx4 v[132:135], v23, s[92:95], s3 offen sc1
s_add_u32 s56, s56, 9216
Lu_80:
Lu_79:
s_sub_u32 s20, s20, 1
s_cmp_lg_u32 s20, 0
s_cbranch_scc1 Ll_72
Ll_72_e:
s_waitcnt vmcnt(16)
s_barrier
s_add_u32 m0, s18, 129024
s_nop 0
buffer_load_dwordx4 v2, s[12:15], s21 offen offset:0  lds
buffer_load_dwordx4 v3, s[12:15], s21 offen offset:1024  lds
buffer_load_dwordx4 v4, s[12:15], s21 offen offset:2048  lds
buffer_load_dwordx4 v5, s[12:15], s21 offen offset:3072  lds
s_add_u32 m0, s18, 133120
s_nop 0
buffer_load_dwordx4 v6, s[12:15], s21 offen offset:0  lds
buffer_load_dwordx4 v7, s[12:15], s21 offen offset:1024  lds
buffer_load_dwordx4 v8, s[12:15], s21 offen offset:2048  lds
buffer_load_dwordx4 v9, s[12:15], s21 offen offset:3072  lds
s_add_u32 s59, s59, 1
s_sub_u32 s60, s60, 1
s_cmp_eq_u32 s60, 0
s_cselect_b32 s62, s58, 0
s_cselect_b32 s60, s58, s60
s_sub_u32 s59, s59, s62
s_sub_u32 s61, s61, 1
s_cmp_eq_u32 s61, 0
s_cselect_b32 s62, s58, 0
s_cselect_b32 s61, s58, s61
s_add_u32 s59, s59, s62
s_cmp_ge_u32 s59, s57
s_cselect_b32 s62, 2, 0
s_add_u32 s62, s62, s59
s_mul_i32 s62, s62, s19
s_add_u32 s21, s35, s62
s_waitcnt vmcnt(16)
s_barrier
s_add_u32 m0, s18, 18432
s_nop 0
buffer_load_dwordx4 v2, s[12:15], s21 offen offset:0  lds
buffer_load_dwordx4 v3, s[12:15], s21 offen offset:1024  lds
buffer_load_dwordx4 v4, s[12:15], s21 offen offset:2048  lds
buffer_load_dwordx4 v5, s[12:15], s21 offen offset:3072  lds
s_add_u32 m0, s18, 22528
s_nop 0
buffer_load_dwordx4 v6, s[12:15], s21 offen offset:0  lds
buffer_load_dwordx4 v7, s[12:15], s21 offen offset:1024  lds
buffer_load_dwordx4 v8, s[12:15], s21 offen offset:2048  lds
buffer_load_dwordx4 v9, s[12:15], s21 offen offset:3072  lds
s_add_u32 s59, s59, 1
s_sub_u32 s60, s60, 1
s_cmp_eq_u32 s60, 0
s_cselect_b32 s62, s58, 0
s_cselect_b32 s60, s58, s60
s_sub_u32 s59, s59, s62
s_sub_u32 s61, s61, 1
s_cmp_eq_u32 s61, 0
s_cselect_b32 s62, s58, 0
s_cselect_b32 s61, s58, s61
s_add_u32 s59, s59, s62
s_cmp_ge_u32 s59, s57
s_cselect_b32 s62, 2, 0
s_add_u32 s62, s62, s59
s_mul_i32 s62, s62, s19
s_add_u32 s21, s35, s62
s_load_dwordx2 s[42:43], s[96:97], s48
s_waitcnt vmcnt(16)
s_barrier
s_add_u32 m0, s18, 55296
s_nop 0
buffer_load_dwordx4 v2, s[12:15], s21 offen offset:0  lds
buffer_load_dwordx4 v3, s[12:15], s21 offen offset:1024  lds
buffer_load_dwordx4 v4, s[12:15], s21 offen offset:2048  lds
buffer_load_dwordx4 v5, s[12:15], s21 offen offset:3072  lds
s_add_u32 m0, s18, 59392
s_nop 0
buffer_load_dwordx4 v6, s[12:15], s21 offen offset:0  lds
buffer_load_dwordx4 v7, s[12:15], s21 offen offset:1024  lds
buffer_load_dwordx4 v8, s[12:15], s21 offen offset:2048  lds
buffer_load_dwordx4 v9, s[12:15], s21 offen offset:3072  lds
s_add_u32 s59, s59, 1
s_sub_u32 s60, s60, 1
s_cmp_eq_u32 s60, 0
s_cselect_b32 s62, s58, 0
s_cselect_b32 s60, s58, s60
s_sub_u32 s59, s59, s62
s_sub_u32 s61, s61, 1
s_cmp_eq_u32 s61, 0
s_cselect_b32 s62, s58, 0
s_cselect_b32 s61, s58, s61
s_add_u32 s59, s59, s62
s_cmp_ge_u32 s59, s57
s_cselect_b32 s62, 2, 0
s_add_u32 s62, s62, s59
s_mul_i32 s62, s62, s19
s_add_u32 s21, s35, s62
s_waitcnt vmcnt(16)
s_barrier
s_waitcnt lgkmcnt(0)
s_cmp_eq_u64 s[42:43], s[100:101]
s_cbranch_scc1 Lt_82
s_mov_b32 s63, 60000
Lp_83:
buffer_load_dwordx2 v[30:31], v28, s[96:99], 0 offen sc1
s_waitcnt vmcnt(0)
v_cmp_ne_u64 vcc, s[100:101], v[30:31]
s_sub_u32 s63, s63, 1
s_cbranch_scc1 Lx_84
s_nop 2
s_cbranch_vccz Lx_84
s_mov_b64 exec, vcc
s_branch Lp_83
Lx_84:
s_mov_b64 exec, -1
Lt_82:
s_add_u32 m0, s34, 73728
s_nop 0
buffer_load_dwordx4 v20, s[36:39], s33 offen offset:0 sc1 lds
buffer_load_dwordx4 v20, s[36:39], s33 offen offset:1024 sc1 lds
buffer_load_dwordx4 v20, s[36:39], s33 offen offset:2048 sc1 lds
buffer_load_dwordx4 v20, s[36:39], s33 offen offset:3072 sc1 lds
s_add_u32 m0, s34, 77824
s_nop 0
buffer_load_dwordx4 v21, s[36:39], s33 offen offset:0 sc1 lds
buffer_load_dwordx4 v21, s[36:39], s33 offen offset:1024 sc1 lds
buffer_load_dwordx4 v21, s[36:39], s33 offen offset:2048 sc1 lds
buffer_load_dwordx4 v21, s[36:39], s33 offen offset:3072 sc1 lds
s_add_u32 m0, s34, 81920
s_nop 0
buffer_load_dwordx4 v22, s[36:39], s33 offen offset:0 sc1 lds
s_lshl_b32 s3, s29, 10
s_add_u32 m0, s3, 158720
s_nop 0
buffer_load_dwordx4 v22, s[36:39], s33 offen offset:1024 sc1 lds
s_waitcnt vmcnt(18)
s_barrier
s_add_u32 m0, s34, 110592
s_nop 0
buffer_load_dwordx4 v20, s[36:39], s32 offen offset:0 sc1 lds
buffer_load_dwordx4 v20, s[36:39], s32 offen offset:1024 sc1 lds
buffer_load_dwordx4 v20, s[36:39], s32 offen offset:2048 sc1 lds
buffer_load_dwordx4 v20, s[36:39], s32 offen offset:3072 sc1 lds
s_add_u32 m0, s34, 114688
s_nop 0
buffer_load_dwordx4 v21, s[36:39], s32 offen offset:0 sc1 lds
buffer_load_dwordx4 v21, s[36:39], s32 offen offset:1024 sc1 lds
buffer_load_dwordx4 v21, s[36:39], s32 offen offset:2048 sc1 lds
buffer_load_dwordx4 v21, s[36:39], s32 offen offset:3072 sc1 lds
s_add_u32 m0, s34, 118784
s_nop 0
buffer_load_dwordx4 v22, s[36:39], s32 offen offset:0 sc1 lds
s_add_u32 s32, s32, 9216
s_waitcnt vmcnt(19)
s_barrier
s_add_u32 m0, s34, 0
s_nop 0
buffer_load_dwordx4 v20, s[36:39], s32 offen offset:0 sc1 lds
buffer_load_dwordx4 v20, s[36:39], s32 offen offset:1024 sc1 lds
buffer_load_dwordx4 v20, s[36:39], s32 offen offset:2048 sc1 lds
buffer_load_dwordx4 v20, s[36:39], s32 offen offset:3072 sc1 lds
s_add_u32 m0, s34, 4096
s_nop 0
buffer_load_dwordx4 v21, s[36:39], s32 offen offset:0 sc1 lds
buffer_load_dwordx4 v21, s[36:39], s32 offen offset:1024 sc1 lds
buffer_load_dwordx4 v21, s[36:39], s32 offen offset:2048 sc1 lds
buffer_load_dwordx4 v21, s[36:39], s32 offen offset:3072 sc1 lds
s_add_u32 m0, s34, 8192
s_nop 0
buffer_load_dwordx4 v22, s[36:39], s32 offen offset:0 sc1 lds
s_add_u32 s32, s32, 9216
Lz_81:
K2_rx:
v_add_u32 v2, 73728, v20
v_add_u32 v3, 159744, v20
v_and_b32 v4, 15, v24
v_mul_u32_u24 v4, 592, v4
v_lshrrev_b32 v5, 4, v24
v_lshl_add_u32 v4, v5, 4, v4
s_and_b32 s3, s29, 1
s_mul_i32 s3, s3, 9472
v_add_u32 v5, s3, v4
s_lshl_b32 s3, s29, 6
v_add_u32 v4, s3, v4
v_pk_mov_b32 v[216:217], 0, 0
v_pk_mov_b32 v[218:219], 0, 0
s_waitcnt vmcnt(9)
s_barrier
ds_read_b128 v[136:139], v2 offset:4096
ds_read_b128 v[140:143], v2 offset:5120
ds_read_b128 v[144:147], v2 offset:13312
ds_read_b128 v[148:151], v2 offset:14336
ds_read_b128 v[152:155], v2 offset:22528
ds_read_b128 v[156:159], v2 offset:23552
ds_read_b128 v[160:163], v2 offset:31744
ds_read_b128 v[164:167], v2 offset:32768
s_waitcnt lgkmcnt(0)
v_mfma_f32_16x16x32_bf16 v[200:203], v[40:43], v[136:139], 0
ds_read_b128 v[168:171], v2 offset:6144
v_mfma_f32_16x16x32_bf16 v[204:207], v[40:43], v[140:143], 0
ds_read_b128 v[172:175], v2 offset:7168
v_mfma_f32_16x16x32_bf16 v[208:211], v[44:47], v[136:139], 0
ds_read_b128 v[176:179], v2 offset:15360
v_mfma_f32_16x16x32_bf16 v[212:215], v[44:47], v[140:143], 0
ds_read_b128 v[180:183], v2 offset:16384
v_mfma_f32_16x16x32_bf16 v[200:203], v[48:51], v[144:147], v[200:203]
ds_read_b128 v[184:187], v2 offset:24576
v_mfma_f32_16x16x32_bf16 v[204:207], v[48:51], v[148:151], v[204:207]
ds_read_b128 v[188:191], v2 offset:25600
v_mfma_f32_16x16x32_bf16 v[208:211], v[52:55], v[144:147], v[208:211]
ds_read_b128 v[192:195], v2 offset:33792
v_mfma_f32_16x16x32_bf16 v[212:215], v[52:55], v[148:151], v[212:215]
ds_read_b128 v[196:199], v2 offset:34816
v_mfma_f32_16x16x32_bf16 v[200:203], v[56:59], v[152:155], v[200:203]
v_mfma_f32_16x16x32_bf16 v[204:207], v[56:59], v[156:159], v[204:207]
v_mfma_f32_16x16x32_bf16 v[208:211], v[60:63], v[152:155], v[208:211]
v_mfma_f32_16x16x32_bf16 v[212:215], v[60:63], v[156:159], v[212:215]
v_mfma_f32_16x16x32_bf16 v[200:203], v[64:67], v[160:163], v[200:203]
v_mfma_f32_16x16x32_bf16 v[204:207], v[64:67], v[164:167], v[204:207]
v_mfma_f32_16x16x32_bf16 v[208:211], v[68:71], v[160:163], v[208:211]
v_mfma_f32_16x16x32_bf16 v[212:215], v[68:71], v[164:167], v[212:215]
s_waitcnt vmcnt(0)
s_barrier
s_waitcnt lgkmcnt(0)
v_mfma_f32_16x16x32_bf16 v[200:203], v[72:75], v[168:171], v[200:203]
ds_read_b128 v[136:139], v2 offset:8192
v_mfma_f32_16x16x32_bf16 v[204:207], v[72:75], v[172:175], v[204:207]
ds_read_b128 v[140:143], v3 offset:0
v_mfma_f32_16x16x32_bf16 v[208:211], v[76:79], v[168:171], v[208:211]
ds_read_b128 v[144:147], v2 offset:17408
v_mfma_f32_16x16x32_bf16 v[212:215], v[76:79], v[172:175], v[212:215]
ds_read_b128 v[148:151], v3 offset:1024
v_mfma_f32_16x16x32_bf16 v[200:203], v[80:83], v[176:179], v[200:203]
ds_read_b128 v[152:155], v2 offset:26624
v_mfma_f32_16x16x32_bf16 v[204:207], v[80:83], v[180:183], v[204:207]
ds_read_b128 v[156:159], v3 offset:2048
v_mfma_f32_16x16x32_bf16 v[208:211], v[84:87], v[176:179], v[208:211]
ds_read_b128 v[160:163], v2 offset:35840
v_mfma_f32_16x16x32_bf16 v[212:215], v[84:87], v[180:183], v[212:215]
ds_read_b128 v[164:167], v3 offset:3072
v_mfma_f32_16x16x32_bf16 v[200:203], v[88:91], v[184:187], v[200:203]
v_mfma_f32_16x16x32_bf16 v[204:207], v[88:91], v[188:191], v[204:207]
v_mfma_f32_16x16x32_bf16 v[208:211], v[92:95], v[184:187], v[208:211]
v_mfma_f32_16x16x32_bf16 v[212:215], v[92:95], v[188:191], v[212:215]
v_mfma_f32_16x16x32_bf16 v[200:203], v[96:99], v[192:195], v[200:203]
v_mfma_f32_16x16x32_bf16 v[204:207], v[96:99], v[196:199], v[204:207]
v_mfma_f32_16x16x32_bf16 v[208:211], v[100:103], v[192:195], v[208:211]
v_mfma_f32_16x16x32_bf16 v[212:215], v[100:103], v[196:199], v[212:215]
s_barrier
buffer_load_dwordx2 v[34:35], v32, s[96:99], 0 offen sc1
s_waitcnt lgkmcnt(0)
v_mfma_f32_16x16x32_bf16 v[200:203], v[104:107], v[136:139], v[200:203]
v_mfma_f32_16x16x32_bf16 v[204:207], v[104:107], v[140:143], v[204:207]
v_mfma_f32_16x16x32_bf16 v[208:211], v[108:111], v[136:139], v[208:211]
v_mfma_f32_16x16x32_bf16 v[212:215], v[108:111], v[140:143], v[212:215]
v_mfma_f32_16x16x32_bf16 v[200:203], v[112:115], v[144:147], v[200:203]
v_mfma_f32_16x16x32_bf16 v[204:207], v[112:115], v[148:151], v[204:207]
v_mfma_f32_16x16x32_bf16 v[208:211], v[116:119], v[144:147], v[208:211]
v_mfma_f32_16x16x32_bf16 v[212:215], v[116:119], v[148:151], v[212:215]
v_mfma_f32_16x16x32_bf16 v[200:203], v[120:123], v[152:155], v[200:203]
v_mfma_f32_16x16x32_bf16 v[204:207], v[120:123], v[156:159], v[204:207]
v_mfma_f32_16x16x32_bf16 v[208:211], v[124:127], v[152:155], v[208:211]
v_mfma_f32_16x16x32_bf16 v[212:215], v[124:127], v[156:159], v[212:215]
v_mfma_f32_16x16x32_bf16 v[200:203], v[128:131], v[160:163], v[200:203]
v_mfma_f32_16x16x32_bf16 v[204:207], v[128:131], v[164:167], v[204:207]
v_mfma_f32_16x16x32_bf16 v[208:211], v[132:135], v[160:163], v[208:211]
v_mfma_f32_16x16x32_bf16 v[212:215], v[132:135], v[164:167], v[212:215]
ds_write_b128 v5, v[216:219] offset:512
s_nop 3
ds_write_b128 v4, v[200:203] offset:0
ds_write_b128 v4, v[204:207] offset:9472
ds_write_b128 v4, v[208:211] offset:256
ds_write_b128 v4, v[212:215] offset:9728
s_waitcnt vmcnt(0)
s_cmp_eq_u32 s29, s28
s_cbranch_scc1 K2_fin
s_add_u32 s8, s26, 20971520
s_addc_u32 s9, s27, 0
s_mov_b32 s10, 9437184
s_mov_b32 s11, 0x20000
s_add_u32 m0, s31, 36864
v_cmp_ne_u64 vcc, s[100:101], v[34:35]
v_lshrrev_b32 v2, 5, v24
v_xor_b32 v2, v2, v24
v_lshlrev_b32 v2, 4, v2
s_nop 1
s_cbranch_vccz K2_rx1
s_mov_b64 exec, 1
s_mov_b32 s63, 60000
Lp_85:
buffer_load_dwordx2 v[34:35], v32, s[96:99], 0 offen sc1
s_waitcnt vmcnt(0)
v_cmp_ne_u64 vcc, s[100:101], v[34:35]
s_sub_u32 s63, s63, 1
s_cbranch_scc1 Lx_86
s_nop 2
s_cbranch_vccz Lx_86
s_mov_b64 exec, vcc
s_sleep 1
s_branch Lp_85
Lx_86:
s_mov_b64 exec, -1
K2_rx1:
buffer_load_dwordx4 v2, s[8:11], s30 offen sc1 lds
s_add_u32 m0, m0, 1056
s_add_u32 s30, s30, 1024
buffer_load_dwordx4 v2, s[8:11], s30 offen sc1 lds
s_add_u32 m0, m0, 1056
s_add_u32 s30, s30, 1024
buffer_load_dwordx4 v2, s[8:11], s30 offen sc1 lds
s_add_u32 m0, m0, 1056
s_add_u32 s30, s30, 1024
buffer_load_dwordx4 v2, s[8:11], s30 offen sc1 lds
s_add_u32 m0, m0, 1056
s_add_u32 s30, s30, 1024
buffer_load_dwordx4 v2, s[8:11], s30 offen sc1 lds
s_add_u32 m0, m0, 1056
s_add_u32 s30, s30, 1024
buffer_load_dwordx4 v2, s[8:11], s30 offen sc1 lds
s_add_u32 m0, m0, 1056
s_add_u32 s30, s30, 1024
buffer_load_dwordx4 v2, s[8:11], s30 offen sc1 lds
s_add_u32 m0, m0, 1056
s_add_u32 s30, s30, 1024
buffer_load_dwordx4 v2, s[8:11], s30 offen sc1 lds
s_add_u32 m0, m0, 1056
s_add_u32 s30, s30, 1024
buffer_load_dwordx4 v2, s[8:11], s30 offen sc1 lds
s_add_u32 m0, m0, 1056
s_add_u32 s30, s30, 1024
s_branch K2_fin
K_end:
s_endpgm
CODE_END:
s_endpgm
.section .rodata,"a"
.p2align 6
.amdhsa_kernel parallel_sum__linear_kernel_hedgehog__mixer_token_mlp__prompt_kernel
  .amdhsa_next_free_vgpr 256
  .amdhsa_next_free_sgpr 102
  .amdhsa_accum_offset 256
  .amdhsa_group_segment_fixed_size 0
  .amdhsa_kernarg_size 96
  .amdhsa_user_sgpr_count 2
  .amdhsa_user_sgpr_kernarg_segment_ptr 1
  .amdhsa_system_sgpr_workgroup_id_x 1
.end_amdhsa_kernel
```
